```python
import torch

def _softmax(x, axis=-1):
    return torch.softmax(x, dim=axis)
def _gelu(x):
    return torch.nn.functional.gelu(x, approximate="tanh")
def _silu(x):
    return torch.nn.functional.silu(x)
def _sigmoid(x):
    return torch.sigmoid(x)
def _layernorm(x, axis=-1, eps=1e-5):
    m = x.mean(dim=axis, keepdim=True)
    v = x.var(dim=axis, keepdim=True, unbiased=False)
    return (x - m) / torch.sqrt(v + eps)
def _scatter_add(tgt, idx, src, axis=0):
    return tgt.clone().index_add_(axis, idx, src)
def _segment_sum(src, seg, n):
    out = torch.zeros((n,) + src.shape[1:], dtype=src.dtype)
    return out.index_add_(0, seg, src)
def _pad(x, pw):
    flat = tuple(v for pair in reversed(pw) for v in pair)
    return torch.nn.functional.pad(x, flat)

kernel_name = 'recurrent_scan__mha_block__glu_gated_swiglu__prompt'

def setup_inputs():

    _w = (lambda a: (lambda t: t.to(torch.bfloat16) if t.is_floating_point() else t)(torch.as_tensor(a)))
    def _A_setup():
        B, S, D, H = 1, 2048, 576, 32
        return {
            "x": _w((lambda *s: torch.randn(*s, dtype=torch.bfloat16) * 0.05)(B, S, D)),
            "wqkv": _w((lambda *s: torch.randn(*s, dtype=torch.bfloat16) * 0.2)(D, 3 * D)),
            "wo": _w((lambda *s: torch.randn(*s, dtype=torch.bfloat16) * 0.2)(D, D)),
        }
    _A_in = _A_setup()

    def _B_setup():
        B, S, D, F = 1, 2048, 576, 4608
        return {
            "x": _w((lambda *s: torch.randn(*s, dtype=torch.bfloat16) * 0.05)(B, S, D)),
            "w1": _w((lambda *s: torch.randn(*s, dtype=torch.bfloat16) * 0.1)(D, F) * (2.0 / D) ** 0.5),
            "w3": _w((lambda *s: torch.randn(*s, dtype=torch.bfloat16) * 0.1)(D, F) * (2.0 / D) ** 0.5),
            "w2": _w((lambda *s: torch.randn(*s, dtype=torch.bfloat16) * 0.1)(F, D) * (2.0 / F) ** 0.5),
        }
    _B_in = _B_setup()

    return {
        "A_x": _A_in["x"],
        "A_wqkv": _A_in["wqkv"],
        "A_wo": _A_in["wo"],
        "B_x": _B_in["x"],
        "B_w1": _B_in["w1"],
        "B_w3": _B_in["w3"],
        "B_w2": _B_in["w2"],
    }

def reference(A_x, A_wqkv, A_wo, B_x, B_w1, B_w3, B_w2):
    def _A_ref(x, wqkv, wo):
        B, S, D = x.shape
        H = 32
        Dh = D // H
        qkv = (lambda x, *d: x.permute(*d))((x @ wqkv).reshape(B, S, 3, H, Dh), 2, 0, 3, 1, 4)
        q, k, v = qkv[0], qkv[1], qkv[2]
        scores = torch.einsum("bhqd,bhkd->bhqk", q, k) * (Dh ** -0.5)
        p = _softmax(scores, axis=-1)
        o = torch.einsum("bhqk,bhkd->bhqd", p, v)
        return (lambda x, *d: x.permute(*d))(o, 0, 2, 1, 3).reshape(B, S, D) @ wo

    def _B_ref(x, w1, w3, w2):
        gate = torch.einsum("bsd,df->bsf", x, w1)
        up = torch.einsum("bsd,df->bsf", x, w3)
        h = _silu(gate) * up
        out = torch.einsum("bsf,fd->bsd", h, w2)
        return out

    x = A_x
    xn = _layernorm(x, axis=-1)
    s = _A_ref(xn, A_wqkv, A_wo)
    g = _silu(_B_ref(xn, B_w1, B_w3, B_w2))
    return x + s * g
```

```asm
; @launch kernel=k1_kernel grid=(256,1,1) block=(512,1,1) lds=147456
; @launch kernel=k2_kernel grid=(496,1,1) block=(256,1,1) lds=79936
.amdgcn_target "amdgcn-amd-amdhsa--gfx950"
.text
.globl k1_kernel
.p2align 8
.type k1_kernel,@function
k1_kernel:
    s_cmp_ge_u32 s2, 256
    s_cbranch_scc1 k1_kernel_end
    s_load_dwordx4 s[4:7], s[0:1], 0
    s_load_dwordx4 s[8:11], s[0:1], 32
    s_load_dwordx2 s[12:13], s[0:1], 72
    s_getpc_b64 s[34:35]
k1_kernel_pc_1:
    s_sub_u32 s34, s34, k1_kernel_pc_1-k1_kernel
    s_subb_u32 s35, s35, 0
    s_lshr_b32 s36, s2, 3
    v_lshrrev_b32 v20, 6, v0
    v_lshl_add_u32 v20, s36, 3, v20
    v_and_b32 v21, 1, v0
    v_lshl_add_u32 v20, v20, 1, v21
    v_lshlrev_b32 v20, 7, v20
    s_mov_b32 s36, k2_kernel_end-k1_kernel
    v_min_u32 v20, s36, v20
    global_load_dword v21, v20, s[34:35]
    v_lshrrev_b32 v1, 6, v0
    s_and_b32 s14, s2, 7
    v_readfirstlane_b32 s3, v1
    s_lshr_b32 s15, s2, 3
    s_lshr_b32 s47, s14, 1
    s_lshl_b32 s47, s47, 2
    s_lshr_b32 s48, s15, 3
    s_add_u32 s47, s47, s48
    s_and_b32 s14, s14, 1
    s_lshl_b32 s14, s14, 3
    s_and_b32 s15, s15, 7
    s_add_u32 s15, s14, s15
    s_mov_b32 s14, s47
    v_and_b32 v1, 63, v0
    s_lshr_b32 s47, s14, 1
    s_and_b32 s48, s14, 1
    s_sub_u32 s40, 5, s48
    s_mul_i32 s41, s47, 9
    s_mul_i32 s46, s48, 5
    s_add_u32 s41, s41, s46
    s_min_u32 s46, s47, 3
    s_mul_i32 s43, s47, 3
    s_add_u32 s43, s43, s46
    s_add_u32 s43, s43, s48
    s_cmp_lt_u32 s47, 3
    s_cselect_b32 s42, 3, 2
    s_cmp_eq_u32 s48, 0
    s_cselect_b32 s42, 1, s42
    s_waitcnt lgkmcnt(0)
    s_cmp_ge_u32 s3, 4
    s_cbranch_scc1 k1_kernel_loader
    s_mov_b32 s16, s4
    s_mov_b32 s17, s5
    s_mov_b32 s18, 0x240000
    s_mov_b32 s19, 0x20000
    v_and_b32 v2, 31, v1
    v_lshrrev_b32 v3, 5, v1
    v_and_b32 v15, 0x13, v2
    v_and_b32 v5, 4, v2
    v_lshl_or_b32 v15, v5, 1, v15
    v_and_b32 v5, 8, v2
    v_lshrrev_b32 v5, 1, v5
    v_or_b32 v15, v15, v5
    s_lshl_b32 s47, s15, 2
    s_add_u32 s47, s47, s3
    s_lshl_b32 s48, s47, 5
    s_and_b32 s54, s14, 3
    v_lshrrev_b32 v6, 3, v1
    s_movk_i32 s44, 1152
    v_mul_lo_u32 v6, v6, s44
    v_lshrrev_b32 v8, 4, v1
    v_and_b32 v9, 7, v1
    v_xor_b32 v8, v8, v9
    v_xor_b32 v9, 4, v8
    v_lshl_add_u32 v7, v9, 4, v6
    v_lshl_add_u32 v6, v8, 4, v6
    s_mul_i32 s44, s48, 1152
    s_mul_i32 s45, s3, 36864
    s_mul_i32 s55, s54, 9
    s_lshr_b32 s55, s55, 2
    s_cmp_eq_u32 s54, 3
    s_addc_u32 s55, s55, 0
    s_lshl_b32 s46, s55, 12
    s_add_u32 m0, s45, s46
    s_lshl_b32 s46, s55, 7
    s_add_u32 s46, s46, s44
    buffer_load_dwordx4 v6, s[16:19], s46 offen lds
    s_add_u32 m0, m0, 1024
    s_add_u32 s46, s46, 9216
    buffer_load_dwordx4 v7, s[16:19], s46 offen lds
    s_add_u32 m0, m0, 1024
    s_add_u32 s46, s46, 9216
    buffer_load_dwordx4 v6, s[16:19], s46 offen lds
    s_add_u32 m0, m0, 1024
    s_add_u32 s46, s46, 9216
    buffer_load_dwordx4 v7, s[16:19], s46 offen lds
    s_add_u32 s55, s55, 1
    s_cmp_eq_u32 s55, 9
    s_cselect_b32 s55, 0, s55
    s_lshl_b32 s46, s55, 12
    s_add_u32 m0, s45, s46
    s_lshl_b32 s46, s55, 7
    s_add_u32 s46, s46, s44
    buffer_load_dwordx4 v6, s[16:19], s46 offen lds
    s_add_u32 m0, m0, 1024
    s_add_u32 s46, s46, 9216
    buffer_load_dwordx4 v7, s[16:19], s46 offen lds
    s_add_u32 m0, m0, 1024
    s_add_u32 s46, s46, 9216
    buffer_load_dwordx4 v6, s[16:19], s46 offen lds
    s_add_u32 m0, m0, 1024
    s_add_u32 s46, s46, 9216
    buffer_load_dwordx4 v7, s[16:19], s46 offen lds
    s_add_u32 s55, s55, 1
    s_cmp_eq_u32 s55, 9
    s_cselect_b32 s55, 0, s55
    s_lshl_b32 s46, s55, 12
    s_add_u32 m0, s45, s46
    s_lshl_b32 s46, s55, 7
    s_add_u32 s46, s46, s44
    buffer_load_dwordx4 v6, s[16:19], s46 offen lds
    s_add_u32 m0, m0, 1024
    s_add_u32 s46, s46, 9216
    buffer_load_dwordx4 v7, s[16:19], s46 offen lds
    s_add_u32 m0, m0, 1024
    s_add_u32 s46, s46, 9216
    buffer_load_dwordx4 v6, s[16:19], s46 offen lds
    s_add_u32 m0, m0, 1024
    s_add_u32 s46, s46, 9216
    buffer_load_dwordx4 v7, s[16:19], s46 offen lds
    s_add_u32 s55, s55, 1
    s_cmp_eq_u32 s55, 9
    s_cselect_b32 s55, 0, s55
    s_lshl_b32 s46, s55, 12
    s_add_u32 m0, s45, s46
    s_lshl_b32 s46, s55, 7
    s_add_u32 s46, s46, s44
    buffer_load_dwordx4 v6, s[16:19], s46 offen lds
    s_add_u32 m0, m0, 1024
    s_add_u32 s46, s46, 9216
    buffer_load_dwordx4 v7, s[16:19], s46 offen lds
    s_add_u32 m0, m0, 1024
    s_add_u32 s46, s46, 9216
    buffer_load_dwordx4 v6, s[16:19], s46 offen lds
    s_add_u32 m0, m0, 1024
    s_add_u32 s46, s46, 9216
    buffer_load_dwordx4 v7, s[16:19], s46 offen lds
    s_add_u32 s55, s55, 1
    s_cmp_eq_u32 s55, 9
    s_cselect_b32 s55, 0, s55
    s_lshl_b32 s46, s55, 12
    s_add_u32 m0, s45, s46
    s_lshl_b32 s46, s55, 7
    s_add_u32 s46, s46, s44
    buffer_load_dwordx4 v6, s[16:19], s46 offen lds
    s_add_u32 m0, m0, 1024
    s_add_u32 s46, s46, 9216
    buffer_load_dwordx4 v7, s[16:19], s46 offen lds
    s_add_u32 m0, m0, 1024
    s_add_u32 s46, s46, 9216
    buffer_load_dwordx4 v6, s[16:19], s46 offen lds
    s_add_u32 m0, m0, 1024
    s_add_u32 s46, s46, 9216
    buffer_load_dwordx4 v7, s[16:19], s46 offen lds
    s_add_u32 s55, s55, 1
    s_cmp_eq_u32 s55, 9
    s_cselect_b32 s55, 0, s55
    s_lshl_b32 s46, s55, 12
    s_add_u32 m0, s45, s46
    s_lshl_b32 s46, s55, 7
    s_add_u32 s46, s46, s44
    buffer_load_dwordx4 v6, s[16:19], s46 offen lds
    s_add_u32 m0, m0, 1024
    s_add_u32 s46, s46, 9216
    buffer_load_dwordx4 v7, s[16:19], s46 offen lds
    s_add_u32 m0, m0, 1024
    s_add_u32 s46, s46, 9216
    buffer_load_dwordx4 v6, s[16:19], s46 offen lds
    s_add_u32 m0, m0, 1024
    s_add_u32 s46, s46, 9216
    buffer_load_dwordx4 v7, s[16:19], s46 offen lds
    s_add_u32 s55, s55, 1
    s_cmp_eq_u32 s55, 9
    s_cselect_b32 s55, 0, s55
    s_lshl_b32 s46, s55, 12
    s_add_u32 m0, s45, s46
    s_lshl_b32 s46, s55, 7
    s_add_u32 s46, s46, s44
    buffer_load_dwordx4 v6, s[16:19], s46 offen lds
    s_add_u32 m0, m0, 1024
    s_add_u32 s46, s46, 9216
    buffer_load_dwordx4 v7, s[16:19], s46 offen lds
    s_add_u32 m0, m0, 1024
    s_add_u32 s46, s46, 9216
    buffer_load_dwordx4 v6, s[16:19], s46 offen lds
    s_add_u32 m0, m0, 1024
    s_add_u32 s46, s46, 9216
    buffer_load_dwordx4 v7, s[16:19], s46 offen lds
    s_add_u32 s55, s55, 1
    s_cmp_eq_u32 s55, 9
    s_cselect_b32 s55, 0, s55
    s_lshl_b32 s46, s55, 12
    s_add_u32 m0, s45, s46
    s_lshl_b32 s46, s55, 7
    s_add_u32 s46, s46, s44
    buffer_load_dwordx4 v6, s[16:19], s46 offen lds
    s_add_u32 m0, m0, 1024
    s_add_u32 s46, s46, 9216
    buffer_load_dwordx4 v7, s[16:19], s46 offen lds
    s_add_u32 m0, m0, 1024
    s_add_u32 s46, s46, 9216
    buffer_load_dwordx4 v6, s[16:19], s46 offen lds
    s_add_u32 m0, m0, 1024
    s_add_u32 s46, s46, 9216
    buffer_load_dwordx4 v7, s[16:19], s46 offen lds
    s_add_u32 s55, s55, 1
    s_cmp_eq_u32 s55, 9
    s_cselect_b32 s55, 0, s55
    s_lshl_b32 s46, s55, 12
    s_add_u32 m0, s45, s46
    s_lshl_b32 s46, s55, 7
    s_add_u32 s46, s46, s44
    buffer_load_dwordx4 v6, s[16:19], s46 offen lds
    s_add_u32 m0, m0, 1024
    s_add_u32 s46, s46, 9216
    buffer_load_dwordx4 v7, s[16:19], s46 offen lds
    s_add_u32 m0, m0, 1024
    s_add_u32 s46, s46, 9216
    buffer_load_dwordx4 v6, s[16:19], s46 offen lds
    s_add_u32 m0, m0, 1024
    s_add_u32 s46, s46, 9216
    buffer_load_dwordx4 v7, s[16:19], s46 offen lds
    s_add_u32 s28, s12, 0x1000000
    s_addc_u32 s29, s13, 0
    s_mov_b32 s30, 0x1200000
    s_mov_b32 s31, 0x20000
    v_add_u32 v5, s48, v15
    v_lshlrev_b32 v12, 5, v5
    v_lshl_add_u32 v12, v3, 4, v12
    v_lshlrev_b32 v13, 12, v15
    v_lshl_add_u32 v13, v3, 4, v13
    s_lshl_b32 s44, s48, 1
    v_add_u32 v13, s44, v13
    v_lshlrev_b32 v11, 4, v1
    s_mul_i32 s49, s47, 294912
    s_lshl_b32 s44, s41, 12
    s_add_u32 s49, s49, s44
    s_lshl_b32 s44, s3, 11
    s_add_u32 s44, s44, 147456
    v_lshl_add_u32 v10, v1, 4, s44
    v_lshrrev_b32 v4, 5, v1
    v_lshlrev_b32 v4, 3, v4
    v_bfe_u32 v5, v1, 2, 2
    v_add_u32 v4, v4, v5
    v_lshlrev_b32 v6, 7, v4
    v_bfe_u32 v4, v1, 3, 1
    v_lshl_add_u32 v6, v4, 6, v6
    v_bfe_u32 v4, v1, 4, 1
    v_lshl_add_u32 v6, v4, 5, v6
    v_and_b32 v4, 1, v1
    v_lshl_add_u32 v6, v4, 4, v6
    v_bfe_u32 v4, v1, 1, 1
    v_lshl_add_u32 v6, v4, 3, v6
    v_xor_b32 v7, 64, v6
    v_mov_b32 v160, 0
    v_mov_b32 v161, 0
    v_mov_b32 v162, 0
    v_mov_b32 v163, 0
    v_mov_b32 v164, 0x3f803f80
    v_lshrrev_b32 v172, 1, v15
    v_and_b32 v172, 7, v172
    v_xor_b32 v172, v172, v3
    v_lshlrev_b32 v173, 7, v15
    v_add_u32 v173, s45, v173
    v_xor_b32 v168, 0, v172
    v_lshl_add_u32 v168, v168, 4, v173
    v_xor_b32 v169, 2, v172
    v_lshl_add_u32 v169, v169, 4, v173
    v_xor_b32 v170, 4, v172
    v_lshl_add_u32 v170, v170, 4, v173
    v_xor_b32 v171, 6, v172
    v_lshl_add_u32 v171, v171, 4, v173
    s_cmp_eq_u32 s54, 1
    s_cbranch_scc1 k1_kernel_xr1
    s_cmp_eq_u32 s54, 2
    s_cbranch_scc1 k1_kernel_xr2
    s_cmp_eq_u32 s54, 3
    s_cbranch_scc1 k1_kernel_xr3
    s_waitcnt vmcnt(32)
    ds_read_b128 v[16:19], v168 offset:0
    ds_read_b128 v[20:23], v169 offset:0
    ds_read_b128 v[24:27], v170 offset:0
    ds_read_b128 v[28:31], v171 offset:0
    s_waitcnt vmcnt(28)
    ds_read_b128 v[32:35], v168 offset:4096
    ds_read_b128 v[36:39], v169 offset:4096
    ds_read_b128 v[40:43], v170 offset:4096
    ds_read_b128 v[44:47], v171 offset:4096
    s_waitcnt lgkmcnt(4)
    v_dot2c_f32_bf16 v160, v16, v164
    v_dot2c_f32_bf16 v162, v16, v16
    v_dot2c_f32_bf16 v161, v17, v164
    v_dot2c_f32_bf16 v163, v17, v17
    v_dot2c_f32_bf16 v160, v18, v164
    v_dot2c_f32_bf16 v162, v18, v18
    v_dot2c_f32_bf16 v161, v19, v164
    v_dot2c_f32_bf16 v163, v19, v19
    v_dot2c_f32_bf16 v160, v20, v164
    v_dot2c_f32_bf16 v162, v20, v20
    v_dot2c_f32_bf16 v161, v21, v164
    v_dot2c_f32_bf16 v163, v21, v21
    v_dot2c_f32_bf16 v160, v22, v164
    v_dot2c_f32_bf16 v162, v22, v22
    v_dot2c_f32_bf16 v161, v23, v164
    v_dot2c_f32_bf16 v163, v23, v23
    v_dot2c_f32_bf16 v160, v24, v164
    v_dot2c_f32_bf16 v162, v24, v24
    v_dot2c_f32_bf16 v161, v25, v164
    v_dot2c_f32_bf16 v163, v25, v25
    v_dot2c_f32_bf16 v160, v26, v164
    v_dot2c_f32_bf16 v162, v26, v26
    v_dot2c_f32_bf16 v161, v27, v164
    v_dot2c_f32_bf16 v163, v27, v27
    v_dot2c_f32_bf16 v160, v28, v164
    v_dot2c_f32_bf16 v162, v28, v28
    v_dot2c_f32_bf16 v161, v29, v164
    v_dot2c_f32_bf16 v163, v29, v29
    v_dot2c_f32_bf16 v160, v30, v164
    v_dot2c_f32_bf16 v162, v30, v30
    v_dot2c_f32_bf16 v161, v31, v164
    v_dot2c_f32_bf16 v163, v31, v31
    s_waitcnt vmcnt(24)
    ds_read_b128 v[48:51], v168 offset:8192
    ds_read_b128 v[52:55], v169 offset:8192
    ds_read_b128 v[56:59], v170 offset:8192
    ds_read_b128 v[60:63], v171 offset:8192
    s_waitcnt lgkmcnt(4)
    v_dot2c_f32_bf16 v160, v32, v164
    v_dot2c_f32_bf16 v162, v32, v32
    v_dot2c_f32_bf16 v161, v33, v164
    v_dot2c_f32_bf16 v163, v33, v33
    v_dot2c_f32_bf16 v160, v34, v164
    v_dot2c_f32_bf16 v162, v34, v34
    v_dot2c_f32_bf16 v161, v35, v164
    v_dot2c_f32_bf16 v163, v35, v35
    v_dot2c_f32_bf16 v160, v36, v164
    v_dot2c_f32_bf16 v162, v36, v36
    v_dot2c_f32_bf16 v161, v37, v164
    v_dot2c_f32_bf16 v163, v37, v37
    v_dot2c_f32_bf16 v160, v38, v164
    v_dot2c_f32_bf16 v162, v38, v38
    v_dot2c_f32_bf16 v161, v39, v164
    v_dot2c_f32_bf16 v163, v39, v39
    v_dot2c_f32_bf16 v160, v40, v164
    v_dot2c_f32_bf16 v162, v40, v40
    v_dot2c_f32_bf16 v161, v41, v164
    v_dot2c_f32_bf16 v163, v41, v41
    v_dot2c_f32_bf16 v160, v42, v164
    v_dot2c_f32_bf16 v162, v42, v42
    v_dot2c_f32_bf16 v161, v43, v164
    v_dot2c_f32_bf16 v163, v43, v43
    v_dot2c_f32_bf16 v160, v44, v164
    v_dot2c_f32_bf16 v162, v44, v44
    v_dot2c_f32_bf16 v161, v45, v164
    v_dot2c_f32_bf16 v163, v45, v45
    v_dot2c_f32_bf16 v160, v46, v164
    v_dot2c_f32_bf16 v162, v46, v46
    v_dot2c_f32_bf16 v161, v47, v164
    v_dot2c_f32_bf16 v163, v47, v47
    s_waitcnt vmcnt(20)
    ds_read_b128 v[64:67], v168 offset:12288
    ds_read_b128 v[68:71], v169 offset:12288
    ds_read_b128 v[72:75], v170 offset:12288
    ds_read_b128 v[76:79], v171 offset:12288
    s_waitcnt lgkmcnt(4)
    v_dot2c_f32_bf16 v160, v48, v164
    v_dot2c_f32_bf16 v162, v48, v48
    v_dot2c_f32_bf16 v161, v49, v164
    v_dot2c_f32_bf16 v163, v49, v49
    v_dot2c_f32_bf16 v160, v50, v164
    v_dot2c_f32_bf16 v162, v50, v50
    v_dot2c_f32_bf16 v161, v51, v164
    v_dot2c_f32_bf16 v163, v51, v51
    v_dot2c_f32_bf16 v160, v52, v164
    v_dot2c_f32_bf16 v162, v52, v52
    v_dot2c_f32_bf16 v161, v53, v164
    v_dot2c_f32_bf16 v163, v53, v53
    v_dot2c_f32_bf16 v160, v54, v164
    v_dot2c_f32_bf16 v162, v54, v54
    v_dot2c_f32_bf16 v161, v55, v164
    v_dot2c_f32_bf16 v163, v55, v55
    v_dot2c_f32_bf16 v160, v56, v164
    v_dot2c_f32_bf16 v162, v56, v56
    v_dot2c_f32_bf16 v161, v57, v164
    v_dot2c_f32_bf16 v163, v57, v57
    v_dot2c_f32_bf16 v160, v58, v164
    v_dot2c_f32_bf16 v162, v58, v58
    v_dot2c_f32_bf16 v161, v59, v164
    v_dot2c_f32_bf16 v163, v59, v59
    v_dot2c_f32_bf16 v160, v60, v164
    v_dot2c_f32_bf16 v162, v60, v60
    v_dot2c_f32_bf16 v161, v61, v164
    v_dot2c_f32_bf16 v163, v61, v61
    v_dot2c_f32_bf16 v160, v62, v164
    v_dot2c_f32_bf16 v162, v62, v62
    v_dot2c_f32_bf16 v161, v63, v164
    v_dot2c_f32_bf16 v163, v63, v63
    s_waitcnt vmcnt(16)
    ds_read_b128 v[80:83], v168 offset:16384
    ds_read_b128 v[84:87], v169 offset:16384
    ds_read_b128 v[88:91], v170 offset:16384
    ds_read_b128 v[92:95], v171 offset:16384
    s_waitcnt lgkmcnt(4)
    v_dot2c_f32_bf16 v160, v64, v164
    v_dot2c_f32_bf16 v162, v64, v64
    v_dot2c_f32_bf16 v161, v65, v164
    v_dot2c_f32_bf16 v163, v65, v65
    v_dot2c_f32_bf16 v160, v66, v164
    v_dot2c_f32_bf16 v162, v66, v66
    v_dot2c_f32_bf16 v161, v67, v164
    v_dot2c_f32_bf16 v163, v67, v67
    v_dot2c_f32_bf16 v160, v68, v164
    v_dot2c_f32_bf16 v162, v68, v68
    v_dot2c_f32_bf16 v161, v69, v164
    v_dot2c_f32_bf16 v163, v69, v69
    v_dot2c_f32_bf16 v160, v70, v164
    v_dot2c_f32_bf16 v162, v70, v70
    v_dot2c_f32_bf16 v161, v71, v164
    v_dot2c_f32_bf16 v163, v71, v71
    v_dot2c_f32_bf16 v160, v72, v164
    v_dot2c_f32_bf16 v162, v72, v72
    v_dot2c_f32_bf16 v161, v73, v164
    v_dot2c_f32_bf16 v163, v73, v73
    v_dot2c_f32_bf16 v160, v74, v164
    v_dot2c_f32_bf16 v162, v74, v74
    v_dot2c_f32_bf16 v161, v75, v164
    v_dot2c_f32_bf16 v163, v75, v75
    v_dot2c_f32_bf16 v160, v76, v164
    v_dot2c_f32_bf16 v162, v76, v76
    v_dot2c_f32_bf16 v161, v77, v164
    v_dot2c_f32_bf16 v163, v77, v77
    v_dot2c_f32_bf16 v160, v78, v164
    v_dot2c_f32_bf16 v162, v78, v78
    v_dot2c_f32_bf16 v161, v79, v164
    v_dot2c_f32_bf16 v163, v79, v79
    s_waitcnt vmcnt(12)
    ds_read_b128 v[96:99], v168 offset:20480
    ds_read_b128 v[100:103], v169 offset:20480
    ds_read_b128 v[104:107], v170 offset:20480
    ds_read_b128 v[108:111], v171 offset:20480
    s_waitcnt lgkmcnt(4)
    v_dot2c_f32_bf16 v160, v80, v164
    v_dot2c_f32_bf16 v162, v80, v80
    v_dot2c_f32_bf16 v161, v81, v164
    v_dot2c_f32_bf16 v163, v81, v81
    v_dot2c_f32_bf16 v160, v82, v164
    v_dot2c_f32_bf16 v162, v82, v82
    v_dot2c_f32_bf16 v161, v83, v164
    v_dot2c_f32_bf16 v163, v83, v83
    v_dot2c_f32_bf16 v160, v84, v164
    v_dot2c_f32_bf16 v162, v84, v84
    v_dot2c_f32_bf16 v161, v85, v164
    v_dot2c_f32_bf16 v163, v85, v85
    v_dot2c_f32_bf16 v160, v86, v164
    v_dot2c_f32_bf16 v162, v86, v86
    v_dot2c_f32_bf16 v161, v87, v164
    v_dot2c_f32_bf16 v163, v87, v87
    v_dot2c_f32_bf16 v160, v88, v164
    v_dot2c_f32_bf16 v162, v88, v88
    v_dot2c_f32_bf16 v161, v89, v164
    v_dot2c_f32_bf16 v163, v89, v89
    v_dot2c_f32_bf16 v160, v90, v164
    v_dot2c_f32_bf16 v162, v90, v90
    v_dot2c_f32_bf16 v161, v91, v164
    v_dot2c_f32_bf16 v163, v91, v91
    v_dot2c_f32_bf16 v160, v92, v164
    v_dot2c_f32_bf16 v162, v92, v92
    v_dot2c_f32_bf16 v161, v93, v164
    v_dot2c_f32_bf16 v163, v93, v93
    v_dot2c_f32_bf16 v160, v94, v164
    v_dot2c_f32_bf16 v162, v94, v94
    v_dot2c_f32_bf16 v161, v95, v164
    v_dot2c_f32_bf16 v163, v95, v95
    s_waitcnt vmcnt(8)
    ds_read_b128 v[112:115], v168 offset:24576
    ds_read_b128 v[116:119], v169 offset:24576
    ds_read_b128 v[120:123], v170 offset:24576
    ds_read_b128 v[124:127], v171 offset:24576
    s_waitcnt lgkmcnt(4)
    v_dot2c_f32_bf16 v160, v96, v164
    v_dot2c_f32_bf16 v162, v96, v96
    v_dot2c_f32_bf16 v161, v97, v164
    v_dot2c_f32_bf16 v163, v97, v97
    v_dot2c_f32_bf16 v160, v98, v164
    v_dot2c_f32_bf16 v162, v98, v98
    v_dot2c_f32_bf16 v161, v99, v164
    v_dot2c_f32_bf16 v163, v99, v99
    v_dot2c_f32_bf16 v160, v100, v164
    v_dot2c_f32_bf16 v162, v100, v100
    v_dot2c_f32_bf16 v161, v101, v164
    v_dot2c_f32_bf16 v163, v101, v101
    v_dot2c_f32_bf16 v160, v102, v164
    v_dot2c_f32_bf16 v162, v102, v102
    v_dot2c_f32_bf16 v161, v103, v164
    v_dot2c_f32_bf16 v163, v103, v103
    v_dot2c_f32_bf16 v160, v104, v164
    v_dot2c_f32_bf16 v162, v104, v104
    v_dot2c_f32_bf16 v161, v105, v164
    v_dot2c_f32_bf16 v163, v105, v105
    v_dot2c_f32_bf16 v160, v106, v164
    v_dot2c_f32_bf16 v162, v106, v106
    v_dot2c_f32_bf16 v161, v107, v164
    v_dot2c_f32_bf16 v163, v107, v107
    v_dot2c_f32_bf16 v160, v108, v164
    v_dot2c_f32_bf16 v162, v108, v108
    v_dot2c_f32_bf16 v161, v109, v164
    v_dot2c_f32_bf16 v163, v109, v109
    v_dot2c_f32_bf16 v160, v110, v164
    v_dot2c_f32_bf16 v162, v110, v110
    v_dot2c_f32_bf16 v161, v111, v164
    v_dot2c_f32_bf16 v163, v111, v111
    s_waitcnt vmcnt(4)
    ds_read_b128 v[128:131], v168 offset:28672
    ds_read_b128 v[132:135], v169 offset:28672
    ds_read_b128 v[136:139], v170 offset:28672
    ds_read_b128 v[140:143], v171 offset:28672
    s_waitcnt lgkmcnt(4)
    v_dot2c_f32_bf16 v160, v112, v164
    v_dot2c_f32_bf16 v162, v112, v112
    v_dot2c_f32_bf16 v161, v113, v164
    v_dot2c_f32_bf16 v163, v113, v113
    v_dot2c_f32_bf16 v160, v114, v164
    v_dot2c_f32_bf16 v162, v114, v114
    v_dot2c_f32_bf16 v161, v115, v164
    v_dot2c_f32_bf16 v163, v115, v115
    v_dot2c_f32_bf16 v160, v116, v164
    v_dot2c_f32_bf16 v162, v116, v116
    v_dot2c_f32_bf16 v161, v117, v164
    v_dot2c_f32_bf16 v163, v117, v117
    v_dot2c_f32_bf16 v160, v118, v164
    v_dot2c_f32_bf16 v162, v118, v118
    v_dot2c_f32_bf16 v161, v119, v164
    v_dot2c_f32_bf16 v163, v119, v119
    v_dot2c_f32_bf16 v160, v120, v164
    v_dot2c_f32_bf16 v162, v120, v120
    v_dot2c_f32_bf16 v161, v121, v164
    v_dot2c_f32_bf16 v163, v121, v121
    v_dot2c_f32_bf16 v160, v122, v164
    v_dot2c_f32_bf16 v162, v122, v122
    v_dot2c_f32_bf16 v161, v123, v164
    v_dot2c_f32_bf16 v163, v123, v123
    v_dot2c_f32_bf16 v160, v124, v164
    v_dot2c_f32_bf16 v162, v124, v124
    v_dot2c_f32_bf16 v161, v125, v164
    v_dot2c_f32_bf16 v163, v125, v125
    v_dot2c_f32_bf16 v160, v126, v164
    v_dot2c_f32_bf16 v162, v126, v126
    v_dot2c_f32_bf16 v161, v127, v164
    v_dot2c_f32_bf16 v163, v127, v127
    s_waitcnt vmcnt(0)
    ds_read_b128 v[144:147], v168 offset:32768
    ds_read_b128 v[148:151], v169 offset:32768
    ds_read_b128 v[152:155], v170 offset:32768
    ds_read_b128 v[156:159], v171 offset:32768
    s_waitcnt lgkmcnt(4)
    v_dot2c_f32_bf16 v160, v128, v164
    v_dot2c_f32_bf16 v162, v128, v128
    v_dot2c_f32_bf16 v161, v129, v164
    v_dot2c_f32_bf16 v163, v129, v129
    v_dot2c_f32_bf16 v160, v130, v164
    v_dot2c_f32_bf16 v162, v130, v130
    v_dot2c_f32_bf16 v161, v131, v164
    v_dot2c_f32_bf16 v163, v131, v131
    v_dot2c_f32_bf16 v160, v132, v164
    v_dot2c_f32_bf16 v162, v132, v132
    v_dot2c_f32_bf16 v161, v133, v164
    v_dot2c_f32_bf16 v163, v133, v133
    v_dot2c_f32_bf16 v160, v134, v164
    v_dot2c_f32_bf16 v162, v134, v134
    v_dot2c_f32_bf16 v161, v135, v164
    v_dot2c_f32_bf16 v163, v135, v135
    v_dot2c_f32_bf16 v160, v136, v164
    v_dot2c_f32_bf16 v162, v136, v136
    v_dot2c_f32_bf16 v161, v137, v164
    v_dot2c_f32_bf16 v163, v137, v137
    v_dot2c_f32_bf16 v160, v138, v164
    v_dot2c_f32_bf16 v162, v138, v138
    v_dot2c_f32_bf16 v161, v139, v164
    v_dot2c_f32_bf16 v163, v139, v139
    v_dot2c_f32_bf16 v160, v140, v164
    v_dot2c_f32_bf16 v162, v140, v140
    v_dot2c_f32_bf16 v161, v141, v164
    v_dot2c_f32_bf16 v163, v141, v141
    v_dot2c_f32_bf16 v160, v142, v164
    v_dot2c_f32_bf16 v162, v142, v142
    v_dot2c_f32_bf16 v161, v143, v164
    v_dot2c_f32_bf16 v163, v143, v143
    s_waitcnt lgkmcnt(0)
    s_barrier
    v_dot2c_f32_bf16 v160, v144, v164
    v_dot2c_f32_bf16 v162, v144, v144
    v_dot2c_f32_bf16 v161, v145, v164
    v_dot2c_f32_bf16 v163, v145, v145
    v_dot2c_f32_bf16 v160, v146, v164
    v_dot2c_f32_bf16 v162, v146, v146
    v_dot2c_f32_bf16 v161, v147, v164
    v_dot2c_f32_bf16 v163, v147, v147
    v_dot2c_f32_bf16 v160, v148, v164
    v_dot2c_f32_bf16 v162, v148, v148
    v_dot2c_f32_bf16 v161, v149, v164
    v_dot2c_f32_bf16 v163, v149, v149
    v_dot2c_f32_bf16 v160, v150, v164
    v_dot2c_f32_bf16 v162, v150, v150
    v_dot2c_f32_bf16 v161, v151, v164
    v_dot2c_f32_bf16 v163, v151, v151
    v_dot2c_f32_bf16 v160, v152, v164
    v_dot2c_f32_bf16 v162, v152, v152
    v_dot2c_f32_bf16 v161, v153, v164
    v_dot2c_f32_bf16 v163, v153, v153
    v_dot2c_f32_bf16 v160, v154, v164
    v_dot2c_f32_bf16 v162, v154, v154
    v_dot2c_f32_bf16 v161, v155, v164
    v_dot2c_f32_bf16 v163, v155, v155
    v_dot2c_f32_bf16 v160, v156, v164
    v_dot2c_f32_bf16 v162, v156, v156
    v_dot2c_f32_bf16 v161, v157, v164
    v_dot2c_f32_bf16 v163, v157, v157
    v_dot2c_f32_bf16 v160, v158, v164
    v_dot2c_f32_bf16 v162, v158, v158
    v_dot2c_f32_bf16 v161, v159, v164
    v_dot2c_f32_bf16 v163, v159, v159
    s_branch k1_kernel_xrd
k1_kernel_xr1:
    s_waitcnt vmcnt(32)
    ds_read_b128 v[48:51], v168 offset:8192
    ds_read_b128 v[52:55], v169 offset:8192
    ds_read_b128 v[56:59], v170 offset:8192
    ds_read_b128 v[60:63], v171 offset:8192
    s_waitcnt vmcnt(28)
    ds_read_b128 v[64:67], v168 offset:12288
    ds_read_b128 v[68:71], v169 offset:12288
    ds_read_b128 v[72:75], v170 offset:12288
    ds_read_b128 v[76:79], v171 offset:12288
    s_waitcnt lgkmcnt(4)
    v_dot2c_f32_bf16 v160, v48, v164
    v_dot2c_f32_bf16 v162, v48, v48
    v_dot2c_f32_bf16 v161, v49, v164
    v_dot2c_f32_bf16 v163, v49, v49
    v_dot2c_f32_bf16 v160, v50, v164
    v_dot2c_f32_bf16 v162, v50, v50
    v_dot2c_f32_bf16 v161, v51, v164
    v_dot2c_f32_bf16 v163, v51, v51
    v_dot2c_f32_bf16 v160, v52, v164
    v_dot2c_f32_bf16 v162, v52, v52
    v_dot2c_f32_bf16 v161, v53, v164
    v_dot2c_f32_bf16 v163, v53, v53
    v_dot2c_f32_bf16 v160, v54, v164
    v_dot2c_f32_bf16 v162, v54, v54
    v_dot2c_f32_bf16 v161, v55, v164
    v_dot2c_f32_bf16 v163, v55, v55
    v_dot2c_f32_bf16 v160, v56, v164
    v_dot2c_f32_bf16 v162, v56, v56
    v_dot2c_f32_bf16 v161, v57, v164
    v_dot2c_f32_bf16 v163, v57, v57
    v_dot2c_f32_bf16 v160, v58, v164
    v_dot2c_f32_bf16 v162, v58, v58
    v_dot2c_f32_bf16 v161, v59, v164
    v_dot2c_f32_bf16 v163, v59, v59
    v_dot2c_f32_bf16 v160, v60, v164
    v_dot2c_f32_bf16 v162, v60, v60
    v_dot2c_f32_bf16 v161, v61, v164
    v_dot2c_f32_bf16 v163, v61, v61
    v_dot2c_f32_bf16 v160, v62, v164
    v_dot2c_f32_bf16 v162, v62, v62
    v_dot2c_f32_bf16 v161, v63, v164
    v_dot2c_f32_bf16 v163, v63, v63
    s_waitcnt vmcnt(24)
    ds_read_b128 v[80:83], v168 offset:16384
    ds_read_b128 v[84:87], v169 offset:16384
    ds_read_b128 v[88:91], v170 offset:16384
    ds_read_b128 v[92:95], v171 offset:16384
    s_waitcnt lgkmcnt(4)
    v_dot2c_f32_bf16 v160, v64, v164
    v_dot2c_f32_bf16 v162, v64, v64
    v_dot2c_f32_bf16 v161, v65, v164
    v_dot2c_f32_bf16 v163, v65, v65
    v_dot2c_f32_bf16 v160, v66, v164
    v_dot2c_f32_bf16 v162, v66, v66
    v_dot2c_f32_bf16 v161, v67, v164
    v_dot2c_f32_bf16 v163, v67, v67
    v_dot2c_f32_bf16 v160, v68, v164
    v_dot2c_f32_bf16 v162, v68, v68
    v_dot2c_f32_bf16 v161, v69, v164
    v_dot2c_f32_bf16 v163, v69, v69
    v_dot2c_f32_bf16 v160, v70, v164
    v_dot2c_f32_bf16 v162, v70, v70
    v_dot2c_f32_bf16 v161, v71, v164
    v_dot2c_f32_bf16 v163, v71, v71
    v_dot2c_f32_bf16 v160, v72, v164
    v_dot2c_f32_bf16 v162, v72, v72
    v_dot2c_f32_bf16 v161, v73, v164
    v_dot2c_f32_bf16 v163, v73, v73
    v_dot2c_f32_bf16 v160, v74, v164
    v_dot2c_f32_bf16 v162, v74, v74
    v_dot2c_f32_bf16 v161, v75, v164
    v_dot2c_f32_bf16 v163, v75, v75
    v_dot2c_f32_bf16 v160, v76, v164
    v_dot2c_f32_bf16 v162, v76, v76
    v_dot2c_f32_bf16 v161, v77, v164
    v_dot2c_f32_bf16 v163, v77, v77
    v_dot2c_f32_bf16 v160, v78, v164
    v_dot2c_f32_bf16 v162, v78, v78
    v_dot2c_f32_bf16 v161, v79, v164
    v_dot2c_f32_bf16 v163, v79, v79
    s_waitcnt vmcnt(20)
    ds_read_b128 v[96:99], v168 offset:20480
    ds_read_b128 v[100:103], v169 offset:20480
    ds_read_b128 v[104:107], v170 offset:20480
    ds_read_b128 v[108:111], v171 offset:20480
    s_waitcnt lgkmcnt(4)
    v_dot2c_f32_bf16 v160, v80, v164
    v_dot2c_f32_bf16 v162, v80, v80
    v_dot2c_f32_bf16 v161, v81, v164
    v_dot2c_f32_bf16 v163, v81, v81
    v_dot2c_f32_bf16 v160, v82, v164
    v_dot2c_f32_bf16 v162, v82, v82
    v_dot2c_f32_bf16 v161, v83, v164
    v_dot2c_f32_bf16 v163, v83, v83
    v_dot2c_f32_bf16 v160, v84, v164
    v_dot2c_f32_bf16 v162, v84, v84
    v_dot2c_f32_bf16 v161, v85, v164
    v_dot2c_f32_bf16 v163, v85, v85
    v_dot2c_f32_bf16 v160, v86, v164
    v_dot2c_f32_bf16 v162, v86, v86
    v_dot2c_f32_bf16 v161, v87, v164
    v_dot2c_f32_bf16 v163, v87, v87
    v_dot2c_f32_bf16 v160, v88, v164
    v_dot2c_f32_bf16 v162, v88, v88
    v_dot2c_f32_bf16 v161, v89, v164
    v_dot2c_f32_bf16 v163, v89, v89
    v_dot2c_f32_bf16 v160, v90, v164
    v_dot2c_f32_bf16 v162, v90, v90
    v_dot2c_f32_bf16 v161, v91, v164
    v_dot2c_f32_bf16 v163, v91, v91
    v_dot2c_f32_bf16 v160, v92, v164
    v_dot2c_f32_bf16 v162, v92, v92
    v_dot2c_f32_bf16 v161, v93, v164
    v_dot2c_f32_bf16 v163, v93, v93
    v_dot2c_f32_bf16 v160, v94, v164
    v_dot2c_f32_bf16 v162, v94, v94
    v_dot2c_f32_bf16 v161, v95, v164
    v_dot2c_f32_bf16 v163, v95, v95
    s_waitcnt vmcnt(16)
    ds_read_b128 v[112:115], v168 offset:24576
    ds_read_b128 v[116:119], v169 offset:24576
    ds_read_b128 v[120:123], v170 offset:24576
    ds_read_b128 v[124:127], v171 offset:24576
    s_waitcnt lgkmcnt(4)
    v_dot2c_f32_bf16 v160, v96, v164
    v_dot2c_f32_bf16 v162, v96, v96
    v_dot2c_f32_bf16 v161, v97, v164
    v_dot2c_f32_bf16 v163, v97, v97
    v_dot2c_f32_bf16 v160, v98, v164
    v_dot2c_f32_bf16 v162, v98, v98
    v_dot2c_f32_bf16 v161, v99, v164
    v_dot2c_f32_bf16 v163, v99, v99
    v_dot2c_f32_bf16 v160, v100, v164
    v_dot2c_f32_bf16 v162, v100, v100
    v_dot2c_f32_bf16 v161, v101, v164
    v_dot2c_f32_bf16 v163, v101, v101
    v_dot2c_f32_bf16 v160, v102, v164
    v_dot2c_f32_bf16 v162, v102, v102
    v_dot2c_f32_bf16 v161, v103, v164
    v_dot2c_f32_bf16 v163, v103, v103
    v_dot2c_f32_bf16 v160, v104, v164
    v_dot2c_f32_bf16 v162, v104, v104
    v_dot2c_f32_bf16 v161, v105, v164
    v_dot2c_f32_bf16 v163, v105, v105
    v_dot2c_f32_bf16 v160, v106, v164
    v_dot2c_f32_bf16 v162, v106, v106
    v_dot2c_f32_bf16 v161, v107, v164
    v_dot2c_f32_bf16 v163, v107, v107
    v_dot2c_f32_bf16 v160, v108, v164
    v_dot2c_f32_bf16 v162, v108, v108
    v_dot2c_f32_bf16 v161, v109, v164
    v_dot2c_f32_bf16 v163, v109, v109
    v_dot2c_f32_bf16 v160, v110, v164
    v_dot2c_f32_bf16 v162, v110, v110
    v_dot2c_f32_bf16 v161, v111, v164
    v_dot2c_f32_bf16 v163, v111, v111
    s_waitcnt vmcnt(12)
    ds_read_b128 v[128:131], v168 offset:28672
    ds_read_b128 v[132:135], v169 offset:28672
    ds_read_b128 v[136:139], v170 offset:28672
    ds_read_b128 v[140:143], v171 offset:28672
    s_waitcnt lgkmcnt(4)
    v_dot2c_f32_bf16 v160, v112, v164
    v_dot2c_f32_bf16 v162, v112, v112
    v_dot2c_f32_bf16 v161, v113, v164
    v_dot2c_f32_bf16 v163, v113, v113
    v_dot2c_f32_bf16 v160, v114, v164
    v_dot2c_f32_bf16 v162, v114, v114
    v_dot2c_f32_bf16 v161, v115, v164
    v_dot2c_f32_bf16 v163, v115, v115
    v_dot2c_f32_bf16 v160, v116, v164
    v_dot2c_f32_bf16 v162, v116, v116
    v_dot2c_f32_bf16 v161, v117, v164
    v_dot2c_f32_bf16 v163, v117, v117
    v_dot2c_f32_bf16 v160, v118, v164
    v_dot2c_f32_bf16 v162, v118, v118
    v_dot2c_f32_bf16 v161, v119, v164
    v_dot2c_f32_bf16 v163, v119, v119
    v_dot2c_f32_bf16 v160, v120, v164
    v_dot2c_f32_bf16 v162, v120, v120
    v_dot2c_f32_bf16 v161, v121, v164
    v_dot2c_f32_bf16 v163, v121, v121
    v_dot2c_f32_bf16 v160, v122, v164
    v_dot2c_f32_bf16 v162, v122, v122
    v_dot2c_f32_bf16 v161, v123, v164
    v_dot2c_f32_bf16 v163, v123, v123
    v_dot2c_f32_bf16 v160, v124, v164
    v_dot2c_f32_bf16 v162, v124, v124
    v_dot2c_f32_bf16 v161, v125, v164
    v_dot2c_f32_bf16 v163, v125, v125
    v_dot2c_f32_bf16 v160, v126, v164
    v_dot2c_f32_bf16 v162, v126, v126
    v_dot2c_f32_bf16 v161, v127, v164
    v_dot2c_f32_bf16 v163, v127, v127
    s_waitcnt vmcnt(8)
    ds_read_b128 v[144:147], v168 offset:32768
    ds_read_b128 v[148:151], v169 offset:32768
    ds_read_b128 v[152:155], v170 offset:32768
    ds_read_b128 v[156:159], v171 offset:32768
    s_waitcnt lgkmcnt(4)
    v_dot2c_f32_bf16 v160, v128, v164
    v_dot2c_f32_bf16 v162, v128, v128
    v_dot2c_f32_bf16 v161, v129, v164
    v_dot2c_f32_bf16 v163, v129, v129
    v_dot2c_f32_bf16 v160, v130, v164
    v_dot2c_f32_bf16 v162, v130, v130
    v_dot2c_f32_bf16 v161, v131, v164
    v_dot2c_f32_bf16 v163, v131, v131
    v_dot2c_f32_bf16 v160, v132, v164
    v_dot2c_f32_bf16 v162, v132, v132
    v_dot2c_f32_bf16 v161, v133, v164
    v_dot2c_f32_bf16 v163, v133, v133
    v_dot2c_f32_bf16 v160, v134, v164
    v_dot2c_f32_bf16 v162, v134, v134
    v_dot2c_f32_bf16 v161, v135, v164
    v_dot2c_f32_bf16 v163, v135, v135
    v_dot2c_f32_bf16 v160, v136, v164
    v_dot2c_f32_bf16 v162, v136, v136
    v_dot2c_f32_bf16 v161, v137, v164
    v_dot2c_f32_bf16 v163, v137, v137
    v_dot2c_f32_bf16 v160, v138, v164
    v_dot2c_f32_bf16 v162, v138, v138
    v_dot2c_f32_bf16 v161, v139, v164
    v_dot2c_f32_bf16 v163, v139, v139
    v_dot2c_f32_bf16 v160, v140, v164
    v_dot2c_f32_bf16 v162, v140, v140
    v_dot2c_f32_bf16 v161, v141, v164
    v_dot2c_f32_bf16 v163, v141, v141
    v_dot2c_f32_bf16 v160, v142, v164
    v_dot2c_f32_bf16 v162, v142, v142
    v_dot2c_f32_bf16 v161, v143, v164
    v_dot2c_f32_bf16 v163, v143, v143
    s_waitcnt vmcnt(4)
    ds_read_b128 v[16:19], v168 offset:0
    ds_read_b128 v[20:23], v169 offset:0
    ds_read_b128 v[24:27], v170 offset:0
    ds_read_b128 v[28:31], v171 offset:0
    s_waitcnt lgkmcnt(4)
    v_dot2c_f32_bf16 v160, v144, v164
    v_dot2c_f32_bf16 v162, v144, v144
    v_dot2c_f32_bf16 v161, v145, v164
    v_dot2c_f32_bf16 v163, v145, v145
    v_dot2c_f32_bf16 v160, v146, v164
    v_dot2c_f32_bf16 v162, v146, v146
    v_dot2c_f32_bf16 v161, v147, v164
    v_dot2c_f32_bf16 v163, v147, v147
    v_dot2c_f32_bf16 v160, v148, v164
    v_dot2c_f32_bf16 v162, v148, v148
    v_dot2c_f32_bf16 v161, v149, v164
    v_dot2c_f32_bf16 v163, v149, v149
    v_dot2c_f32_bf16 v160, v150, v164
    v_dot2c_f32_bf16 v162, v150, v150
    v_dot2c_f32_bf16 v161, v151, v164
    v_dot2c_f32_bf16 v163, v151, v151
    v_dot2c_f32_bf16 v160, v152, v164
    v_dot2c_f32_bf16 v162, v152, v152
    v_dot2c_f32_bf16 v161, v153, v164
    v_dot2c_f32_bf16 v163, v153, v153
    v_dot2c_f32_bf16 v160, v154, v164
    v_dot2c_f32_bf16 v162, v154, v154
    v_dot2c_f32_bf16 v161, v155, v164
    v_dot2c_f32_bf16 v163, v155, v155
    v_dot2c_f32_bf16 v160, v156, v164
    v_dot2c_f32_bf16 v162, v156, v156
    v_dot2c_f32_bf16 v161, v157, v164
    v_dot2c_f32_bf16 v163, v157, v157
    v_dot2c_f32_bf16 v160, v158, v164
    v_dot2c_f32_bf16 v162, v158, v158
    v_dot2c_f32_bf16 v161, v159, v164
    v_dot2c_f32_bf16 v163, v159, v159
    s_waitcnt vmcnt(0)
    ds_read_b128 v[32:35], v168 offset:4096
    ds_read_b128 v[36:39], v169 offset:4096
    ds_read_b128 v[40:43], v170 offset:4096
    ds_read_b128 v[44:47], v171 offset:4096
    s_waitcnt lgkmcnt(4)
    v_dot2c_f32_bf16 v160, v16, v164
    v_dot2c_f32_bf16 v162, v16, v16
    v_dot2c_f32_bf16 v161, v17, v164
    v_dot2c_f32_bf16 v163, v17, v17
    v_dot2c_f32_bf16 v160, v18, v164
    v_dot2c_f32_bf16 v162, v18, v18
    v_dot2c_f32_bf16 v161, v19, v164
    v_dot2c_f32_bf16 v163, v19, v19
    v_dot2c_f32_bf16 v160, v20, v164
    v_dot2c_f32_bf16 v162, v20, v20
    v_dot2c_f32_bf16 v161, v21, v164
    v_dot2c_f32_bf16 v163, v21, v21
    v_dot2c_f32_bf16 v160, v22, v164
    v_dot2c_f32_bf16 v162, v22, v22
    v_dot2c_f32_bf16 v161, v23, v164
    v_dot2c_f32_bf16 v163, v23, v23
    v_dot2c_f32_bf16 v160, v24, v164
    v_dot2c_f32_bf16 v162, v24, v24
    v_dot2c_f32_bf16 v161, v25, v164
    v_dot2c_f32_bf16 v163, v25, v25
    v_dot2c_f32_bf16 v160, v26, v164
    v_dot2c_f32_bf16 v162, v26, v26
    v_dot2c_f32_bf16 v161, v27, v164
    v_dot2c_f32_bf16 v163, v27, v27
    v_dot2c_f32_bf16 v160, v28, v164
    v_dot2c_f32_bf16 v162, v28, v28
    v_dot2c_f32_bf16 v161, v29, v164
    v_dot2c_f32_bf16 v163, v29, v29
    v_dot2c_f32_bf16 v160, v30, v164
    v_dot2c_f32_bf16 v162, v30, v30
    v_dot2c_f32_bf16 v161, v31, v164
    v_dot2c_f32_bf16 v163, v31, v31
    s_waitcnt lgkmcnt(0)
    s_barrier
    v_dot2c_f32_bf16 v160, v32, v164
    v_dot2c_f32_bf16 v162, v32, v32
    v_dot2c_f32_bf16 v161, v33, v164
    v_dot2c_f32_bf16 v163, v33, v33
    v_dot2c_f32_bf16 v160, v34, v164
    v_dot2c_f32_bf16 v162, v34, v34
    v_dot2c_f32_bf16 v161, v35, v164
    v_dot2c_f32_bf16 v163, v35, v35
    v_dot2c_f32_bf16 v160, v36, v164
    v_dot2c_f32_bf16 v162, v36, v36
    v_dot2c_f32_bf16 v161, v37, v164
    v_dot2c_f32_bf16 v163, v37, v37
    v_dot2c_f32_bf16 v160, v38, v164
    v_dot2c_f32_bf16 v162, v38, v38
    v_dot2c_f32_bf16 v161, v39, v164
    v_dot2c_f32_bf16 v163, v39, v39
    v_dot2c_f32_bf16 v160, v40, v164
    v_dot2c_f32_bf16 v162, v40, v40
    v_dot2c_f32_bf16 v161, v41, v164
    v_dot2c_f32_bf16 v163, v41, v41
    v_dot2c_f32_bf16 v160, v42, v164
    v_dot2c_f32_bf16 v162, v42, v42
    v_dot2c_f32_bf16 v161, v43, v164
    v_dot2c_f32_bf16 v163, v43, v43
    v_dot2c_f32_bf16 v160, v44, v164
    v_dot2c_f32_bf16 v162, v44, v44
    v_dot2c_f32_bf16 v161, v45, v164
    v_dot2c_f32_bf16 v163, v45, v45
    v_dot2c_f32_bf16 v160, v46, v164
    v_dot2c_f32_bf16 v162, v46, v46
    v_dot2c_f32_bf16 v161, v47, v164
    v_dot2c_f32_bf16 v163, v47, v47
    s_branch k1_kernel_xrd
k1_kernel_xr2:
    s_waitcnt vmcnt(32)
    ds_read_b128 v[80:83], v168 offset:16384
    ds_read_b128 v[84:87], v169 offset:16384
    ds_read_b128 v[88:91], v170 offset:16384
    ds_read_b128 v[92:95], v171 offset:16384
    s_waitcnt vmcnt(28)
    ds_read_b128 v[96:99], v168 offset:20480
    ds_read_b128 v[100:103], v169 offset:20480
    ds_read_b128 v[104:107], v170 offset:20480
    ds_read_b128 v[108:111], v171 offset:20480
    s_waitcnt lgkmcnt(4)
    v_dot2c_f32_bf16 v160, v80, v164
    v_dot2c_f32_bf16 v162, v80, v80
    v_dot2c_f32_bf16 v161, v81, v164
    v_dot2c_f32_bf16 v163, v81, v81
    v_dot2c_f32_bf16 v160, v82, v164
    v_dot2c_f32_bf16 v162, v82, v82
    v_dot2c_f32_bf16 v161, v83, v164
    v_dot2c_f32_bf16 v163, v83, v83
    v_dot2c_f32_bf16 v160, v84, v164
    v_dot2c_f32_bf16 v162, v84, v84
    v_dot2c_f32_bf16 v161, v85, v164
    v_dot2c_f32_bf16 v163, v85, v85
    v_dot2c_f32_bf16 v160, v86, v164
    v_dot2c_f32_bf16 v162, v86, v86
    v_dot2c_f32_bf16 v161, v87, v164
    v_dot2c_f32_bf16 v163, v87, v87
    v_dot2c_f32_bf16 v160, v88, v164
    v_dot2c_f32_bf16 v162, v88, v88
    v_dot2c_f32_bf16 v161, v89, v164
    v_dot2c_f32_bf16 v163, v89, v89
    v_dot2c_f32_bf16 v160, v90, v164
    v_dot2c_f32_bf16 v162, v90, v90
    v_dot2c_f32_bf16 v161, v91, v164
    v_dot2c_f32_bf16 v163, v91, v91
    v_dot2c_f32_bf16 v160, v92, v164
    v_dot2c_f32_bf16 v162, v92, v92
    v_dot2c_f32_bf16 v161, v93, v164
    v_dot2c_f32_bf16 v163, v93, v93
    v_dot2c_f32_bf16 v160, v94, v164
    v_dot2c_f32_bf16 v162, v94, v94
    v_dot2c_f32_bf16 v161, v95, v164
    v_dot2c_f32_bf16 v163, v95, v95
    s_waitcnt vmcnt(24)
    ds_read_b128 v[112:115], v168 offset:24576
    ds_read_b128 v[116:119], v169 offset:24576
    ds_read_b128 v[120:123], v170 offset:24576
    ds_read_b128 v[124:127], v171 offset:24576
    s_waitcnt lgkmcnt(4)
    v_dot2c_f32_bf16 v160, v96, v164
    v_dot2c_f32_bf16 v162, v96, v96
    v_dot2c_f32_bf16 v161, v97, v164
    v_dot2c_f32_bf16 v163, v97, v97
    v_dot2c_f32_bf16 v160, v98, v164
    v_dot2c_f32_bf16 v162, v98, v98
    v_dot2c_f32_bf16 v161, v99, v164
    v_dot2c_f32_bf16 v163, v99, v99
    v_dot2c_f32_bf16 v160, v100, v164
    v_dot2c_f32_bf16 v162, v100, v100
    v_dot2c_f32_bf16 v161, v101, v164
    v_dot2c_f32_bf16 v163, v101, v101
    v_dot2c_f32_bf16 v160, v102, v164
    v_dot2c_f32_bf16 v162, v102, v102
    v_dot2c_f32_bf16 v161, v103, v164
    v_dot2c_f32_bf16 v163, v103, v103
    v_dot2c_f32_bf16 v160, v104, v164
    v_dot2c_f32_bf16 v162, v104, v104
    v_dot2c_f32_bf16 v161, v105, v164
    v_dot2c_f32_bf16 v163, v105, v105
    v_dot2c_f32_bf16 v160, v106, v164
    v_dot2c_f32_bf16 v162, v106, v106
    v_dot2c_f32_bf16 v161, v107, v164
    v_dot2c_f32_bf16 v163, v107, v107
    v_dot2c_f32_bf16 v160, v108, v164
    v_dot2c_f32_bf16 v162, v108, v108
    v_dot2c_f32_bf16 v161, v109, v164
    v_dot2c_f32_bf16 v163, v109, v109
    v_dot2c_f32_bf16 v160, v110, v164
    v_dot2c_f32_bf16 v162, v110, v110
    v_dot2c_f32_bf16 v161, v111, v164
    v_dot2c_f32_bf16 v163, v111, v111
    s_waitcnt vmcnt(20)
    ds_read_b128 v[128:131], v168 offset:28672
    ds_read_b128 v[132:135], v169 offset:28672
    ds_read_b128 v[136:139], v170 offset:28672
    ds_read_b128 v[140:143], v171 offset:28672
    s_waitcnt lgkmcnt(4)
    v_dot2c_f32_bf16 v160, v112, v164
    v_dot2c_f32_bf16 v162, v112, v112
    v_dot2c_f32_bf16 v161, v113, v164
    v_dot2c_f32_bf16 v163, v113, v113
    v_dot2c_f32_bf16 v160, v114, v164
    v_dot2c_f32_bf16 v162, v114, v114
    v_dot2c_f32_bf16 v161, v115, v164
    v_dot2c_f32_bf16 v163, v115, v115
    v_dot2c_f32_bf16 v160, v116, v164
    v_dot2c_f32_bf16 v162, v116, v116
    v_dot2c_f32_bf16 v161, v117, v164
    v_dot2c_f32_bf16 v163, v117, v117
    v_dot2c_f32_bf16 v160, v118, v164
    v_dot2c_f32_bf16 v162, v118, v118
    v_dot2c_f32_bf16 v161, v119, v164
    v_dot2c_f32_bf16 v163, v119, v119
    v_dot2c_f32_bf16 v160, v120, v164
    v_dot2c_f32_bf16 v162, v120, v120
    v_dot2c_f32_bf16 v161, v121, v164
    v_dot2c_f32_bf16 v163, v121, v121
    v_dot2c_f32_bf16 v160, v122, v164
    v_dot2c_f32_bf16 v162, v122, v122
    v_dot2c_f32_bf16 v161, v123, v164
    v_dot2c_f32_bf16 v163, v123, v123
    v_dot2c_f32_bf16 v160, v124, v164
    v_dot2c_f32_bf16 v162, v124, v124
    v_dot2c_f32_bf16 v161, v125, v164
    v_dot2c_f32_bf16 v163, v125, v125
    v_dot2c_f32_bf16 v160, v126, v164
    v_dot2c_f32_bf16 v162, v126, v126
    v_dot2c_f32_bf16 v161, v127, v164
    v_dot2c_f32_bf16 v163, v127, v127
    s_waitcnt vmcnt(16)
    ds_read_b128 v[144:147], v168 offset:32768
    ds_read_b128 v[148:151], v169 offset:32768
    ds_read_b128 v[152:155], v170 offset:32768
    ds_read_b128 v[156:159], v171 offset:32768
    s_waitcnt lgkmcnt(4)
    v_dot2c_f32_bf16 v160, v128, v164
    v_dot2c_f32_bf16 v162, v128, v128
    v_dot2c_f32_bf16 v161, v129, v164
    v_dot2c_f32_bf16 v163, v129, v129
    v_dot2c_f32_bf16 v160, v130, v164
    v_dot2c_f32_bf16 v162, v130, v130
    v_dot2c_f32_bf16 v161, v131, v164
    v_dot2c_f32_bf16 v163, v131, v131
    v_dot2c_f32_bf16 v160, v132, v164
    v_dot2c_f32_bf16 v162, v132, v132
    v_dot2c_f32_bf16 v161, v133, v164
    v_dot2c_f32_bf16 v163, v133, v133
    v_dot2c_f32_bf16 v160, v134, v164
    v_dot2c_f32_bf16 v162, v134, v134
    v_dot2c_f32_bf16 v161, v135, v164
    v_dot2c_f32_bf16 v163, v135, v135
    v_dot2c_f32_bf16 v160, v136, v164
    v_dot2c_f32_bf16 v162, v136, v136
    v_dot2c_f32_bf16 v161, v137, v164
    v_dot2c_f32_bf16 v163, v137, v137
    v_dot2c_f32_bf16 v160, v138, v164
    v_dot2c_f32_bf16 v162, v138, v138
    v_dot2c_f32_bf16 v161, v139, v164
    v_dot2c_f32_bf16 v163, v139, v139
    v_dot2c_f32_bf16 v160, v140, v164
    v_dot2c_f32_bf16 v162, v140, v140
    v_dot2c_f32_bf16 v161, v141, v164
    v_dot2c_f32_bf16 v163, v141, v141
    v_dot2c_f32_bf16 v160, v142, v164
    v_dot2c_f32_bf16 v162, v142, v142
    v_dot2c_f32_bf16 v161, v143, v164
    v_dot2c_f32_bf16 v163, v143, v143
    s_waitcnt vmcnt(12)
    ds_read_b128 v[16:19], v168 offset:0
    ds_read_b128 v[20:23], v169 offset:0
    ds_read_b128 v[24:27], v170 offset:0
    ds_read_b128 v[28:31], v171 offset:0
    s_waitcnt lgkmcnt(4)
    v_dot2c_f32_bf16 v160, v144, v164
    v_dot2c_f32_bf16 v162, v144, v144
    v_dot2c_f32_bf16 v161, v145, v164
    v_dot2c_f32_bf16 v163, v145, v145
    v_dot2c_f32_bf16 v160, v146, v164
    v_dot2c_f32_bf16 v162, v146, v146
    v_dot2c_f32_bf16 v161, v147, v164
    v_dot2c_f32_bf16 v163, v147, v147
    v_dot2c_f32_bf16 v160, v148, v164
    v_dot2c_f32_bf16 v162, v148, v148
    v_dot2c_f32_bf16 v161, v149, v164
    v_dot2c_f32_bf16 v163, v149, v149
    v_dot2c_f32_bf16 v160, v150, v164
    v_dot2c_f32_bf16 v162, v150, v150
    v_dot2c_f32_bf16 v161, v151, v164
    v_dot2c_f32_bf16 v163, v151, v151
    v_dot2c_f32_bf16 v160, v152, v164
    v_dot2c_f32_bf16 v162, v152, v152
    v_dot2c_f32_bf16 v161, v153, v164
    v_dot2c_f32_bf16 v163, v153, v153
    v_dot2c_f32_bf16 v160, v154, v164
    v_dot2c_f32_bf16 v162, v154, v154
    v_dot2c_f32_bf16 v161, v155, v164
    v_dot2c_f32_bf16 v163, v155, v155
    v_dot2c_f32_bf16 v160, v156, v164
    v_dot2c_f32_bf16 v162, v156, v156
    v_dot2c_f32_bf16 v161, v157, v164
    v_dot2c_f32_bf16 v163, v157, v157
    v_dot2c_f32_bf16 v160, v158, v164
    v_dot2c_f32_bf16 v162, v158, v158
    v_dot2c_f32_bf16 v161, v159, v164
    v_dot2c_f32_bf16 v163, v159, v159
    s_waitcnt vmcnt(8)
    ds_read_b128 v[32:35], v168 offset:4096
    ds_read_b128 v[36:39], v169 offset:4096
    ds_read_b128 v[40:43], v170 offset:4096
    ds_read_b128 v[44:47], v171 offset:4096
    s_waitcnt lgkmcnt(4)
    v_dot2c_f32_bf16 v160, v16, v164
    v_dot2c_f32_bf16 v162, v16, v16
    v_dot2c_f32_bf16 v161, v17, v164
    v_dot2c_f32_bf16 v163, v17, v17
    v_dot2c_f32_bf16 v160, v18, v164
    v_dot2c_f32_bf16 v162, v18, v18
    v_dot2c_f32_bf16 v161, v19, v164
    v_dot2c_f32_bf16 v163, v19, v19
    v_dot2c_f32_bf16 v160, v20, v164
    v_dot2c_f32_bf16 v162, v20, v20
    v_dot2c_f32_bf16 v161, v21, v164
    v_dot2c_f32_bf16 v163, v21, v21
    v_dot2c_f32_bf16 v160, v22, v164
    v_dot2c_f32_bf16 v162, v22, v22
    v_dot2c_f32_bf16 v161, v23, v164
    v_dot2c_f32_bf16 v163, v23, v23
    v_dot2c_f32_bf16 v160, v24, v164
    v_dot2c_f32_bf16 v162, v24, v24
    v_dot2c_f32_bf16 v161, v25, v164
    v_dot2c_f32_bf16 v163, v25, v25
    v_dot2c_f32_bf16 v160, v26, v164
    v_dot2c_f32_bf16 v162, v26, v26
    v_dot2c_f32_bf16 v161, v27, v164
    v_dot2c_f32_bf16 v163, v27, v27
    v_dot2c_f32_bf16 v160, v28, v164
    v_dot2c_f32_bf16 v162, v28, v28
    v_dot2c_f32_bf16 v161, v29, v164
    v_dot2c_f32_bf16 v163, v29, v29
    v_dot2c_f32_bf16 v160, v30, v164
    v_dot2c_f32_bf16 v162, v30, v30
    v_dot2c_f32_bf16 v161, v31, v164
    v_dot2c_f32_bf16 v163, v31, v31
    s_waitcnt vmcnt(4)
    ds_read_b128 v[48:51], v168 offset:8192
    ds_read_b128 v[52:55], v169 offset:8192
    ds_read_b128 v[56:59], v170 offset:8192
    ds_read_b128 v[60:63], v171 offset:8192
    s_waitcnt lgkmcnt(4)
    v_dot2c_f32_bf16 v160, v32, v164
    v_dot2c_f32_bf16 v162, v32, v32
    v_dot2c_f32_bf16 v161, v33, v164
    v_dot2c_f32_bf16 v163, v33, v33
    v_dot2c_f32_bf16 v160, v34, v164
    v_dot2c_f32_bf16 v162, v34, v34
    v_dot2c_f32_bf16 v161, v35, v164
    v_dot2c_f32_bf16 v163, v35, v35
    v_dot2c_f32_bf16 v160, v36, v164
    v_dot2c_f32_bf16 v162, v36, v36
    v_dot2c_f32_bf16 v161, v37, v164
    v_dot2c_f32_bf16 v163, v37, v37
    v_dot2c_f32_bf16 v160, v38, v164
    v_dot2c_f32_bf16 v162, v38, v38
    v_dot2c_f32_bf16 v161, v39, v164
    v_dot2c_f32_bf16 v163, v39, v39
    v_dot2c_f32_bf16 v160, v40, v164
    v_dot2c_f32_bf16 v162, v40, v40
    v_dot2c_f32_bf16 v161, v41, v164
    v_dot2c_f32_bf16 v163, v41, v41
    v_dot2c_f32_bf16 v160, v42, v164
    v_dot2c_f32_bf16 v162, v42, v42
    v_dot2c_f32_bf16 v161, v43, v164
    v_dot2c_f32_bf16 v163, v43, v43
    v_dot2c_f32_bf16 v160, v44, v164
    v_dot2c_f32_bf16 v162, v44, v44
    v_dot2c_f32_bf16 v161, v45, v164
    v_dot2c_f32_bf16 v163, v45, v45
    v_dot2c_f32_bf16 v160, v46, v164
    v_dot2c_f32_bf16 v162, v46, v46
    v_dot2c_f32_bf16 v161, v47, v164
    v_dot2c_f32_bf16 v163, v47, v47
    s_waitcnt vmcnt(0)
    ds_read_b128 v[64:67], v168 offset:12288
    ds_read_b128 v[68:71], v169 offset:12288
    ds_read_b128 v[72:75], v170 offset:12288
    ds_read_b128 v[76:79], v171 offset:12288
    s_waitcnt lgkmcnt(4)
    v_dot2c_f32_bf16 v160, v48, v164
    v_dot2c_f32_bf16 v162, v48, v48
    v_dot2c_f32_bf16 v161, v49, v164
    v_dot2c_f32_bf16 v163, v49, v49
    v_dot2c_f32_bf16 v160, v50, v164
    v_dot2c_f32_bf16 v162, v50, v50
    v_dot2c_f32_bf16 v161, v51, v164
    v_dot2c_f32_bf16 v163, v51, v51
    v_dot2c_f32_bf16 v160, v52, v164
    v_dot2c_f32_bf16 v162, v52, v52
    v_dot2c_f32_bf16 v161, v53, v164
    v_dot2c_f32_bf16 v163, v53, v53
    v_dot2c_f32_bf16 v160, v54, v164
    v_dot2c_f32_bf16 v162, v54, v54
    v_dot2c_f32_bf16 v161, v55, v164
    v_dot2c_f32_bf16 v163, v55, v55
    v_dot2c_f32_bf16 v160, v56, v164
    v_dot2c_f32_bf16 v162, v56, v56
    v_dot2c_f32_bf16 v161, v57, v164
    v_dot2c_f32_bf16 v163, v57, v57
    v_dot2c_f32_bf16 v160, v58, v164
    v_dot2c_f32_bf16 v162, v58, v58
    v_dot2c_f32_bf16 v161, v59, v164
    v_dot2c_f32_bf16 v163, v59, v59
    v_dot2c_f32_bf16 v160, v60, v164
    v_dot2c_f32_bf16 v162, v60, v60
    v_dot2c_f32_bf16 v161, v61, v164
    v_dot2c_f32_bf16 v163, v61, v61
    v_dot2c_f32_bf16 v160, v62, v164
    v_dot2c_f32_bf16 v162, v62, v62
    v_dot2c_f32_bf16 v161, v63, v164
    v_dot2c_f32_bf16 v163, v63, v63
    s_waitcnt lgkmcnt(0)
    s_barrier
    v_dot2c_f32_bf16 v160, v64, v164
    v_dot2c_f32_bf16 v162, v64, v64
    v_dot2c_f32_bf16 v161, v65, v164
    v_dot2c_f32_bf16 v163, v65, v65
    v_dot2c_f32_bf16 v160, v66, v164
    v_dot2c_f32_bf16 v162, v66, v66
    v_dot2c_f32_bf16 v161, v67, v164
    v_dot2c_f32_bf16 v163, v67, v67
    v_dot2c_f32_bf16 v160, v68, v164
    v_dot2c_f32_bf16 v162, v68, v68
    v_dot2c_f32_bf16 v161, v69, v164
    v_dot2c_f32_bf16 v163, v69, v69
    v_dot2c_f32_bf16 v160, v70, v164
    v_dot2c_f32_bf16 v162, v70, v70
    v_dot2c_f32_bf16 v161, v71, v164
    v_dot2c_f32_bf16 v163, v71, v71
    v_dot2c_f32_bf16 v160, v72, v164
    v_dot2c_f32_bf16 v162, v72, v72
    v_dot2c_f32_bf16 v161, v73, v164
    v_dot2c_f32_bf16 v163, v73, v73
    v_dot2c_f32_bf16 v160, v74, v164
    v_dot2c_f32_bf16 v162, v74, v74
    v_dot2c_f32_bf16 v161, v75, v164
    v_dot2c_f32_bf16 v163, v75, v75
    v_dot2c_f32_bf16 v160, v76, v164
    v_dot2c_f32_bf16 v162, v76, v76
    v_dot2c_f32_bf16 v161, v77, v164
    v_dot2c_f32_bf16 v163, v77, v77
    v_dot2c_f32_bf16 v160, v78, v164
    v_dot2c_f32_bf16 v162, v78, v78
    v_dot2c_f32_bf16 v161, v79, v164
    v_dot2c_f32_bf16 v163, v79, v79
    s_branch k1_kernel_xrd
k1_kernel_xr3:
    s_waitcnt vmcnt(32)
    ds_read_b128 v[128:131], v168 offset:28672
    ds_read_b128 v[132:135], v169 offset:28672
    ds_read_b128 v[136:139], v170 offset:28672
    ds_read_b128 v[140:143], v171 offset:28672
    s_waitcnt vmcnt(28)
    ds_read_b128 v[144:147], v168 offset:32768
    ds_read_b128 v[148:151], v169 offset:32768
    ds_read_b128 v[152:155], v170 offset:32768
    ds_read_b128 v[156:159], v171 offset:32768
    s_waitcnt lgkmcnt(4)
    v_dot2c_f32_bf16 v160, v128, v164
    v_dot2c_f32_bf16 v162, v128, v128
    v_dot2c_f32_bf16 v161, v129, v164
    v_dot2c_f32_bf16 v163, v129, v129
    v_dot2c_f32_bf16 v160, v130, v164
    v_dot2c_f32_bf16 v162, v130, v130
    v_dot2c_f32_bf16 v161, v131, v164
    v_dot2c_f32_bf16 v163, v131, v131
    v_dot2c_f32_bf16 v160, v132, v164
    v_dot2c_f32_bf16 v162, v132, v132
    v_dot2c_f32_bf16 v161, v133, v164
    v_dot2c_f32_bf16 v163, v133, v133
    v_dot2c_f32_bf16 v160, v134, v164
    v_dot2c_f32_bf16 v162, v134, v134
    v_dot2c_f32_bf16 v161, v135, v164
    v_dot2c_f32_bf16 v163, v135, v135
    v_dot2c_f32_bf16 v160, v136, v164
    v_dot2c_f32_bf16 v162, v136, v136
    v_dot2c_f32_bf16 v161, v137, v164
    v_dot2c_f32_bf16 v163, v137, v137
    v_dot2c_f32_bf16 v160, v138, v164
    v_dot2c_f32_bf16 v162, v138, v138
    v_dot2c_f32_bf16 v161, v139, v164
    v_dot2c_f32_bf16 v163, v139, v139
    v_dot2c_f32_bf16 v160, v140, v164
    v_dot2c_f32_bf16 v162, v140, v140
    v_dot2c_f32_bf16 v161, v141, v164
    v_dot2c_f32_bf16 v163, v141, v141
    v_dot2c_f32_bf16 v160, v142, v164
    v_dot2c_f32_bf16 v162, v142, v142
    v_dot2c_f32_bf16 v161, v143, v164
    v_dot2c_f32_bf16 v163, v143, v143
    s_waitcnt vmcnt(24)
    ds_read_b128 v[16:19], v168 offset:0
    ds_read_b128 v[20:23], v169 offset:0
    ds_read_b128 v[24:27], v170 offset:0
    ds_read_b128 v[28:31], v171 offset:0
    s_waitcnt lgkmcnt(4)
    v_dot2c_f32_bf16 v160, v144, v164
    v_dot2c_f32_bf16 v162, v144, v144
    v_dot2c_f32_bf16 v161, v145, v164
    v_dot2c_f32_bf16 v163, v145, v145
    v_dot2c_f32_bf16 v160, v146, v164
    v_dot2c_f32_bf16 v162, v146, v146
    v_dot2c_f32_bf16 v161, v147, v164
    v_dot2c_f32_bf16 v163, v147, v147
    v_dot2c_f32_bf16 v160, v148, v164
    v_dot2c_f32_bf16 v162, v148, v148
    v_dot2c_f32_bf16 v161, v149, v164
    v_dot2c_f32_bf16 v163, v149, v149
    v_dot2c_f32_bf16 v160, v150, v164
    v_dot2c_f32_bf16 v162, v150, v150
    v_dot2c_f32_bf16 v161, v151, v164
    v_dot2c_f32_bf16 v163, v151, v151
    v_dot2c_f32_bf16 v160, v152, v164
    v_dot2c_f32_bf16 v162, v152, v152
    v_dot2c_f32_bf16 v161, v153, v164
    v_dot2c_f32_bf16 v163, v153, v153
    v_dot2c_f32_bf16 v160, v154, v164
    v_dot2c_f32_bf16 v162, v154, v154
    v_dot2c_f32_bf16 v161, v155, v164
    v_dot2c_f32_bf16 v163, v155, v155
    v_dot2c_f32_bf16 v160, v156, v164
    v_dot2c_f32_bf16 v162, v156, v156
    v_dot2c_f32_bf16 v161, v157, v164
    v_dot2c_f32_bf16 v163, v157, v157
    v_dot2c_f32_bf16 v160, v158, v164
    v_dot2c_f32_bf16 v162, v158, v158
    v_dot2c_f32_bf16 v161, v159, v164
    v_dot2c_f32_bf16 v163, v159, v159
    s_waitcnt vmcnt(20)
    ds_read_b128 v[32:35], v168 offset:4096
    ds_read_b128 v[36:39], v169 offset:4096
    ds_read_b128 v[40:43], v170 offset:4096
    ds_read_b128 v[44:47], v171 offset:4096
    s_waitcnt lgkmcnt(4)
    v_dot2c_f32_bf16 v160, v16, v164
    v_dot2c_f32_bf16 v162, v16, v16
    v_dot2c_f32_bf16 v161, v17, v164
    v_dot2c_f32_bf16 v163, v17, v17
    v_dot2c_f32_bf16 v160, v18, v164
    v_dot2c_f32_bf16 v162, v18, v18
    v_dot2c_f32_bf16 v161, v19, v164
    v_dot2c_f32_bf16 v163, v19, v19
    v_dot2c_f32_bf16 v160, v20, v164
    v_dot2c_f32_bf16 v162, v20, v20
    v_dot2c_f32_bf16 v161, v21, v164
    v_dot2c_f32_bf16 v163, v21, v21
    v_dot2c_f32_bf16 v160, v22, v164
    v_dot2c_f32_bf16 v162, v22, v22
    v_dot2c_f32_bf16 v161, v23, v164
    v_dot2c_f32_bf16 v163, v23, v23
    v_dot2c_f32_bf16 v160, v24, v164
    v_dot2c_f32_bf16 v162, v24, v24
    v_dot2c_f32_bf16 v161, v25, v164
    v_dot2c_f32_bf16 v163, v25, v25
    v_dot2c_f32_bf16 v160, v26, v164
    v_dot2c_f32_bf16 v162, v26, v26
    v_dot2c_f32_bf16 v161, v27, v164
    v_dot2c_f32_bf16 v163, v27, v27
    v_dot2c_f32_bf16 v160, v28, v164
    v_dot2c_f32_bf16 v162, v28, v28
    v_dot2c_f32_bf16 v161, v29, v164
    v_dot2c_f32_bf16 v163, v29, v29
    v_dot2c_f32_bf16 v160, v30, v164
    v_dot2c_f32_bf16 v162, v30, v30
    v_dot2c_f32_bf16 v161, v31, v164
    v_dot2c_f32_bf16 v163, v31, v31
    s_waitcnt vmcnt(16)
    ds_read_b128 v[48:51], v168 offset:8192
    ds_read_b128 v[52:55], v169 offset:8192
    ds_read_b128 v[56:59], v170 offset:8192
    ds_read_b128 v[60:63], v171 offset:8192
    s_waitcnt lgkmcnt(4)
    v_dot2c_f32_bf16 v160, v32, v164
    v_dot2c_f32_bf16 v162, v32, v32
    v_dot2c_f32_bf16 v161, v33, v164
    v_dot2c_f32_bf16 v163, v33, v33
    v_dot2c_f32_bf16 v160, v34, v164
    v_dot2c_f32_bf16 v162, v34, v34
    v_dot2c_f32_bf16 v161, v35, v164
    v_dot2c_f32_bf16 v163, v35, v35
    v_dot2c_f32_bf16 v160, v36, v164
    v_dot2c_f32_bf16 v162, v36, v36
    v_dot2c_f32_bf16 v161, v37, v164
    v_dot2c_f32_bf16 v163, v37, v37
    v_dot2c_f32_bf16 v160, v38, v164
    v_dot2c_f32_bf16 v162, v38, v38
    v_dot2c_f32_bf16 v161, v39, v164
    v_dot2c_f32_bf16 v163, v39, v39
    v_dot2c_f32_bf16 v160, v40, v164
    v_dot2c_f32_bf16 v162, v40, v40
    v_dot2c_f32_bf16 v161, v41, v164
    v_dot2c_f32_bf16 v163, v41, v41
    v_dot2c_f32_bf16 v160, v42, v164
    v_dot2c_f32_bf16 v162, v42, v42
    v_dot2c_f32_bf16 v161, v43, v164
    v_dot2c_f32_bf16 v163, v43, v43
    v_dot2c_f32_bf16 v160, v44, v164
    v_dot2c_f32_bf16 v162, v44, v44
    v_dot2c_f32_bf16 v161, v45, v164
    v_dot2c_f32_bf16 v163, v45, v45
    v_dot2c_f32_bf16 v160, v46, v164
    v_dot2c_f32_bf16 v162, v46, v46
    v_dot2c_f32_bf16 v161, v47, v164
    v_dot2c_f32_bf16 v163, v47, v47
    s_waitcnt vmcnt(12)
    ds_read_b128 v[64:67], v168 offset:12288
    ds_read_b128 v[68:71], v169 offset:12288
    ds_read_b128 v[72:75], v170 offset:12288
    ds_read_b128 v[76:79], v171 offset:12288
    s_waitcnt lgkmcnt(4)
    v_dot2c_f32_bf16 v160, v48, v164
    v_dot2c_f32_bf16 v162, v48, v48
    v_dot2c_f32_bf16 v161, v49, v164
    v_dot2c_f32_bf16 v163, v49, v49
    v_dot2c_f32_bf16 v160, v50, v164
    v_dot2c_f32_bf16 v162, v50, v50
    v_dot2c_f32_bf16 v161, v51, v164
    v_dot2c_f32_bf16 v163, v51, v51
    v_dot2c_f32_bf16 v160, v52, v164
    v_dot2c_f32_bf16 v162, v52, v52
    v_dot2c_f32_bf16 v161, v53, v164
    v_dot2c_f32_bf16 v163, v53, v53
    v_dot2c_f32_bf16 v160, v54, v164
    v_dot2c_f32_bf16 v162, v54, v54
    v_dot2c_f32_bf16 v161, v55, v164
    v_dot2c_f32_bf16 v163, v55, v55
    v_dot2c_f32_bf16 v160, v56, v164
    v_dot2c_f32_bf16 v162, v56, v56
    v_dot2c_f32_bf16 v161, v57, v164
    v_dot2c_f32_bf16 v163, v57, v57
    v_dot2c_f32_bf16 v160, v58, v164
    v_dot2c_f32_bf16 v162, v58, v58
    v_dot2c_f32_bf16 v161, v59, v164
    v_dot2c_f32_bf16 v163, v59, v59
    v_dot2c_f32_bf16 v160, v60, v164
    v_dot2c_f32_bf16 v162, v60, v60
    v_dot2c_f32_bf16 v161, v61, v164
    v_dot2c_f32_bf16 v163, v61, v61
    v_dot2c_f32_bf16 v160, v62, v164
    v_dot2c_f32_bf16 v162, v62, v62
    v_dot2c_f32_bf16 v161, v63, v164
    v_dot2c_f32_bf16 v163, v63, v63
    s_waitcnt vmcnt(8)
    ds_read_b128 v[80:83], v168 offset:16384
    ds_read_b128 v[84:87], v169 offset:16384
    ds_read_b128 v[88:91], v170 offset:16384
    ds_read_b128 v[92:95], v171 offset:16384
    s_waitcnt lgkmcnt(4)
    v_dot2c_f32_bf16 v160, v64, v164
    v_dot2c_f32_bf16 v162, v64, v64
    v_dot2c_f32_bf16 v161, v65, v164
    v_dot2c_f32_bf16 v163, v65, v65
    v_dot2c_f32_bf16 v160, v66, v164
    v_dot2c_f32_bf16 v162, v66, v66
    v_dot2c_f32_bf16 v161, v67, v164
    v_dot2c_f32_bf16 v163, v67, v67
    v_dot2c_f32_bf16 v160, v68, v164
    v_dot2c_f32_bf16 v162, v68, v68
    v_dot2c_f32_bf16 v161, v69, v164
    v_dot2c_f32_bf16 v163, v69, v69
    v_dot2c_f32_bf16 v160, v70, v164
    v_dot2c_f32_bf16 v162, v70, v70
    v_dot2c_f32_bf16 v161, v71, v164
    v_dot2c_f32_bf16 v163, v71, v71
    v_dot2c_f32_bf16 v160, v72, v164
    v_dot2c_f32_bf16 v162, v72, v72
    v_dot2c_f32_bf16 v161, v73, v164
    v_dot2c_f32_bf16 v163, v73, v73
    v_dot2c_f32_bf16 v160, v74, v164
    v_dot2c_f32_bf16 v162, v74, v74
    v_dot2c_f32_bf16 v161, v75, v164
    v_dot2c_f32_bf16 v163, v75, v75
    v_dot2c_f32_bf16 v160, v76, v164
    v_dot2c_f32_bf16 v162, v76, v76
    v_dot2c_f32_bf16 v161, v77, v164
    v_dot2c_f32_bf16 v163, v77, v77
    v_dot2c_f32_bf16 v160, v78, v164
    v_dot2c_f32_bf16 v162, v78, v78
    v_dot2c_f32_bf16 v161, v79, v164
    v_dot2c_f32_bf16 v163, v79, v79
    s_waitcnt vmcnt(4)
    ds_read_b128 v[96:99], v168 offset:20480
    ds_read_b128 v[100:103], v169 offset:20480
    ds_read_b128 v[104:107], v170 offset:20480
    ds_read_b128 v[108:111], v171 offset:20480
    s_waitcnt lgkmcnt(4)
    v_dot2c_f32_bf16 v160, v80, v164
    v_dot2c_f32_bf16 v162, v80, v80
    v_dot2c_f32_bf16 v161, v81, v164
    v_dot2c_f32_bf16 v163, v81, v81
    v_dot2c_f32_bf16 v160, v82, v164
    v_dot2c_f32_bf16 v162, v82, v82
    v_dot2c_f32_bf16 v161, v83, v164
    v_dot2c_f32_bf16 v163, v83, v83
    v_dot2c_f32_bf16 v160, v84, v164
    v_dot2c_f32_bf16 v162, v84, v84
    v_dot2c_f32_bf16 v161, v85, v164
    v_dot2c_f32_bf16 v163, v85, v85
    v_dot2c_f32_bf16 v160, v86, v164
    v_dot2c_f32_bf16 v162, v86, v86
    v_dot2c_f32_bf16 v161, v87, v164
    v_dot2c_f32_bf16 v163, v87, v87
    v_dot2c_f32_bf16 v160, v88, v164
    v_dot2c_f32_bf16 v162, v88, v88
    v_dot2c_f32_bf16 v161, v89, v164
    v_dot2c_f32_bf16 v163, v89, v89
    v_dot2c_f32_bf16 v160, v90, v164
    v_dot2c_f32_bf16 v162, v90, v90
    v_dot2c_f32_bf16 v161, v91, v164
    v_dot2c_f32_bf16 v163, v91, v91
    v_dot2c_f32_bf16 v160, v92, v164
    v_dot2c_f32_bf16 v162, v92, v92
    v_dot2c_f32_bf16 v161, v93, v164
    v_dot2c_f32_bf16 v163, v93, v93
    v_dot2c_f32_bf16 v160, v94, v164
    v_dot2c_f32_bf16 v162, v94, v94
    v_dot2c_f32_bf16 v161, v95, v164
    v_dot2c_f32_bf16 v163, v95, v95
    s_waitcnt vmcnt(0)
    ds_read_b128 v[112:115], v168 offset:24576
    ds_read_b128 v[116:119], v169 offset:24576
    ds_read_b128 v[120:123], v170 offset:24576
    ds_read_b128 v[124:127], v171 offset:24576
    s_waitcnt lgkmcnt(4)
    v_dot2c_f32_bf16 v160, v96, v164
    v_dot2c_f32_bf16 v162, v96, v96
    v_dot2c_f32_bf16 v161, v97, v164
    v_dot2c_f32_bf16 v163, v97, v97
    v_dot2c_f32_bf16 v160, v98, v164
    v_dot2c_f32_bf16 v162, v98, v98
    v_dot2c_f32_bf16 v161, v99, v164
    v_dot2c_f32_bf16 v163, v99, v99
    v_dot2c_f32_bf16 v160, v100, v164
    v_dot2c_f32_bf16 v162, v100, v100
    v_dot2c_f32_bf16 v161, v101, v164
    v_dot2c_f32_bf16 v163, v101, v101
    v_dot2c_f32_bf16 v160, v102, v164
    v_dot2c_f32_bf16 v162, v102, v102
    v_dot2c_f32_bf16 v161, v103, v164
    v_dot2c_f32_bf16 v163, v103, v103
    v_dot2c_f32_bf16 v160, v104, v164
    v_dot2c_f32_bf16 v162, v104, v104
    v_dot2c_f32_bf16 v161, v105, v164
    v_dot2c_f32_bf16 v163, v105, v105
    v_dot2c_f32_bf16 v160, v106, v164
    v_dot2c_f32_bf16 v162, v106, v106
    v_dot2c_f32_bf16 v161, v107, v164
    v_dot2c_f32_bf16 v163, v107, v107
    v_dot2c_f32_bf16 v160, v108, v164
    v_dot2c_f32_bf16 v162, v108, v108
    v_dot2c_f32_bf16 v161, v109, v164
    v_dot2c_f32_bf16 v163, v109, v109
    v_dot2c_f32_bf16 v160, v110, v164
    v_dot2c_f32_bf16 v162, v110, v110
    v_dot2c_f32_bf16 v161, v111, v164
    v_dot2c_f32_bf16 v163, v111, v111
    s_waitcnt lgkmcnt(0)
    s_barrier
    v_dot2c_f32_bf16 v160, v112, v164
    v_dot2c_f32_bf16 v162, v112, v112
    v_dot2c_f32_bf16 v161, v113, v164
    v_dot2c_f32_bf16 v163, v113, v113
    v_dot2c_f32_bf16 v160, v114, v164
    v_dot2c_f32_bf16 v162, v114, v114
    v_dot2c_f32_bf16 v161, v115, v164
    v_dot2c_f32_bf16 v163, v115, v115
    v_dot2c_f32_bf16 v160, v116, v164
    v_dot2c_f32_bf16 v162, v116, v116
    v_dot2c_f32_bf16 v161, v117, v164
    v_dot2c_f32_bf16 v163, v117, v117
    v_dot2c_f32_bf16 v160, v118, v164
    v_dot2c_f32_bf16 v162, v118, v118
    v_dot2c_f32_bf16 v161, v119, v164
    v_dot2c_f32_bf16 v163, v119, v119
    v_dot2c_f32_bf16 v160, v120, v164
    v_dot2c_f32_bf16 v162, v120, v120
    v_dot2c_f32_bf16 v161, v121, v164
    v_dot2c_f32_bf16 v163, v121, v121
    v_dot2c_f32_bf16 v160, v122, v164
    v_dot2c_f32_bf16 v162, v122, v122
    v_dot2c_f32_bf16 v161, v123, v164
    v_dot2c_f32_bf16 v163, v123, v123
    v_dot2c_f32_bf16 v160, v124, v164
    v_dot2c_f32_bf16 v162, v124, v124
    v_dot2c_f32_bf16 v161, v125, v164
    v_dot2c_f32_bf16 v163, v125, v125
    v_dot2c_f32_bf16 v160, v126, v164
    v_dot2c_f32_bf16 v162, v126, v126
    v_dot2c_f32_bf16 v161, v127, v164
    v_dot2c_f32_bf16 v163, v127, v127
k1_kernel_xrd:
    s_nop 2
    v_add_f32 v160, v160, v161
    v_add_f32 v162, v162, v163
    s_nop 0
    v_mov_b32 v161, v160
    v_mov_b32 v163, v162
    s_nop 1
    v_permlane32_swap_b32 v160, v161
    v_permlane32_swap_b32 v162, v163
    s_nop 1
    v_add_f32 v160, v160, v161
    v_add_f32 v162, v162, v163
    v_mul_f32 v160, 0x3ae38e39, v160
    v_mul_f32 v162, 0x3ae38e39, v162
    v_fma_f32 v162, -v160, v160, v162
    v_max_f32 v162, 0, v162
    v_add_f32 v162, 0x3727c5ac, v162
    v_rsq_f32 v162, v162
    s_nop 0
    v_mul_f32 v252, 0x3fb8aa3b, v162
    v_mov_b32 v253, v252
    v_mul_f32 v254, v160, v252
    v_sub_f32 v254, 0, v254
    v_mov_b32 v255, v254
    v_lshlrev_b32 v248, 16, v16
    v_and_b32 v249, 0xffff0000, v16
    v_lshlrev_b32 v250, 16, v17
    v_and_b32 v251, 0xffff0000, v17
    v_pk_fma_f32 v[248:249], v[248:249], v[252:253], v[254:255]
    v_pk_fma_f32 v[250:251], v[250:251], v[252:253], v[254:255]
    v_cvt_pk_bf16_f32 v16, v248, v249
    v_cvt_pk_bf16_f32 v17, v250, v251
    v_lshlrev_b32 v248, 16, v18
    v_and_b32 v249, 0xffff0000, v18
    v_lshlrev_b32 v250, 16, v19
    v_and_b32 v251, 0xffff0000, v19
    v_pk_fma_f32 v[248:249], v[248:249], v[252:253], v[254:255]
    v_pk_fma_f32 v[250:251], v[250:251], v[252:253], v[254:255]
    v_cvt_pk_bf16_f32 v18, v248, v249
    v_cvt_pk_bf16_f32 v19, v250, v251
    v_lshlrev_b32 v248, 16, v20
    v_and_b32 v249, 0xffff0000, v20
    v_lshlrev_b32 v250, 16, v21
    v_and_b32 v251, 0xffff0000, v21
    v_pk_fma_f32 v[248:249], v[248:249], v[252:253], v[254:255]
    v_pk_fma_f32 v[250:251], v[250:251], v[252:253], v[254:255]
    v_cvt_pk_bf16_f32 v20, v248, v249
    v_cvt_pk_bf16_f32 v21, v250, v251
    v_lshlrev_b32 v248, 16, v22
    v_and_b32 v249, 0xffff0000, v22
    v_lshlrev_b32 v250, 16, v23
    v_and_b32 v251, 0xffff0000, v23
    v_pk_fma_f32 v[248:249], v[248:249], v[252:253], v[254:255]
    v_pk_fma_f32 v[250:251], v[250:251], v[252:253], v[254:255]
    v_cvt_pk_bf16_f32 v22, v248, v249
    v_cvt_pk_bf16_f32 v23, v250, v251
    v_lshlrev_b32 v248, 16, v24
    v_and_b32 v249, 0xffff0000, v24
    v_lshlrev_b32 v250, 16, v25
    v_and_b32 v251, 0xffff0000, v25
    v_pk_fma_f32 v[248:249], v[248:249], v[252:253], v[254:255]
    v_pk_fma_f32 v[250:251], v[250:251], v[252:253], v[254:255]
    v_cvt_pk_bf16_f32 v24, v248, v249
    v_cvt_pk_bf16_f32 v25, v250, v251
    v_lshlrev_b32 v248, 16, v26
    v_and_b32 v249, 0xffff0000, v26
    v_lshlrev_b32 v250, 16, v27
    v_and_b32 v251, 0xffff0000, v27
    v_pk_fma_f32 v[248:249], v[248:249], v[252:253], v[254:255]
    v_pk_fma_f32 v[250:251], v[250:251], v[252:253], v[254:255]
    v_cvt_pk_bf16_f32 v26, v248, v249
    v_cvt_pk_bf16_f32 v27, v250, v251
    v_lshlrev_b32 v248, 16, v28
    v_and_b32 v249, 0xffff0000, v28
    v_lshlrev_b32 v250, 16, v29
    v_and_b32 v251, 0xffff0000, v29
    v_pk_fma_f32 v[248:249], v[248:249], v[252:253], v[254:255]
    v_pk_fma_f32 v[250:251], v[250:251], v[252:253], v[254:255]
    v_cvt_pk_bf16_f32 v28, v248, v249
    v_cvt_pk_bf16_f32 v29, v250, v251
    v_lshlrev_b32 v248, 16, v30
    v_and_b32 v249, 0xffff0000, v30
    v_lshlrev_b32 v250, 16, v31
    v_and_b32 v251, 0xffff0000, v31
    v_pk_fma_f32 v[248:249], v[248:249], v[252:253], v[254:255]
    v_pk_fma_f32 v[250:251], v[250:251], v[252:253], v[254:255]
    v_cvt_pk_bf16_f32 v30, v248, v249
    v_cvt_pk_bf16_f32 v31, v250, v251
    v_lshlrev_b32 v248, 16, v32
    v_and_b32 v249, 0xffff0000, v32
    v_lshlrev_b32 v250, 16, v33
    v_and_b32 v251, 0xffff0000, v33
    v_pk_fma_f32 v[248:249], v[248:249], v[252:253], v[254:255]
    v_pk_fma_f32 v[250:251], v[250:251], v[252:253], v[254:255]
    v_cvt_pk_bf16_f32 v32, v248, v249
    v_cvt_pk_bf16_f32 v33, v250, v251
    v_lshlrev_b32 v248, 16, v34
    v_and_b32 v249, 0xffff0000, v34
    v_lshlrev_b32 v250, 16, v35
    v_and_b32 v251, 0xffff0000, v35
    v_pk_fma_f32 v[248:249], v[248:249], v[252:253], v[254:255]
    v_pk_fma_f32 v[250:251], v[250:251], v[252:253], v[254:255]
    v_cvt_pk_bf16_f32 v34, v248, v249
    v_cvt_pk_bf16_f32 v35, v250, v251
    v_lshlrev_b32 v248, 16, v36
    v_and_b32 v249, 0xffff0000, v36
    v_lshlrev_b32 v250, 16, v37
    v_and_b32 v251, 0xffff0000, v37
    v_pk_fma_f32 v[248:249], v[248:249], v[252:253], v[254:255]
    v_pk_fma_f32 v[250:251], v[250:251], v[252:253], v[254:255]
    v_cvt_pk_bf16_f32 v36, v248, v249
    v_cvt_pk_bf16_f32 v37, v250, v251
    v_lshlrev_b32 v248, 16, v38
    v_and_b32 v249, 0xffff0000, v38
    v_lshlrev_b32 v250, 16, v39
    v_and_b32 v251, 0xffff0000, v39
    v_pk_fma_f32 v[248:249], v[248:249], v[252:253], v[254:255]
    v_pk_fma_f32 v[250:251], v[250:251], v[252:253], v[254:255]
    v_cvt_pk_bf16_f32 v38, v248, v249
    v_cvt_pk_bf16_f32 v39, v250, v251
    v_lshlrev_b32 v248, 16, v40
    v_and_b32 v249, 0xffff0000, v40
    v_lshlrev_b32 v250, 16, v41
    v_and_b32 v251, 0xffff0000, v41
    v_pk_fma_f32 v[248:249], v[248:249], v[252:253], v[254:255]
    v_pk_fma_f32 v[250:251], v[250:251], v[252:253], v[254:255]
    v_cvt_pk_bf16_f32 v40, v248, v249
    v_cvt_pk_bf16_f32 v41, v250, v251
    v_lshlrev_b32 v248, 16, v42
    v_and_b32 v249, 0xffff0000, v42
    v_lshlrev_b32 v250, 16, v43
    v_and_b32 v251, 0xffff0000, v43
    v_pk_fma_f32 v[248:249], v[248:249], v[252:253], v[254:255]
    v_pk_fma_f32 v[250:251], v[250:251], v[252:253], v[254:255]
    v_cvt_pk_bf16_f32 v42, v248, v249
    v_cvt_pk_bf16_f32 v43, v250, v251
    v_lshlrev_b32 v248, 16, v44
    v_and_b32 v249, 0xffff0000, v44
    v_lshlrev_b32 v250, 16, v45
    v_and_b32 v251, 0xffff0000, v45
    v_pk_fma_f32 v[248:249], v[248:249], v[252:253], v[254:255]
    v_pk_fma_f32 v[250:251], v[250:251], v[252:253], v[254:255]
    v_cvt_pk_bf16_f32 v44, v248, v249
    v_cvt_pk_bf16_f32 v45, v250, v251
    v_lshlrev_b32 v248, 16, v46
    v_and_b32 v249, 0xffff0000, v46
    v_lshlrev_b32 v250, 16, v47
    v_and_b32 v251, 0xffff0000, v47
    v_pk_fma_f32 v[248:249], v[248:249], v[252:253], v[254:255]
    v_pk_fma_f32 v[250:251], v[250:251], v[252:253], v[254:255]
    v_cvt_pk_bf16_f32 v46, v248, v249
    v_cvt_pk_bf16_f32 v47, v250, v251
    v_lshlrev_b32 v248, 16, v48
    v_and_b32 v249, 0xffff0000, v48
    v_lshlrev_b32 v250, 16, v49
    v_and_b32 v251, 0xffff0000, v49
    v_pk_fma_f32 v[248:249], v[248:249], v[252:253], v[254:255]
    v_pk_fma_f32 v[250:251], v[250:251], v[252:253], v[254:255]
    v_cvt_pk_bf16_f32 v48, v248, v249
    v_cvt_pk_bf16_f32 v49, v250, v251
    v_lshlrev_b32 v248, 16, v50
    v_and_b32 v249, 0xffff0000, v50
    v_lshlrev_b32 v250, 16, v51
    v_and_b32 v251, 0xffff0000, v51
    v_pk_fma_f32 v[248:249], v[248:249], v[252:253], v[254:255]
    v_pk_fma_f32 v[250:251], v[250:251], v[252:253], v[254:255]
    v_cvt_pk_bf16_f32 v50, v248, v249
    v_cvt_pk_bf16_f32 v51, v250, v251
    v_lshlrev_b32 v248, 16, v52
    v_and_b32 v249, 0xffff0000, v52
    v_lshlrev_b32 v250, 16, v53
    v_and_b32 v251, 0xffff0000, v53
    v_pk_fma_f32 v[248:249], v[248:249], v[252:253], v[254:255]
    v_pk_fma_f32 v[250:251], v[250:251], v[252:253], v[254:255]
    v_cvt_pk_bf16_f32 v52, v248, v249
    v_cvt_pk_bf16_f32 v53, v250, v251
    v_lshlrev_b32 v248, 16, v54
    v_and_b32 v249, 0xffff0000, v54
    v_lshlrev_b32 v250, 16, v55
    v_and_b32 v251, 0xffff0000, v55
    v_pk_fma_f32 v[248:249], v[248:249], v[252:253], v[254:255]
    v_pk_fma_f32 v[250:251], v[250:251], v[252:253], v[254:255]
    v_cvt_pk_bf16_f32 v54, v248, v249
    v_cvt_pk_bf16_f32 v55, v250, v251
    v_lshlrev_b32 v248, 16, v56
    v_and_b32 v249, 0xffff0000, v56
    v_lshlrev_b32 v250, 16, v57
    v_and_b32 v251, 0xffff0000, v57
    v_pk_fma_f32 v[248:249], v[248:249], v[252:253], v[254:255]
    v_pk_fma_f32 v[250:251], v[250:251], v[252:253], v[254:255]
    v_cvt_pk_bf16_f32 v56, v248, v249
    v_cvt_pk_bf16_f32 v57, v250, v251
    v_lshlrev_b32 v248, 16, v58
    v_and_b32 v249, 0xffff0000, v58
    v_lshlrev_b32 v250, 16, v59
    v_and_b32 v251, 0xffff0000, v59
    v_pk_fma_f32 v[248:249], v[248:249], v[252:253], v[254:255]
    v_pk_fma_f32 v[250:251], v[250:251], v[252:253], v[254:255]
    v_cvt_pk_bf16_f32 v58, v248, v249
    v_cvt_pk_bf16_f32 v59, v250, v251
    v_lshlrev_b32 v248, 16, v60
    v_and_b32 v249, 0xffff0000, v60
    v_lshlrev_b32 v250, 16, v61
    v_and_b32 v251, 0xffff0000, v61
    v_pk_fma_f32 v[248:249], v[248:249], v[252:253], v[254:255]
    v_pk_fma_f32 v[250:251], v[250:251], v[252:253], v[254:255]
    v_cvt_pk_bf16_f32 v60, v248, v249
    v_cvt_pk_bf16_f32 v61, v250, v251
    v_lshlrev_b32 v248, 16, v62
    v_and_b32 v249, 0xffff0000, v62
    v_lshlrev_b32 v250, 16, v63
    v_and_b32 v251, 0xffff0000, v63
    v_pk_fma_f32 v[248:249], v[248:249], v[252:253], v[254:255]
    v_pk_fma_f32 v[250:251], v[250:251], v[252:253], v[254:255]
    v_cvt_pk_bf16_f32 v62, v248, v249
    v_cvt_pk_bf16_f32 v63, v250, v251
    v_lshlrev_b32 v248, 16, v64
    v_and_b32 v249, 0xffff0000, v64
    v_lshlrev_b32 v250, 16, v65
    v_and_b32 v251, 0xffff0000, v65
    v_pk_fma_f32 v[248:249], v[248:249], v[252:253], v[254:255]
    v_pk_fma_f32 v[250:251], v[250:251], v[252:253], v[254:255]
    v_cvt_pk_bf16_f32 v64, v248, v249
    v_cvt_pk_bf16_f32 v65, v250, v251
    v_lshlrev_b32 v248, 16, v66
    v_and_b32 v249, 0xffff0000, v66
    v_lshlrev_b32 v250, 16, v67
    v_and_b32 v251, 0xffff0000, v67
    v_pk_fma_f32 v[248:249], v[248:249], v[252:253], v[254:255]
    v_pk_fma_f32 v[250:251], v[250:251], v[252:253], v[254:255]
    v_cvt_pk_bf16_f32 v66, v248, v249
    v_cvt_pk_bf16_f32 v67, v250, v251
    v_lshlrev_b32 v248, 16, v68
    v_and_b32 v249, 0xffff0000, v68
    v_lshlrev_b32 v250, 16, v69
    v_and_b32 v251, 0xffff0000, v69
    v_pk_fma_f32 v[248:249], v[248:249], v[252:253], v[254:255]
    v_pk_fma_f32 v[250:251], v[250:251], v[252:253], v[254:255]
    v_cvt_pk_bf16_f32 v68, v248, v249
    v_cvt_pk_bf16_f32 v69, v250, v251
    v_lshlrev_b32 v248, 16, v70
    v_and_b32 v249, 0xffff0000, v70
    v_lshlrev_b32 v250, 16, v71
    v_and_b32 v251, 0xffff0000, v71
    v_pk_fma_f32 v[248:249], v[248:249], v[252:253], v[254:255]
    v_pk_fma_f32 v[250:251], v[250:251], v[252:253], v[254:255]
    v_cvt_pk_bf16_f32 v70, v248, v249
    v_cvt_pk_bf16_f32 v71, v250, v251
    v_lshlrev_b32 v248, 16, v72
    v_and_b32 v249, 0xffff0000, v72
    v_lshlrev_b32 v250, 16, v73
    v_and_b32 v251, 0xffff0000, v73
    v_pk_fma_f32 v[248:249], v[248:249], v[252:253], v[254:255]
    v_pk_fma_f32 v[250:251], v[250:251], v[252:253], v[254:255]
    v_cvt_pk_bf16_f32 v72, v248, v249
    v_cvt_pk_bf16_f32 v73, v250, v251
    v_lshlrev_b32 v248, 16, v74
    v_and_b32 v249, 0xffff0000, v74
    v_lshlrev_b32 v250, 16, v75
    v_and_b32 v251, 0xffff0000, v75
    v_pk_fma_f32 v[248:249], v[248:249], v[252:253], v[254:255]
    v_pk_fma_f32 v[250:251], v[250:251], v[252:253], v[254:255]
    v_cvt_pk_bf16_f32 v74, v248, v249
    v_cvt_pk_bf16_f32 v75, v250, v251
    v_lshlrev_b32 v248, 16, v76
    v_and_b32 v249, 0xffff0000, v76
    v_lshlrev_b32 v250, 16, v77
    v_and_b32 v251, 0xffff0000, v77
    v_pk_fma_f32 v[248:249], v[248:249], v[252:253], v[254:255]
    v_pk_fma_f32 v[250:251], v[250:251], v[252:253], v[254:255]
    v_cvt_pk_bf16_f32 v76, v248, v249
    v_cvt_pk_bf16_f32 v77, v250, v251
    v_lshlrev_b32 v248, 16, v78
    v_and_b32 v249, 0xffff0000, v78
    v_lshlrev_b32 v250, 16, v79
    v_and_b32 v251, 0xffff0000, v79
    v_pk_fma_f32 v[248:249], v[248:249], v[252:253], v[254:255]
    v_pk_fma_f32 v[250:251], v[250:251], v[252:253], v[254:255]
    v_cvt_pk_bf16_f32 v78, v248, v249
    v_cvt_pk_bf16_f32 v79, v250, v251
    v_lshlrev_b32 v248, 16, v80
    v_and_b32 v249, 0xffff0000, v80
    v_lshlrev_b32 v250, 16, v81
    v_and_b32 v251, 0xffff0000, v81
    v_pk_fma_f32 v[248:249], v[248:249], v[252:253], v[254:255]
    v_pk_fma_f32 v[250:251], v[250:251], v[252:253], v[254:255]
    v_cvt_pk_bf16_f32 v80, v248, v249
    v_cvt_pk_bf16_f32 v81, v250, v251
    v_lshlrev_b32 v248, 16, v82
    v_and_b32 v249, 0xffff0000, v82
    v_lshlrev_b32 v250, 16, v83
    v_and_b32 v251, 0xffff0000, v83
    v_pk_fma_f32 v[248:249], v[248:249], v[252:253], v[254:255]
    v_pk_fma_f32 v[250:251], v[250:251], v[252:253], v[254:255]
    v_cvt_pk_bf16_f32 v82, v248, v249
    v_cvt_pk_bf16_f32 v83, v250, v251
    v_lshlrev_b32 v248, 16, v84
    v_and_b32 v249, 0xffff0000, v84
    v_lshlrev_b32 v250, 16, v85
    v_and_b32 v251, 0xffff0000, v85
    v_pk_fma_f32 v[248:249], v[248:249], v[252:253], v[254:255]
    v_pk_fma_f32 v[250:251], v[250:251], v[252:253], v[254:255]
    v_cvt_pk_bf16_f32 v84, v248, v249
    v_cvt_pk_bf16_f32 v85, v250, v251
    v_lshlrev_b32 v248, 16, v86
    v_and_b32 v249, 0xffff0000, v86
    v_lshlrev_b32 v250, 16, v87
    v_and_b32 v251, 0xffff0000, v87
    v_pk_fma_f32 v[248:249], v[248:249], v[252:253], v[254:255]
    v_pk_fma_f32 v[250:251], v[250:251], v[252:253], v[254:255]
    v_cvt_pk_bf16_f32 v86, v248, v249
    v_cvt_pk_bf16_f32 v87, v250, v251
    v_lshlrev_b32 v248, 16, v88
    v_and_b32 v249, 0xffff0000, v88
    v_lshlrev_b32 v250, 16, v89
    v_and_b32 v251, 0xffff0000, v89
    v_pk_fma_f32 v[248:249], v[248:249], v[252:253], v[254:255]
    v_pk_fma_f32 v[250:251], v[250:251], v[252:253], v[254:255]
    v_cvt_pk_bf16_f32 v88, v248, v249
    v_cvt_pk_bf16_f32 v89, v250, v251
    v_lshlrev_b32 v248, 16, v90
    v_and_b32 v249, 0xffff0000, v90
    v_lshlrev_b32 v250, 16, v91
    v_and_b32 v251, 0xffff0000, v91
    v_pk_fma_f32 v[248:249], v[248:249], v[252:253], v[254:255]
    v_pk_fma_f32 v[250:251], v[250:251], v[252:253], v[254:255]
    v_cvt_pk_bf16_f32 v90, v248, v249
    v_cvt_pk_bf16_f32 v91, v250, v251
    v_lshlrev_b32 v248, 16, v92
    v_and_b32 v249, 0xffff0000, v92
    v_lshlrev_b32 v250, 16, v93
    v_and_b32 v251, 0xffff0000, v93
    v_pk_fma_f32 v[248:249], v[248:249], v[252:253], v[254:255]
    v_pk_fma_f32 v[250:251], v[250:251], v[252:253], v[254:255]
    v_cvt_pk_bf16_f32 v92, v248, v249
    v_cvt_pk_bf16_f32 v93, v250, v251
    v_lshlrev_b32 v248, 16, v94
    v_and_b32 v249, 0xffff0000, v94
    v_lshlrev_b32 v250, 16, v95
    v_and_b32 v251, 0xffff0000, v95
    v_pk_fma_f32 v[248:249], v[248:249], v[252:253], v[254:255]
    v_pk_fma_f32 v[250:251], v[250:251], v[252:253], v[254:255]
    v_cvt_pk_bf16_f32 v94, v248, v249
    v_cvt_pk_bf16_f32 v95, v250, v251
    v_lshlrev_b32 v248, 16, v96
    v_and_b32 v249, 0xffff0000, v96
    v_lshlrev_b32 v250, 16, v97
    v_and_b32 v251, 0xffff0000, v97
    v_pk_fma_f32 v[248:249], v[248:249], v[252:253], v[254:255]
    v_pk_fma_f32 v[250:251], v[250:251], v[252:253], v[254:255]
    v_cvt_pk_bf16_f32 v96, v248, v249
    v_cvt_pk_bf16_f32 v97, v250, v251
    v_lshlrev_b32 v248, 16, v98
    v_and_b32 v249, 0xffff0000, v98
    v_lshlrev_b32 v250, 16, v99
    v_and_b32 v251, 0xffff0000, v99
    v_pk_fma_f32 v[248:249], v[248:249], v[252:253], v[254:255]
    v_pk_fma_f32 v[250:251], v[250:251], v[252:253], v[254:255]
    v_cvt_pk_bf16_f32 v98, v248, v249
    v_cvt_pk_bf16_f32 v99, v250, v251
    v_lshlrev_b32 v248, 16, v100
    v_and_b32 v249, 0xffff0000, v100
    v_lshlrev_b32 v250, 16, v101
    v_and_b32 v251, 0xffff0000, v101
    v_pk_fma_f32 v[248:249], v[248:249], v[252:253], v[254:255]
    v_pk_fma_f32 v[250:251], v[250:251], v[252:253], v[254:255]
    v_cvt_pk_bf16_f32 v100, v248, v249
    v_cvt_pk_bf16_f32 v101, v250, v251
    v_lshlrev_b32 v248, 16, v102
    v_and_b32 v249, 0xffff0000, v102
    v_lshlrev_b32 v250, 16, v103
    v_and_b32 v251, 0xffff0000, v103
    v_pk_fma_f32 v[248:249], v[248:249], v[252:253], v[254:255]
    v_pk_fma_f32 v[250:251], v[250:251], v[252:253], v[254:255]
    v_cvt_pk_bf16_f32 v102, v248, v249
    v_cvt_pk_bf16_f32 v103, v250, v251
    v_lshlrev_b32 v248, 16, v104
    v_and_b32 v249, 0xffff0000, v104
    v_lshlrev_b32 v250, 16, v105
    v_and_b32 v251, 0xffff0000, v105
    v_pk_fma_f32 v[248:249], v[248:249], v[252:253], v[254:255]
    v_pk_fma_f32 v[250:251], v[250:251], v[252:253], v[254:255]
    v_cvt_pk_bf16_f32 v104, v248, v249
    v_cvt_pk_bf16_f32 v105, v250, v251
    v_lshlrev_b32 v248, 16, v106
    v_and_b32 v249, 0xffff0000, v106
    v_lshlrev_b32 v250, 16, v107
    v_and_b32 v251, 0xffff0000, v107
    v_pk_fma_f32 v[248:249], v[248:249], v[252:253], v[254:255]
    v_pk_fma_f32 v[250:251], v[250:251], v[252:253], v[254:255]
    v_cvt_pk_bf16_f32 v106, v248, v249
    v_cvt_pk_bf16_f32 v107, v250, v251
    v_lshlrev_b32 v248, 16, v108
    v_and_b32 v249, 0xffff0000, v108
    v_lshlrev_b32 v250, 16, v109
    v_and_b32 v251, 0xffff0000, v109
    v_pk_fma_f32 v[248:249], v[248:249], v[252:253], v[254:255]
    v_pk_fma_f32 v[250:251], v[250:251], v[252:253], v[254:255]
    v_cvt_pk_bf16_f32 v108, v248, v249
    v_cvt_pk_bf16_f32 v109, v250, v251
    v_lshlrev_b32 v248, 16, v110
    v_and_b32 v249, 0xffff0000, v110
    v_lshlrev_b32 v250, 16, v111
    v_and_b32 v251, 0xffff0000, v111
    v_pk_fma_f32 v[248:249], v[248:249], v[252:253], v[254:255]
    v_pk_fma_f32 v[250:251], v[250:251], v[252:253], v[254:255]
    v_cvt_pk_bf16_f32 v110, v248, v249
    v_cvt_pk_bf16_f32 v111, v250, v251
    v_lshlrev_b32 v248, 16, v112
    v_and_b32 v249, 0xffff0000, v112
    v_lshlrev_b32 v250, 16, v113
    v_and_b32 v251, 0xffff0000, v113
    v_pk_fma_f32 v[248:249], v[248:249], v[252:253], v[254:255]
    v_pk_fma_f32 v[250:251], v[250:251], v[252:253], v[254:255]
    v_cvt_pk_bf16_f32 v112, v248, v249
    v_cvt_pk_bf16_f32 v113, v250, v251
    v_lshlrev_b32 v248, 16, v114
    v_and_b32 v249, 0xffff0000, v114
    v_lshlrev_b32 v250, 16, v115
    v_and_b32 v251, 0xffff0000, v115
    v_pk_fma_f32 v[248:249], v[248:249], v[252:253], v[254:255]
    v_pk_fma_f32 v[250:251], v[250:251], v[252:253], v[254:255]
    v_cvt_pk_bf16_f32 v114, v248, v249
    v_cvt_pk_bf16_f32 v115, v250, v251
    v_lshlrev_b32 v248, 16, v116
    v_and_b32 v249, 0xffff0000, v116
    v_lshlrev_b32 v250, 16, v117
    v_and_b32 v251, 0xffff0000, v117
    v_pk_fma_f32 v[248:249], v[248:249], v[252:253], v[254:255]
    v_pk_fma_f32 v[250:251], v[250:251], v[252:253], v[254:255]
    v_cvt_pk_bf16_f32 v116, v248, v249
    v_cvt_pk_bf16_f32 v117, v250, v251
    v_lshlrev_b32 v248, 16, v118
    v_and_b32 v249, 0xffff0000, v118
    v_lshlrev_b32 v250, 16, v119
    v_and_b32 v251, 0xffff0000, v119
    v_pk_fma_f32 v[248:249], v[248:249], v[252:253], v[254:255]
    v_pk_fma_f32 v[250:251], v[250:251], v[252:253], v[254:255]
    v_cvt_pk_bf16_f32 v118, v248, v249
    v_cvt_pk_bf16_f32 v119, v250, v251
    v_lshlrev_b32 v248, 16, v120
    v_and_b32 v249, 0xffff0000, v120
    v_lshlrev_b32 v250, 16, v121
    v_and_b32 v251, 0xffff0000, v121
    v_pk_fma_f32 v[248:249], v[248:249], v[252:253], v[254:255]
    v_pk_fma_f32 v[250:251], v[250:251], v[252:253], v[254:255]
    v_cvt_pk_bf16_f32 v120, v248, v249
    v_cvt_pk_bf16_f32 v121, v250, v251
    v_lshlrev_b32 v248, 16, v122
    v_and_b32 v249, 0xffff0000, v122
    v_lshlrev_b32 v250, 16, v123
    v_and_b32 v251, 0xffff0000, v123
    v_pk_fma_f32 v[248:249], v[248:249], v[252:253], v[254:255]
    v_pk_fma_f32 v[250:251], v[250:251], v[252:253], v[254:255]
    v_cvt_pk_bf16_f32 v122, v248, v249
    v_cvt_pk_bf16_f32 v123, v250, v251
    v_lshlrev_b32 v248, 16, v124
    v_and_b32 v249, 0xffff0000, v124
    v_lshlrev_b32 v250, 16, v125
    v_and_b32 v251, 0xffff0000, v125
    v_pk_fma_f32 v[248:249], v[248:249], v[252:253], v[254:255]
    v_pk_fma_f32 v[250:251], v[250:251], v[252:253], v[254:255]
    v_cvt_pk_bf16_f32 v124, v248, v249
    v_cvt_pk_bf16_f32 v125, v250, v251
    v_lshlrev_b32 v248, 16, v126
    v_and_b32 v249, 0xffff0000, v126
    v_lshlrev_b32 v250, 16, v127
    v_and_b32 v251, 0xffff0000, v127
    v_pk_fma_f32 v[248:249], v[248:249], v[252:253], v[254:255]
    v_pk_fma_f32 v[250:251], v[250:251], v[252:253], v[254:255]
    v_cvt_pk_bf16_f32 v126, v248, v249
    v_cvt_pk_bf16_f32 v127, v250, v251
    v_lshlrev_b32 v248, 16, v128
    v_and_b32 v249, 0xffff0000, v128
    v_lshlrev_b32 v250, 16, v129
    v_and_b32 v251, 0xffff0000, v129
    v_pk_fma_f32 v[248:249], v[248:249], v[252:253], v[254:255]
    v_pk_fma_f32 v[250:251], v[250:251], v[252:253], v[254:255]
    v_cvt_pk_bf16_f32 v128, v248, v249
    v_cvt_pk_bf16_f32 v129, v250, v251
    v_lshlrev_b32 v248, 16, v130
    v_and_b32 v249, 0xffff0000, v130
    v_lshlrev_b32 v250, 16, v131
    v_and_b32 v251, 0xffff0000, v131
    v_pk_fma_f32 v[248:249], v[248:249], v[252:253], v[254:255]
    v_pk_fma_f32 v[250:251], v[250:251], v[252:253], v[254:255]
    v_cvt_pk_bf16_f32 v130, v248, v249
    v_cvt_pk_bf16_f32 v131, v250, v251
    v_lshlrev_b32 v248, 16, v132
    v_and_b32 v249, 0xffff0000, v132
    v_lshlrev_b32 v250, 16, v133
    v_and_b32 v251, 0xffff0000, v133
    v_pk_fma_f32 v[248:249], v[248:249], v[252:253], v[254:255]
    v_pk_fma_f32 v[250:251], v[250:251], v[252:253], v[254:255]
    v_cvt_pk_bf16_f32 v132, v248, v249
    v_cvt_pk_bf16_f32 v133, v250, v251
    v_lshlrev_b32 v248, 16, v134
    v_and_b32 v249, 0xffff0000, v134
    v_lshlrev_b32 v250, 16, v135
    v_and_b32 v251, 0xffff0000, v135
    v_pk_fma_f32 v[248:249], v[248:249], v[252:253], v[254:255]
    v_pk_fma_f32 v[250:251], v[250:251], v[252:253], v[254:255]
    v_cvt_pk_bf16_f32 v134, v248, v249
    v_cvt_pk_bf16_f32 v135, v250, v251
    v_lshlrev_b32 v248, 16, v136
    v_and_b32 v249, 0xffff0000, v136
    v_lshlrev_b32 v250, 16, v137
    v_and_b32 v251, 0xffff0000, v137
    v_pk_fma_f32 v[248:249], v[248:249], v[252:253], v[254:255]
    v_pk_fma_f32 v[250:251], v[250:251], v[252:253], v[254:255]
    v_cvt_pk_bf16_f32 v136, v248, v249
    v_cvt_pk_bf16_f32 v137, v250, v251
    v_lshlrev_b32 v248, 16, v138
    v_and_b32 v249, 0xffff0000, v138
    v_lshlrev_b32 v250, 16, v139
    v_and_b32 v251, 0xffff0000, v139
    v_pk_fma_f32 v[248:249], v[248:249], v[252:253], v[254:255]
    v_pk_fma_f32 v[250:251], v[250:251], v[252:253], v[254:255]
    v_cvt_pk_bf16_f32 v138, v248, v249
    v_cvt_pk_bf16_f32 v139, v250, v251
    v_lshlrev_b32 v248, 16, v140
    v_and_b32 v249, 0xffff0000, v140
    v_lshlrev_b32 v250, 16, v141
    v_and_b32 v251, 0xffff0000, v141
    v_pk_fma_f32 v[248:249], v[248:249], v[252:253], v[254:255]
    v_pk_fma_f32 v[250:251], v[250:251], v[252:253], v[254:255]
    v_cvt_pk_bf16_f32 v140, v248, v249
    v_cvt_pk_bf16_f32 v141, v250, v251
    v_lshlrev_b32 v248, 16, v142
    v_and_b32 v249, 0xffff0000, v142
    v_lshlrev_b32 v250, 16, v143
    v_and_b32 v251, 0xffff0000, v143
    v_pk_fma_f32 v[248:249], v[248:249], v[252:253], v[254:255]
    v_pk_fma_f32 v[250:251], v[250:251], v[252:253], v[254:255]
    v_cvt_pk_bf16_f32 v142, v248, v249
    v_cvt_pk_bf16_f32 v143, v250, v251
    v_lshlrev_b32 v248, 16, v144
    v_and_b32 v249, 0xffff0000, v144
    v_lshlrev_b32 v250, 16, v145
    v_and_b32 v251, 0xffff0000, v145
    v_pk_fma_f32 v[248:249], v[248:249], v[252:253], v[254:255]
    v_pk_fma_f32 v[250:251], v[250:251], v[252:253], v[254:255]
    v_cvt_pk_bf16_f32 v144, v248, v249
    v_cvt_pk_bf16_f32 v145, v250, v251
    v_lshlrev_b32 v248, 16, v146
    v_and_b32 v249, 0xffff0000, v146
    v_lshlrev_b32 v250, 16, v147
    v_and_b32 v251, 0xffff0000, v147
    v_pk_fma_f32 v[248:249], v[248:249], v[252:253], v[254:255]
    v_pk_fma_f32 v[250:251], v[250:251], v[252:253], v[254:255]
    v_cvt_pk_bf16_f32 v146, v248, v249
    v_cvt_pk_bf16_f32 v147, v250, v251
    v_lshlrev_b32 v248, 16, v148
    v_and_b32 v249, 0xffff0000, v148
    v_lshlrev_b32 v250, 16, v149
    v_and_b32 v251, 0xffff0000, v149
    v_pk_fma_f32 v[248:249], v[248:249], v[252:253], v[254:255]
    v_pk_fma_f32 v[250:251], v[250:251], v[252:253], v[254:255]
    v_cvt_pk_bf16_f32 v148, v248, v249
    v_cvt_pk_bf16_f32 v149, v250, v251
    v_lshlrev_b32 v248, 16, v150
    v_and_b32 v249, 0xffff0000, v150
    v_lshlrev_b32 v250, 16, v151
    v_and_b32 v251, 0xffff0000, v151
    v_pk_fma_f32 v[248:249], v[248:249], v[252:253], v[254:255]
    v_pk_fma_f32 v[250:251], v[250:251], v[252:253], v[254:255]
    v_cvt_pk_bf16_f32 v150, v248, v249
    v_cvt_pk_bf16_f32 v151, v250, v251
    v_lshlrev_b32 v248, 16, v152
    v_and_b32 v249, 0xffff0000, v152
    v_lshlrev_b32 v250, 16, v153
    v_and_b32 v251, 0xffff0000, v153
    v_pk_fma_f32 v[248:249], v[248:249], v[252:253], v[254:255]
    v_pk_fma_f32 v[250:251], v[250:251], v[252:253], v[254:255]
    v_cvt_pk_bf16_f32 v152, v248, v249
    v_cvt_pk_bf16_f32 v153, v250, v251
    v_lshlrev_b32 v248, 16, v154
    v_and_b32 v249, 0xffff0000, v154
    v_lshlrev_b32 v250, 16, v155
    v_and_b32 v251, 0xffff0000, v155
    v_pk_fma_f32 v[248:249], v[248:249], v[252:253], v[254:255]
    v_pk_fma_f32 v[250:251], v[250:251], v[252:253], v[254:255]
    v_cvt_pk_bf16_f32 v154, v248, v249
    v_cvt_pk_bf16_f32 v155, v250, v251
    v_lshlrev_b32 v248, 16, v156
    v_and_b32 v249, 0xffff0000, v156
    v_lshlrev_b32 v250, 16, v157
    v_and_b32 v251, 0xffff0000, v157
    v_pk_fma_f32 v[248:249], v[248:249], v[252:253], v[254:255]
    v_pk_fma_f32 v[250:251], v[250:251], v[252:253], v[254:255]
    v_cvt_pk_bf16_f32 v156, v248, v249
    v_cvt_pk_bf16_f32 v157, v250, v251
    v_lshlrev_b32 v248, 16, v158
    v_and_b32 v249, 0xffff0000, v158
    v_lshlrev_b32 v250, 16, v159
    v_and_b32 v251, 0xffff0000, v159
    v_pk_fma_f32 v[248:249], v[248:249], v[252:253], v[254:255]
    v_pk_fma_f32 v[250:251], v[250:251], v[252:253], v[254:255]
    v_cvt_pk_bf16_f32 v158, v248, v249
    v_cvt_pk_bf16_f32 v159, v250, v251
    s_barrier
    v_add_u32 v8, 0, v6
    ds_read_b64_tr_b16 v[224:225], v8 offset:0
    ds_read_b64_tr_b16 v[226:227], v8 offset:512
    ds_read_b64_tr_b16 v[228:229], v8 offset:18432
    ds_read_b64_tr_b16 v[230:231], v8 offset:18944
    ds_read_b64_tr_b16 v[232:233], v8 offset:2048
    ds_read_b64_tr_b16 v[234:235], v8 offset:2560
    ds_read_b64_tr_b16 v[236:237], v8 offset:20480
    ds_read_b64_tr_b16 v[238:239], v8 offset:20992
    ds_read_b64_tr_b16 v[240:241], v8 offset:4096
    ds_read_b64_tr_b16 v[242:243], v8 offset:4608
    ds_read_b64_tr_b16 v[244:245], v8 offset:22528
    ds_read_b64_tr_b16 v[246:247], v8 offset:23040
    s_waitcnt lgkmcnt(8)
    v_mfma_f32_32x32x16_bf16 v[160:175], v[224:227], v[16:19], 0
    ds_read_b64_tr_b16 v[224:225], v8 offset:6144
    ds_read_b64_tr_b16 v[226:227], v8 offset:6656
    v_mfma_f32_32x32x16_bf16 v[176:191], v[228:231], v[16:19], 0
    ds_read_b64_tr_b16 v[228:229], v8 offset:24576
    ds_read_b64_tr_b16 v[230:231], v8 offset:25088
    s_waitcnt lgkmcnt(8)
    v_mfma_f32_32x32x16_bf16 v[160:175], v[232:235], v[20:23], v[160:175]
    ds_read_b64_tr_b16 v[232:233], v8 offset:8192
    ds_read_b64_tr_b16 v[234:235], v8 offset:8704
    v_mfma_f32_32x32x16_bf16 v[176:191], v[236:239], v[20:23], v[176:191]
    ds_read_b64_tr_b16 v[236:237], v8 offset:26624
    ds_read_b64_tr_b16 v[238:239], v8 offset:27136
    s_waitcnt lgkmcnt(8)
    v_mfma_f32_32x32x16_bf16 v[160:175], v[240:243], v[24:27], v[160:175]
    ds_read_b64_tr_b16 v[240:241], v8 offset:10240
    ds_read_b64_tr_b16 v[242:243], v8 offset:10752
    v_mfma_f32_32x32x16_bf16 v[176:191], v[244:247], v[24:27], v[176:191]
    ds_read_b64_tr_b16 v[244:245], v8 offset:28672
    ds_read_b64_tr_b16 v[246:247], v8 offset:29184
    s_waitcnt lgkmcnt(8)
    v_mfma_f32_32x32x16_bf16 v[160:175], v[224:227], v[28:31], v[160:175]
    ds_read_b64_tr_b16 v[224:225], v8 offset:12288
    ds_read_b64_tr_b16 v[226:227], v8 offset:12800
    v_mfma_f32_32x32x16_bf16 v[176:191], v[228:231], v[28:31], v[176:191]
    ds_read_b64_tr_b16 v[228:229], v8 offset:30720
    ds_read_b64_tr_b16 v[230:231], v8 offset:31232
    s_waitcnt lgkmcnt(8)
    v_mfma_f32_32x32x16_bf16 v[160:175], v[232:235], v[32:35], v[160:175]
    ds_read_b64_tr_b16 v[232:233], v8 offset:14336
    ds_read_b64_tr_b16 v[234:235], v8 offset:14848
    v_mfma_f32_32x32x16_bf16 v[176:191], v[236:239], v[32:35], v[176:191]
    ds_read_b64_tr_b16 v[236:237], v8 offset:32768
    ds_read_b64_tr_b16 v[238:239], v8 offset:33280
    s_waitcnt lgkmcnt(8)
    v_mfma_f32_32x32x16_bf16 v[160:175], v[240:243], v[36:39], v[160:175]
    ds_read_b64_tr_b16 v[240:241], v8 offset:16384
    ds_read_b64_tr_b16 v[242:243], v8 offset:16896
    v_mfma_f32_32x32x16_bf16 v[176:191], v[244:247], v[36:39], v[176:191]
    ds_read_b64_tr_b16 v[244:245], v8 offset:34816
    ds_read_b64_tr_b16 v[246:247], v8 offset:35328
    s_waitcnt lgkmcnt(8)
    v_mfma_f32_32x32x16_bf16 v[160:175], v[224:227], v[40:43], v[160:175]
    s_barrier
    v_add_u32 v9, 36864, v6
    ds_read_b64_tr_b16 v[224:225], v9 offset:0
    ds_read_b64_tr_b16 v[226:227], v9 offset:512
    v_mfma_f32_32x32x16_bf16 v[176:191], v[228:231], v[40:43], v[176:191]
    ds_read_b64_tr_b16 v[228:229], v9 offset:18432
    ds_read_b64_tr_b16 v[230:231], v9 offset:18944
    s_waitcnt lgkmcnt(8)
    v_mfma_f32_32x32x16_bf16 v[160:175], v[232:235], v[44:47], v[160:175]
    ds_read_b64_tr_b16 v[232:233], v9 offset:2048
    ds_read_b64_tr_b16 v[234:235], v9 offset:2560
    v_mfma_f32_32x32x16_bf16 v[176:191], v[236:239], v[44:47], v[176:191]
    ds_read_b64_tr_b16 v[236:237], v9 offset:20480
    ds_read_b64_tr_b16 v[238:239], v9 offset:20992
    s_waitcnt lgkmcnt(8)
    v_mfma_f32_32x32x16_bf16 v[160:175], v[240:243], v[48:51], v[160:175]
    ds_read_b64_tr_b16 v[240:241], v9 offset:4096
    ds_read_b64_tr_b16 v[242:243], v9 offset:4608
    v_mfma_f32_32x32x16_bf16 v[176:191], v[244:247], v[48:51], v[176:191]
    ds_read_b64_tr_b16 v[244:245], v9 offset:22528
    ds_read_b64_tr_b16 v[246:247], v9 offset:23040
    s_waitcnt lgkmcnt(8)
    v_mfma_f32_32x32x16_bf16 v[160:175], v[224:227], v[52:55], v[160:175]
    ds_read_b64_tr_b16 v[224:225], v9 offset:6144
    ds_read_b64_tr_b16 v[226:227], v9 offset:6656
    v_mfma_f32_32x32x16_bf16 v[176:191], v[228:231], v[52:55], v[176:191]
    ds_read_b64_tr_b16 v[228:229], v9 offset:24576
    ds_read_b64_tr_b16 v[230:231], v9 offset:25088
    s_waitcnt lgkmcnt(8)
    v_mfma_f32_32x32x16_bf16 v[160:175], v[232:235], v[56:59], v[160:175]
    ds_read_b64_tr_b16 v[232:233], v9 offset:8192
    ds_read_b64_tr_b16 v[234:235], v9 offset:8704
    v_mfma_f32_32x32x16_bf16 v[176:191], v[236:239], v[56:59], v[176:191]
    ds_read_b64_tr_b16 v[236:237], v9 offset:26624
    ds_read_b64_tr_b16 v[238:239], v9 offset:27136
    s_waitcnt lgkmcnt(8)
    v_mfma_f32_32x32x16_bf16 v[160:175], v[240:243], v[60:63], v[160:175]
    ds_read_b64_tr_b16 v[240:241], v9 offset:10240
    ds_read_b64_tr_b16 v[242:243], v9 offset:10752
    v_mfma_f32_32x32x16_bf16 v[176:191], v[244:247], v[60:63], v[176:191]
    ds_read_b64_tr_b16 v[244:245], v9 offset:28672
    ds_read_b64_tr_b16 v[246:247], v9 offset:29184
    s_waitcnt lgkmcnt(8)
    v_mfma_f32_32x32x16_bf16 v[160:175], v[224:227], v[64:67], v[160:175]
    ds_read_b64_tr_b16 v[224:225], v9 offset:12288
    ds_read_b64_tr_b16 v[226:227], v9 offset:12800
    v_mfma_f32_32x32x16_bf16 v[176:191], v[228:231], v[64:67], v[176:191]
    ds_read_b64_tr_b16 v[228:229], v9 offset:30720
    ds_read_b64_tr_b16 v[230:231], v9 offset:31232
    s_waitcnt lgkmcnt(8)
    v_mfma_f32_32x32x16_bf16 v[160:175], v[232:235], v[68:71], v[160:175]
    ds_read_b64_tr_b16 v[232:233], v9 offset:14336
    ds_read_b64_tr_b16 v[234:235], v9 offset:14848
    v_mfma_f32_32x32x16_bf16 v[176:191], v[236:239], v[68:71], v[176:191]
    ds_read_b64_tr_b16 v[236:237], v9 offset:32768
    ds_read_b64_tr_b16 v[238:239], v9 offset:33280
    s_waitcnt lgkmcnt(8)
    v_mfma_f32_32x32x16_bf16 v[160:175], v[240:243], v[72:75], v[160:175]
    ds_read_b64_tr_b16 v[240:241], v9 offset:16384
    ds_read_b64_tr_b16 v[242:243], v9 offset:16896
    v_mfma_f32_32x32x16_bf16 v[176:191], v[244:247], v[72:75], v[176:191]
    ds_read_b64_tr_b16 v[244:245], v9 offset:34816
    ds_read_b64_tr_b16 v[246:247], v9 offset:35328
    s_waitcnt lgkmcnt(8)
    v_mfma_f32_32x32x16_bf16 v[160:175], v[224:227], v[76:79], v[160:175]
    v_add_u32 v8, 0, v7
    ds_read_b64_tr_b16 v[224:225], v8 offset:0
    ds_read_b64_tr_b16 v[226:227], v8 offset:512
    v_mfma_f32_32x32x16_bf16 v[176:191], v[228:231], v[76:79], v[176:191]
    ds_read_b64_tr_b16 v[228:229], v8 offset:18432
    ds_read_b64_tr_b16 v[230:231], v8 offset:18944
    s_waitcnt lgkmcnt(8)
    v_mfma_f32_32x32x16_bf16 v[160:175], v[232:235], v[80:83], v[160:175]
    ds_read_b64_tr_b16 v[232:233], v8 offset:2048
    ds_read_b64_tr_b16 v[234:235], v8 offset:2560
    v_mfma_f32_32x32x16_bf16 v[176:191], v[236:239], v[80:83], v[176:191]
    ds_read_b64_tr_b16 v[236:237], v8 offset:20480
    ds_read_b64_tr_b16 v[238:239], v8 offset:20992
    s_waitcnt lgkmcnt(8)
    v_mfma_f32_32x32x16_bf16 v[160:175], v[240:243], v[84:87], v[160:175]
    ds_read_b64_tr_b16 v[240:241], v8 offset:4096
    ds_read_b64_tr_b16 v[242:243], v8 offset:4608
    v_mfma_f32_32x32x16_bf16 v[176:191], v[244:247], v[84:87], v[176:191]
    ds_read_b64_tr_b16 v[244:245], v8 offset:22528
    ds_read_b64_tr_b16 v[246:247], v8 offset:23040
    s_waitcnt lgkmcnt(8)
    v_mfma_f32_32x32x16_bf16 v[192:207], v[224:227], v[16:19], 0
    ds_read_b64_tr_b16 v[224:225], v8 offset:6144
    ds_read_b64_tr_b16 v[226:227], v8 offset:6656
    v_mfma_f32_32x32x16_bf16 v[208:223], v[228:231], v[16:19], 0
    ds_read_b64_tr_b16 v[228:229], v8 offset:24576
    ds_read_b64_tr_b16 v[230:231], v8 offset:25088
    s_waitcnt lgkmcnt(8)
    v_mfma_f32_32x32x16_bf16 v[192:207], v[232:235], v[20:23], v[192:207]
    ds_read_b64_tr_b16 v[232:233], v8 offset:8192
    ds_read_b64_tr_b16 v[234:235], v8 offset:8704
    v_mfma_f32_32x32x16_bf16 v[208:223], v[236:239], v[20:23], v[208:223]
    ds_read_b64_tr_b16 v[236:237], v8 offset:26624
    ds_read_b64_tr_b16 v[238:239], v8 offset:27136
    s_waitcnt lgkmcnt(8)
    v_mfma_f32_32x32x16_bf16 v[192:207], v[240:243], v[24:27], v[192:207]
    ds_read_b64_tr_b16 v[240:241], v8 offset:10240
    ds_read_b64_tr_b16 v[242:243], v8 offset:10752
    v_mfma_f32_32x32x16_bf16 v[208:223], v[244:247], v[24:27], v[208:223]
    ds_read_b64_tr_b16 v[244:245], v8 offset:28672
    ds_read_b64_tr_b16 v[246:247], v8 offset:29184
    s_waitcnt lgkmcnt(8)
    v_mfma_f32_32x32x16_bf16 v[192:207], v[224:227], v[28:31], v[192:207]
    ds_read_b64_tr_b16 v[224:225], v8 offset:12288
    ds_read_b64_tr_b16 v[226:227], v8 offset:12800
    v_mfma_f32_32x32x16_bf16 v[208:223], v[228:231], v[28:31], v[208:223]
    ds_read_b64_tr_b16 v[228:229], v8 offset:30720
    ds_read_b64_tr_b16 v[230:231], v8 offset:31232
    s_waitcnt lgkmcnt(8)
    v_mfma_f32_32x32x16_bf16 v[192:207], v[232:235], v[32:35], v[192:207]
    ds_read_b64_tr_b16 v[232:233], v8 offset:14336
    ds_read_b64_tr_b16 v[234:235], v8 offset:14848
    v_mfma_f32_32x32x16_bf16 v[208:223], v[236:239], v[32:35], v[208:223]
    ds_read_b64_tr_b16 v[236:237], v8 offset:32768
    ds_read_b64_tr_b16 v[238:239], v8 offset:33280
    s_waitcnt lgkmcnt(8)
    v_mfma_f32_32x32x16_bf16 v[192:207], v[240:243], v[36:39], v[192:207]
    ds_read_b64_tr_b16 v[240:241], v8 offset:16384
    ds_read_b64_tr_b16 v[242:243], v8 offset:16896
    v_mfma_f32_32x32x16_bf16 v[208:223], v[244:247], v[36:39], v[208:223]
    ds_read_b64_tr_b16 v[244:245], v8 offset:34816
    ds_read_b64_tr_b16 v[246:247], v8 offset:35328
    s_waitcnt lgkmcnt(8)
    v_mfma_f32_32x32x16_bf16 v[192:207], v[224:227], v[40:43], v[192:207]
    v_add_u32 v9, 36864, v7
    ds_read_b64_tr_b16 v[224:225], v9 offset:0
    ds_read_b64_tr_b16 v[226:227], v9 offset:512
    v_mfma_f32_32x32x16_bf16 v[208:223], v[228:231], v[40:43], v[208:223]
    ds_read_b64_tr_b16 v[228:229], v9 offset:18432
    ds_read_b64_tr_b16 v[230:231], v9 offset:18944
    s_waitcnt lgkmcnt(8)
    v_mfma_f32_32x32x16_bf16 v[192:207], v[232:235], v[44:47], v[192:207]
    ds_read_b64_tr_b16 v[232:233], v9 offset:2048
    ds_read_b64_tr_b16 v[234:235], v9 offset:2560
    v_mfma_f32_32x32x16_bf16 v[208:223], v[236:239], v[44:47], v[208:223]
    ds_read_b64_tr_b16 v[236:237], v9 offset:20480
    ds_read_b64_tr_b16 v[238:239], v9 offset:20992
    s_waitcnt lgkmcnt(8)
    v_mfma_f32_32x32x16_bf16 v[192:207], v[240:243], v[48:51], v[192:207]
    ds_read_b64_tr_b16 v[240:241], v9 offset:4096
    ds_read_b64_tr_b16 v[242:243], v9 offset:4608
    v_mfma_f32_32x32x16_bf16 v[208:223], v[244:247], v[48:51], v[208:223]
    ds_read_b64_tr_b16 v[244:245], v9 offset:22528
    ds_read_b64_tr_b16 v[246:247], v9 offset:23040
    s_waitcnt lgkmcnt(8)
    v_mfma_f32_32x32x16_bf16 v[192:207], v[224:227], v[52:55], v[192:207]
    ds_read_b64_tr_b16 v[224:225], v9 offset:6144
    ds_read_b64_tr_b16 v[226:227], v9 offset:6656
    v_mfma_f32_32x32x16_bf16 v[208:223], v[228:231], v[52:55], v[208:223]
    ds_read_b64_tr_b16 v[228:229], v9 offset:24576
    ds_read_b64_tr_b16 v[230:231], v9 offset:25088
    s_waitcnt lgkmcnt(8)
    v_mfma_f32_32x32x16_bf16 v[192:207], v[232:235], v[56:59], v[192:207]
    ds_read_b64_tr_b16 v[232:233], v9 offset:8192
    ds_read_b64_tr_b16 v[234:235], v9 offset:8704
    v_mfma_f32_32x32x16_bf16 v[208:223], v[236:239], v[56:59], v[208:223]
    ds_read_b64_tr_b16 v[236:237], v9 offset:26624
    ds_read_b64_tr_b16 v[238:239], v9 offset:27136
    s_waitcnt lgkmcnt(8)
    v_mfma_f32_32x32x16_bf16 v[192:207], v[240:243], v[60:63], v[192:207]
    ds_read_b64_tr_b16 v[240:241], v9 offset:10240
    ds_read_b64_tr_b16 v[242:243], v9 offset:10752
    v_mfma_f32_32x32x16_bf16 v[208:223], v[244:247], v[60:63], v[208:223]
    ds_read_b64_tr_b16 v[244:245], v9 offset:28672
    ds_read_b64_tr_b16 v[246:247], v9 offset:29184
    s_waitcnt lgkmcnt(8)
    v_mfma_f32_32x32x16_bf16 v[192:207], v[224:227], v[64:67], v[192:207]
    ds_read_b64_tr_b16 v[224:225], v9 offset:12288
    ds_read_b64_tr_b16 v[226:227], v9 offset:12800
    v_mfma_f32_32x32x16_bf16 v[208:223], v[228:231], v[64:67], v[208:223]
    ds_read_b64_tr_b16 v[228:229], v9 offset:30720
    ds_read_b64_tr_b16 v[230:231], v9 offset:31232
    s_waitcnt lgkmcnt(8)
    v_mfma_f32_32x32x16_bf16 v[192:207], v[232:235], v[68:71], v[192:207]
    ds_read_b64_tr_b16 v[232:233], v9 offset:14336
    ds_read_b64_tr_b16 v[234:235], v9 offset:14848
    v_mfma_f32_32x32x16_bf16 v[208:223], v[236:239], v[68:71], v[208:223]
    ds_read_b64_tr_b16 v[236:237], v9 offset:32768
    ds_read_b64_tr_b16 v[238:239], v9 offset:33280
    s_waitcnt lgkmcnt(8)
    v_mfma_f32_32x32x16_bf16 v[192:207], v[240:243], v[72:75], v[192:207]
    ds_read_b64_tr_b16 v[240:241], v9 offset:16384
    ds_read_b64_tr_b16 v[242:243], v9 offset:16896
    v_mfma_f32_32x32x16_bf16 v[208:223], v[244:247], v[72:75], v[208:223]
    ds_read_b64_tr_b16 v[244:245], v9 offset:34816
    ds_read_b64_tr_b16 v[246:247], v9 offset:35328
    s_waitcnt lgkmcnt(8)
    v_mfma_f32_32x32x16_bf16 v[192:207], v[224:227], v[76:79], v[192:207]
    s_barrier
    v_add_u32 v8, 73728, v6
    ds_read_b64_tr_b16 v[224:225], v8 offset:0
    ds_read_b64_tr_b16 v[226:227], v8 offset:512
    v_mfma_f32_32x32x16_bf16 v[208:223], v[228:231], v[76:79], v[208:223]
    ds_read_b64_tr_b16 v[228:229], v8 offset:18432
    ds_read_b64_tr_b16 v[230:231], v8 offset:18944
    s_waitcnt lgkmcnt(8)
    v_mfma_f32_32x32x16_bf16 v[192:207], v[232:235], v[80:83], v[192:207]
    ds_read_b64_tr_b16 v[232:233], v8 offset:2048
    ds_read_b64_tr_b16 v[234:235], v8 offset:2560
    v_mfma_f32_32x32x16_bf16 v[208:223], v[236:239], v[80:83], v[208:223]
    ds_read_b64_tr_b16 v[236:237], v8 offset:20480
    ds_read_b64_tr_b16 v[238:239], v8 offset:20992
    s_waitcnt lgkmcnt(8)
    v_mfma_f32_32x32x16_bf16 v[192:207], v[240:243], v[84:87], v[192:207]
    ds_read_b64_tr_b16 v[240:241], v8 offset:4096
    ds_read_b64_tr_b16 v[242:243], v8 offset:4608
    v_mfma_f32_32x32x16_bf16 v[208:223], v[244:247], v[84:87], v[208:223]
    ds_read_b64_tr_b16 v[244:245], v8 offset:22528
    ds_read_b64_tr_b16 v[246:247], v8 offset:23040
    s_mov_b32 s46, s40
    s_branch k1_kernel_q2
k1_kernel_quadloop:
    s_waitcnt lgkmcnt(8)
    v_mfma_f32_32x32x16_bf16 v[160:175], v[224:227], v[16:19], 0
    ds_read_b64_tr_b16 v[224:225], v8 offset:6144
    ds_read_b64_tr_b16 v[226:227], v8 offset:6656
    v_mfma_f32_32x32x16_bf16 v[176:191], v[228:231], v[16:19], 0
    ds_read_b64_tr_b16 v[228:229], v8 offset:24576
    ds_read_b64_tr_b16 v[230:231], v8 offset:25088
    s_waitcnt lgkmcnt(8)
    v_mfma_f32_32x32x16_bf16 v[160:175], v[232:235], v[20:23], v[160:175]
    ds_read_b64_tr_b16 v[232:233], v8 offset:8192
    ds_read_b64_tr_b16 v[234:235], v8 offset:8704
    v_mfma_f32_32x32x16_bf16 v[176:191], v[236:239], v[20:23], v[176:191]
    ds_read_b64_tr_b16 v[236:237], v8 offset:26624
    ds_read_b64_tr_b16 v[238:239], v8 offset:27136
    v_exp_f32 v248, -v192
    v_exp_f32 v249, -v193
    v_mul_f32 v208, v192, v208
    s_waitcnt lgkmcnt(8)
    v_mfma_f32_32x32x16_bf16 v[160:175], v[240:243], v[24:27], v[160:175]
    ds_read_b64_tr_b16 v[240:241], v8 offset:10240
    ds_read_b64_tr_b16 v[242:243], v8 offset:10752
    v_mul_f32 v209, v193, v209
    v_add_f32 v248, 1.0, v248
    v_add_f32 v249, 1.0, v249
    v_mfma_f32_32x32x16_bf16 v[176:191], v[244:247], v[24:27], v[176:191]
    ds_read_b64_tr_b16 v[244:245], v8 offset:28672
    ds_read_b64_tr_b16 v[246:247], v8 offset:29184
    v_rcp_f32 v248, v248
    v_rcp_f32 v249, v249
    s_nop 0
    s_waitcnt lgkmcnt(8)
    v_mfma_f32_32x32x16_bf16 v[160:175], v[224:227], v[28:31], v[160:175]
    ds_read_b64_tr_b16 v[224:225], v8 offset:12288
    ds_read_b64_tr_b16 v[226:227], v8 offset:12800
    v_mul_f32 v192, v208, v248
    v_mul_f32 v193, v209, v249
    v_exp_f32 v250, -v194
    v_mfma_f32_32x32x16_bf16 v[176:191], v[228:231], v[28:31], v[176:191]
    ds_read_b64_tr_b16 v[228:229], v8 offset:30720
    ds_read_b64_tr_b16 v[230:231], v8 offset:31232
    v_exp_f32 v251, -v195
    v_mul_f32 v210, v194, v210
    v_mul_f32 v211, v195, v211
    s_waitcnt lgkmcnt(8)
    v_mfma_f32_32x32x16_bf16 v[160:175], v[232:235], v[32:35], v[160:175]
    ds_read_b64_tr_b16 v[232:233], v8 offset:14336
    ds_read_b64_tr_b16 v[234:235], v8 offset:14848
    v_add_f32 v250, 1.0, v250
    v_add_f32 v251, 1.0, v251
    v_rcp_f32 v250, v250
    v_mfma_f32_32x32x16_bf16 v[176:191], v[236:239], v[32:35], v[176:191]
    ds_read_b64_tr_b16 v[236:237], v8 offset:32768
    ds_read_b64_tr_b16 v[238:239], v8 offset:33280
    v_rcp_f32 v251, v251
    v_cvt_pk_bf16_f32 v208, v192, v193
    v_mul_f32 v194, v210, v250
    s_waitcnt lgkmcnt(8)
    v_mfma_f32_32x32x16_bf16 v[160:175], v[240:243], v[36:39], v[160:175]
    ds_read_b64_tr_b16 v[240:241], v8 offset:16384
    ds_read_b64_tr_b16 v[242:243], v8 offset:16896
    v_mul_f32 v195, v211, v251
    v_exp_f32 v252, -v196
    v_exp_f32 v253, -v197
    v_mfma_f32_32x32x16_bf16 v[176:191], v[244:247], v[36:39], v[176:191]
    ds_read_b64_tr_b16 v[244:245], v8 offset:34816
    ds_read_b64_tr_b16 v[246:247], v8 offset:35328
    v_mul_f32 v212, v196, v212
    v_mul_f32 v213, v197, v213
    v_add_f32 v252, 1.0, v252
    s_waitcnt lgkmcnt(8)
    v_mfma_f32_32x32x16_bf16 v[160:175], v[224:227], v[40:43], v[160:175]
    s_barrier
    v_add_u32 v9, 36864, v6
    ds_read_b64_tr_b16 v[224:225], v9 offset:0
    ds_read_b64_tr_b16 v[226:227], v9 offset:512
    v_add_f32 v253, 1.0, v253
    v_rcp_f32 v252, v252
    v_rcp_f32 v253, v253
    v_mfma_f32_32x32x16_bf16 v[176:191], v[228:231], v[40:43], v[176:191]
    ds_read_b64_tr_b16 v[228:229], v9 offset:18432
    ds_read_b64_tr_b16 v[230:231], v9 offset:18944
    v_cvt_pk_bf16_f32 v209, v194, v195
    v_mul_f32 v196, v212, v252
    v_mul_f32 v197, v213, v253
    s_waitcnt lgkmcnt(8)
    v_mfma_f32_32x32x16_bf16 v[160:175], v[232:235], v[44:47], v[160:175]
    ds_read_b64_tr_b16 v[232:233], v9 offset:2048
    ds_read_b64_tr_b16 v[234:235], v9 offset:2560
    v_exp_f32 v254, -v198
    v_exp_f32 v255, -v199
    v_mul_f32 v214, v198, v214
    v_mfma_f32_32x32x16_bf16 v[176:191], v[236:239], v[44:47], v[176:191]
    ds_read_b64_tr_b16 v[236:237], v9 offset:20480
    ds_read_b64_tr_b16 v[238:239], v9 offset:20992
    v_mul_f32 v215, v199, v215
    v_add_f32 v254, 1.0, v254
    v_add_f32 v255, 1.0, v255
    s_waitcnt lgkmcnt(8)
    v_mfma_f32_32x32x16_bf16 v[160:175], v[240:243], v[48:51], v[160:175]
    ds_read_b64_tr_b16 v[240:241], v9 offset:4096
    ds_read_b64_tr_b16 v[242:243], v9 offset:4608
    v_rcp_f32 v254, v254
    v_rcp_f32 v255, v255
    v_cvt_pk_bf16_f32 v210, v196, v197
    v_mfma_f32_32x32x16_bf16 v[176:191], v[244:247], v[48:51], v[176:191]
    ds_read_b64_tr_b16 v[244:245], v9 offset:22528
    ds_read_b64_tr_b16 v[246:247], v9 offset:23040
    v_mul_f32 v198, v214, v254
    v_mul_f32 v199, v215, v255
    v_exp_f32 v248, -v200
    s_waitcnt lgkmcnt(8)
    v_mfma_f32_32x32x16_bf16 v[160:175], v[224:227], v[52:55], v[160:175]
    ds_read_b64_tr_b16 v[224:225], v9 offset:6144
    ds_read_b64_tr_b16 v[226:227], v9 offset:6656
    v_exp_f32 v249, -v201
    v_mul_f32 v216, v200, v216
    v_mul_f32 v217, v201, v217
    v_mfma_f32_32x32x16_bf16 v[176:191], v[228:231], v[52:55], v[176:191]
    ds_read_b64_tr_b16 v[228:229], v9 offset:24576
    ds_read_b64_tr_b16 v[230:231], v9 offset:25088
    v_add_f32 v248, 1.0, v248
    v_add_f32 v249, 1.0, v249
    v_rcp_f32 v248, v248
    s_waitcnt lgkmcnt(8)
    v_mfma_f32_32x32x16_bf16 v[160:175], v[232:235], v[56:59], v[160:175]
    ds_read_b64_tr_b16 v[232:233], v9 offset:8192
    ds_read_b64_tr_b16 v[234:235], v9 offset:8704
    v_rcp_f32 v249, v249
    v_cvt_pk_bf16_f32 v211, v198, v199
    v_mul_f32 v200, v216, v248
    v_mfma_f32_32x32x16_bf16 v[176:191], v[236:239], v[56:59], v[176:191]
    ds_read_b64_tr_b16 v[236:237], v9 offset:26624
    ds_read_b64_tr_b16 v[238:239], v9 offset:27136
    v_mul_f32 v201, v217, v249
    buffer_store_dwordx4 v[208:211], v11, s[28:31], s49 offen sc0 sc1
    v_exp_f32 v250, -v202
    s_waitcnt lgkmcnt(8)
    v_mfma_f32_32x32x16_bf16 v[160:175], v[240:243], v[60:63], v[160:175]
    ds_read_b64_tr_b16 v[240:241], v9 offset:10240
    ds_read_b64_tr_b16 v[242:243], v9 offset:10752
    v_exp_f32 v251, -v203
    v_mul_f32 v218, v202, v218
    v_mul_f32 v219, v203, v219
    v_mfma_f32_32x32x16_bf16 v[176:191], v[244:247], v[60:63], v[176:191]
    ds_read_b64_tr_b16 v[244:245], v9 offset:28672
    ds_read_b64_tr_b16 v[246:247], v9 offset:29184
    v_add_f32 v250, 1.0, v250
    v_add_f32 v251, 1.0, v251
    v_rcp_f32 v250, v250
    s_waitcnt lgkmcnt(8)
    v_mfma_f32_32x32x16_bf16 v[160:175], v[224:227], v[64:67], v[160:175]
    ds_read_b64_tr_b16 v[224:225], v9 offset:12288
    ds_read_b64_tr_b16 v[226:227], v9 offset:12800
    v_rcp_f32 v251, v251
    v_cvt_pk_bf16_f32 v212, v200, v201
    v_mul_f32 v202, v218, v250
    v_mfma_f32_32x32x16_bf16 v[176:191], v[228:231], v[64:67], v[176:191]
    ds_read_b64_tr_b16 v[228:229], v9 offset:30720
    ds_read_b64_tr_b16 v[230:231], v9 offset:31232
    v_mul_f32 v203, v219, v251
    v_exp_f32 v252, -v204
    v_exp_f32 v253, -v205
    s_waitcnt lgkmcnt(8)
    v_mfma_f32_32x32x16_bf16 v[160:175], v[232:235], v[68:71], v[160:175]
    ds_read_b64_tr_b16 v[232:233], v9 offset:14336
    ds_read_b64_tr_b16 v[234:235], v9 offset:14848
    v_mul_f32 v220, v204, v220
    v_mul_f32 v221, v205, v221
    v_add_f32 v252, 1.0, v252
    v_mfma_f32_32x32x16_bf16 v[176:191], v[236:239], v[68:71], v[176:191]
    ds_read_b64_tr_b16 v[236:237], v9 offset:32768
    ds_read_b64_tr_b16 v[238:239], v9 offset:33280
    v_add_f32 v253, 1.0, v253
    v_rcp_f32 v252, v252
    v_rcp_f32 v253, v253
    s_waitcnt lgkmcnt(8)
    v_mfma_f32_32x32x16_bf16 v[160:175], v[240:243], v[72:75], v[160:175]
    ds_read_b64_tr_b16 v[240:241], v9 offset:16384
    ds_read_b64_tr_b16 v[242:243], v9 offset:16896
    v_cvt_pk_bf16_f32 v213, v202, v203
    v_mul_f32 v204, v220, v252
    v_mul_f32 v205, v221, v253
    v_mfma_f32_32x32x16_bf16 v[176:191], v[244:247], v[72:75], v[176:191]
    ds_read_b64_tr_b16 v[244:245], v9 offset:34816
    ds_read_b64_tr_b16 v[246:247], v9 offset:35328
    v_exp_f32 v254, -v206
    v_exp_f32 v255, -v207
    v_mul_f32 v222, v206, v222
    s_waitcnt lgkmcnt(8)
    v_mfma_f32_32x32x16_bf16 v[160:175], v[224:227], v[76:79], v[160:175]
    v_add_u32 v8, 0, v7
    ds_read_b64_tr_b16 v[224:225], v8 offset:0
    ds_read_b64_tr_b16 v[226:227], v8 offset:512
    v_mul_f32 v223, v207, v223
    v_add_f32 v254, 1.0, v254
    v_add_f32 v255, 1.0, v255
    v_mfma_f32_32x32x16_bf16 v[176:191], v[228:231], v[76:79], v[176:191]
    ds_read_b64_tr_b16 v[228:229], v8 offset:18432
    ds_read_b64_tr_b16 v[230:231], v8 offset:18944
    v_rcp_f32 v254, v254
    v_rcp_f32 v255, v255
    v_cvt_pk_bf16_f32 v214, v204, v205
    s_waitcnt lgkmcnt(8)
    v_mfma_f32_32x32x16_bf16 v[160:175], v[232:235], v[80:83], v[160:175]
    ds_read_b64_tr_b16 v[232:233], v8 offset:2048
    ds_read_b64_tr_b16 v[234:235], v8 offset:2560
    v_mul_f32 v206, v222, v254
    v_mul_f32 v207, v223, v255
    v_cvt_pk_bf16_f32 v215, v206, v207
    v_mfma_f32_32x32x16_bf16 v[176:191], v[236:239], v[80:83], v[176:191]
    ds_read_b64_tr_b16 v[236:237], v8 offset:20480
    ds_read_b64_tr_b16 v[238:239], v8 offset:20992
    buffer_store_dwordx4 v[212:215], v11, s[28:31], s49 offen offset:1024 sc0 sc1
    s_add_u32 s49, s49, 2048
    s_waitcnt lgkmcnt(8)
    v_mfma_f32_32x32x16_bf16 v[160:175], v[240:243], v[84:87], v[160:175]
    ds_read_b64_tr_b16 v[240:241], v8 offset:4096
    ds_read_b64_tr_b16 v[242:243], v8 offset:4608
    v_mfma_f32_32x32x16_bf16 v[176:191], v[244:247], v[84:87], v[176:191]
    ds_read_b64_tr_b16 v[244:245], v8 offset:22528
    ds_read_b64_tr_b16 v[246:247], v8 offset:23040
    s_waitcnt lgkmcnt(8)
    v_mfma_f32_32x32x16_bf16 v[192:207], v[224:227], v[16:19], 0
    ds_read_b64_tr_b16 v[224:225], v8 offset:6144
    ds_read_b64_tr_b16 v[226:227], v8 offset:6656
    v_mfma_f32_32x32x16_bf16 v[208:223], v[228:231], v[16:19], 0
    ds_read_b64_tr_b16 v[228:229], v8 offset:24576
    ds_read_b64_tr_b16 v[230:231], v8 offset:25088
    s_waitcnt lgkmcnt(8)
    v_mfma_f32_32x32x16_bf16 v[192:207], v[232:235], v[20:23], v[192:207]
    ds_read_b64_tr_b16 v[232:233], v8 offset:8192
    ds_read_b64_tr_b16 v[234:235], v8 offset:8704
    v_mfma_f32_32x32x16_bf16 v[208:223], v[236:239], v[20:23], v[208:223]
    ds_read_b64_tr_b16 v[236:237], v8 offset:26624
    ds_read_b64_tr_b16 v[238:239], v8 offset:27136
    s_waitcnt lgkmcnt(8)
    v_mfma_f32_32x32x16_bf16 v[192:207], v[240:243], v[24:27], v[192:207]
    ds_read_b64_tr_b16 v[240:241], v8 offset:10240
    ds_read_b64_tr_b16 v[242:243], v8 offset:10752
    v_mfma_f32_32x32x16_bf16 v[208:223], v[244:247], v[24:27], v[208:223]
    ds_read_b64_tr_b16 v[244:245], v8 offset:28672
    ds_read_b64_tr_b16 v[246:247], v8 offset:29184
    s_waitcnt lgkmcnt(8)
    v_mfma_f32_32x32x16_bf16 v[192:207], v[224:227], v[28:31], v[192:207]
    ds_read_b64_tr_b16 v[224:225], v8 offset:12288
    ds_read_b64_tr_b16 v[226:227], v8 offset:12800
    v_mfma_f32_32x32x16_bf16 v[208:223], v[228:231], v[28:31], v[208:223]
    ds_read_b64_tr_b16 v[228:229], v8 offset:30720
    ds_read_b64_tr_b16 v[230:231], v8 offset:31232
    s_waitcnt lgkmcnt(8)
    v_mfma_f32_32x32x16_bf16 v[192:207], v[232:235], v[32:35], v[192:207]
    ds_read_b64_tr_b16 v[232:233], v8 offset:14336
    ds_read_b64_tr_b16 v[234:235], v8 offset:14848
    v_mfma_f32_32x32x16_bf16 v[208:223], v[236:239], v[32:35], v[208:223]
    ds_read_b64_tr_b16 v[236:237], v8 offset:32768
    ds_read_b64_tr_b16 v[238:239], v8 offset:33280
    s_waitcnt lgkmcnt(8)
    v_mfma_f32_32x32x16_bf16 v[192:207], v[240:243], v[36:39], v[192:207]
    ds_read_b64_tr_b16 v[240:241], v8 offset:16384
    ds_read_b64_tr_b16 v[242:243], v8 offset:16896
    v_mfma_f32_32x32x16_bf16 v[208:223], v[244:247], v[36:39], v[208:223]
    ds_read_b64_tr_b16 v[244:245], v8 offset:34816
    ds_read_b64_tr_b16 v[246:247], v8 offset:35328
    s_waitcnt lgkmcnt(8)
    v_mfma_f32_32x32x16_bf16 v[192:207], v[224:227], v[40:43], v[192:207]
    v_add_u32 v9, 36864, v7
    ds_read_b64_tr_b16 v[224:225], v9 offset:0
    ds_read_b64_tr_b16 v[226:227], v9 offset:512
    v_mfma_f32_32x32x16_bf16 v[208:223], v[228:231], v[40:43], v[208:223]
    ds_read_b64_tr_b16 v[228:229], v9 offset:18432
    ds_read_b64_tr_b16 v[230:231], v9 offset:18944
    s_waitcnt lgkmcnt(8)
    v_mfma_f32_32x32x16_bf16 v[192:207], v[232:235], v[44:47], v[192:207]
    ds_read_b64_tr_b16 v[232:233], v9 offset:2048
    ds_read_b64_tr_b16 v[234:235], v9 offset:2560
    v_mfma_f32_32x32x16_bf16 v[208:223], v[236:239], v[44:47], v[208:223]
    ds_read_b64_tr_b16 v[236:237], v9 offset:20480
    ds_read_b64_tr_b16 v[238:239], v9 offset:20992
    s_waitcnt lgkmcnt(8)
    v_mfma_f32_32x32x16_bf16 v[192:207], v[240:243], v[48:51], v[192:207]
    ds_read_b64_tr_b16 v[240:241], v9 offset:4096
    ds_read_b64_tr_b16 v[242:243], v9 offset:4608
    v_mfma_f32_32x32x16_bf16 v[208:223], v[244:247], v[48:51], v[208:223]
    ds_read_b64_tr_b16 v[244:245], v9 offset:22528
    ds_read_b64_tr_b16 v[246:247], v9 offset:23040
    s_waitcnt lgkmcnt(8)
    v_mfma_f32_32x32x16_bf16 v[192:207], v[224:227], v[52:55], v[192:207]
    ds_read_b64_tr_b16 v[224:225], v9 offset:6144
    ds_read_b64_tr_b16 v[226:227], v9 offset:6656
    v_mfma_f32_32x32x16_bf16 v[208:223], v[228:231], v[52:55], v[208:223]
    ds_read_b64_tr_b16 v[228:229], v9 offset:24576
    ds_read_b64_tr_b16 v[230:231], v9 offset:25088
    s_waitcnt lgkmcnt(8)
    v_mfma_f32_32x32x16_bf16 v[192:207], v[232:235], v[56:59], v[192:207]
    ds_read_b64_tr_b16 v[232:233], v9 offset:8192
    ds_read_b64_tr_b16 v[234:235], v9 offset:8704
    v_mfma_f32_32x32x16_bf16 v[208:223], v[236:239], v[56:59], v[208:223]
    ds_read_b64_tr_b16 v[236:237], v9 offset:26624
    ds_read_b64_tr_b16 v[238:239], v9 offset:27136
    s_waitcnt lgkmcnt(8)
    v_mfma_f32_32x32x16_bf16 v[192:207], v[240:243], v[60:63], v[192:207]
    ds_read_b64_tr_b16 v[240:241], v9 offset:10240
    ds_read_b64_tr_b16 v[242:243], v9 offset:10752
    v_mfma_f32_32x32x16_bf16 v[208:223], v[244:247], v[60:63], v[208:223]
    ds_read_b64_tr_b16 v[244:245], v9 offset:28672
    ds_read_b64_tr_b16 v[246:247], v9 offset:29184
    s_waitcnt lgkmcnt(8)
    v_mfma_f32_32x32x16_bf16 v[192:207], v[224:227], v[64:67], v[192:207]
    ds_read_b64_tr_b16 v[224:225], v9 offset:12288
    ds_read_b64_tr_b16 v[226:227], v9 offset:12800
    v_mfma_f32_32x32x16_bf16 v[208:223], v[228:231], v[64:67], v[208:223]
    ds_read_b64_tr_b16 v[228:229], v9 offset:30720
    ds_read_b64_tr_b16 v[230:231], v9 offset:31232
    s_waitcnt lgkmcnt(8)
    v_mfma_f32_32x32x16_bf16 v[192:207], v[232:235], v[68:71], v[192:207]
    ds_read_b64_tr_b16 v[232:233], v9 offset:14336
    ds_read_b64_tr_b16 v[234:235], v9 offset:14848
    v_mfma_f32_32x32x16_bf16 v[208:223], v[236:239], v[68:71], v[208:223]
    ds_read_b64_tr_b16 v[236:237], v9 offset:32768
    ds_read_b64_tr_b16 v[238:239], v9 offset:33280
    s_waitcnt lgkmcnt(8)
    v_mfma_f32_32x32x16_bf16 v[192:207], v[240:243], v[72:75], v[192:207]
    ds_read_b64_tr_b16 v[240:241], v9 offset:16384
    ds_read_b64_tr_b16 v[242:243], v9 offset:16896
    v_mfma_f32_32x32x16_bf16 v[208:223], v[244:247], v[72:75], v[208:223]
    ds_read_b64_tr_b16 v[244:245], v9 offset:34816
    ds_read_b64_tr_b16 v[246:247], v9 offset:35328
    s_waitcnt lgkmcnt(8)
    v_mfma_f32_32x32x16_bf16 v[192:207], v[224:227], v[76:79], v[192:207]
    s_barrier
    v_add_u32 v8, 73728, v6
    ds_read_b64_tr_b16 v[224:225], v8 offset:0
    ds_read_b64_tr_b16 v[226:227], v8 offset:512
    v_mfma_f32_32x32x16_bf16 v[208:223], v[228:231], v[76:79], v[208:223]
    ds_read_b64_tr_b16 v[228:229], v8 offset:18432
    ds_read_b64_tr_b16 v[230:231], v8 offset:18944
    s_waitcnt lgkmcnt(8)
    v_mfma_f32_32x32x16_bf16 v[192:207], v[232:235], v[80:83], v[192:207]
    ds_read_b64_tr_b16 v[232:233], v8 offset:2048
    ds_read_b64_tr_b16 v[234:235], v8 offset:2560
    v_mfma_f32_32x32x16_bf16 v[208:223], v[236:239], v[80:83], v[208:223]
    ds_read_b64_tr_b16 v[236:237], v8 offset:20480
    ds_read_b64_tr_b16 v[238:239], v8 offset:20992
    s_waitcnt lgkmcnt(8)
    v_mfma_f32_32x32x16_bf16 v[192:207], v[240:243], v[84:87], v[192:207]
    ds_read_b64_tr_b16 v[240:241], v8 offset:4096
    ds_read_b64_tr_b16 v[242:243], v8 offset:4608
    v_mfma_f32_32x32x16_bf16 v[208:223], v[244:247], v[84:87], v[208:223]
    ds_read_b64_tr_b16 v[244:245], v8 offset:22528
    ds_read_b64_tr_b16 v[246:247], v8 offset:23040
k1_kernel_q2:
    s_waitcnt lgkmcnt(8)
    v_mfma_f32_32x32x16_bf16 v[160:175], v[224:227], v[88:91], v[160:175]
    ds_read_b64_tr_b16 v[224:225], v8 offset:6144
    ds_read_b64_tr_b16 v[226:227], v8 offset:6656
    v_mfma_f32_32x32x16_bf16 v[176:191], v[228:231], v[88:91], v[176:191]
    ds_read_b64_tr_b16 v[228:229], v8 offset:24576
    ds_read_b64_tr_b16 v[230:231], v8 offset:25088
    s_waitcnt lgkmcnt(8)
    v_mfma_f32_32x32x16_bf16 v[160:175], v[232:235], v[92:95], v[160:175]
    ds_read_b64_tr_b16 v[232:233], v8 offset:8192
    ds_read_b64_tr_b16 v[234:235], v8 offset:8704
    v_mfma_f32_32x32x16_bf16 v[176:191], v[236:239], v[92:95], v[176:191]
    ds_read_b64_tr_b16 v[236:237], v8 offset:26624
    ds_read_b64_tr_b16 v[238:239], v8 offset:27136
    s_waitcnt lgkmcnt(8)
    v_mfma_f32_32x32x16_bf16 v[160:175], v[240:243], v[96:99], v[160:175]
    ds_read_b64_tr_b16 v[240:241], v8 offset:10240
    ds_read_b64_tr_b16 v[242:243], v8 offset:10752
    v_mfma_f32_32x32x16_bf16 v[176:191], v[244:247], v[96:99], v[176:191]
    ds_read_b64_tr_b16 v[244:245], v8 offset:28672
    ds_read_b64_tr_b16 v[246:247], v8 offset:29184
    s_waitcnt lgkmcnt(8)
    v_mfma_f32_32x32x16_bf16 v[160:175], v[224:227], v[100:103], v[160:175]
    ds_read_b64_tr_b16 v[224:225], v8 offset:12288
    ds_read_b64_tr_b16 v[226:227], v8 offset:12800
    v_mfma_f32_32x32x16_bf16 v[176:191], v[228:231], v[100:103], v[176:191]
    ds_read_b64_tr_b16 v[228:229], v8 offset:30720
    ds_read_b64_tr_b16 v[230:231], v8 offset:31232
    s_waitcnt lgkmcnt(8)
    v_mfma_f32_32x32x16_bf16 v[160:175], v[232:235], v[104:107], v[160:175]
    ds_read_b64_tr_b16 v[232:233], v8 offset:14336
    ds_read_b64_tr_b16 v[234:235], v8 offset:14848
    v_mfma_f32_32x32x16_bf16 v[176:191], v[236:239], v[104:107], v[176:191]
    ds_read_b64_tr_b16 v[236:237], v8 offset:32768
    ds_read_b64_tr_b16 v[238:239], v8 offset:33280
    s_waitcnt lgkmcnt(8)
    v_mfma_f32_32x32x16_bf16 v[160:175], v[240:243], v[108:111], v[160:175]
    ds_read_b64_tr_b16 v[240:241], v8 offset:16384
    ds_read_b64_tr_b16 v[242:243], v8 offset:16896
    v_mfma_f32_32x32x16_bf16 v[176:191], v[244:247], v[108:111], v[176:191]
    ds_read_b64_tr_b16 v[244:245], v8 offset:34816
    ds_read_b64_tr_b16 v[246:247], v8 offset:35328
    s_waitcnt lgkmcnt(8)
    v_mfma_f32_32x32x16_bf16 v[160:175], v[224:227], v[112:115], v[160:175]
    s_barrier
    v_add_u32 v9, 110592, v6
    ds_read_b64_tr_b16 v[224:225], v9 offset:0
    ds_read_b64_tr_b16 v[226:227], v9 offset:512
    v_mfma_f32_32x32x16_bf16 v[176:191], v[228:231], v[112:115], v[176:191]
    ds_read_b64_tr_b16 v[228:229], v9 offset:18432
    ds_read_b64_tr_b16 v[230:231], v9 offset:18944
    s_waitcnt lgkmcnt(8)
    v_mfma_f32_32x32x16_bf16 v[160:175], v[232:235], v[116:119], v[160:175]
    ds_read_b64_tr_b16 v[232:233], v9 offset:2048
    ds_read_b64_tr_b16 v[234:235], v9 offset:2560
    v_mfma_f32_32x32x16_bf16 v[176:191], v[236:239], v[116:119], v[176:191]
    ds_read_b64_tr_b16 v[236:237], v9 offset:20480
    ds_read_b64_tr_b16 v[238:239], v9 offset:20992
    s_waitcnt lgkmcnt(8)
    v_mfma_f32_32x32x16_bf16 v[160:175], v[240:243], v[120:123], v[160:175]
    ds_read_b64_tr_b16 v[240:241], v9 offset:4096
    ds_read_b64_tr_b16 v[242:243], v9 offset:4608
    v_mfma_f32_32x32x16_bf16 v[176:191], v[244:247], v[120:123], v[176:191]
    ds_read_b64_tr_b16 v[244:245], v9 offset:22528
    ds_read_b64_tr_b16 v[246:247], v9 offset:23040
    s_waitcnt lgkmcnt(8)
    v_mfma_f32_32x32x16_bf16 v[160:175], v[224:227], v[124:127], v[160:175]
    ds_read_b64_tr_b16 v[224:225], v9 offset:6144
    ds_read_b64_tr_b16 v[226:227], v9 offset:6656
    v_mfma_f32_32x32x16_bf16 v[176:191], v[228:231], v[124:127], v[176:191]
    ds_read_b64_tr_b16 v[228:229], v9 offset:24576
    ds_read_b64_tr_b16 v[230:231], v9 offset:25088
    s_waitcnt lgkmcnt(8)
    v_mfma_f32_32x32x16_bf16 v[160:175], v[232:235], v[128:131], v[160:175]
    ds_read_b64_tr_b16 v[232:233], v9 offset:8192
    ds_read_b64_tr_b16 v[234:235], v9 offset:8704
    v_mfma_f32_32x32x16_bf16 v[176:191], v[236:239], v[128:131], v[176:191]
    ds_read_b64_tr_b16 v[236:237], v9 offset:26624
    ds_read_b64_tr_b16 v[238:239], v9 offset:27136
    s_waitcnt lgkmcnt(8)
    v_mfma_f32_32x32x16_bf16 v[160:175], v[240:243], v[132:135], v[160:175]
    ds_read_b64_tr_b16 v[240:241], v9 offset:10240
    ds_read_b64_tr_b16 v[242:243], v9 offset:10752
    v_mfma_f32_32x32x16_bf16 v[176:191], v[244:247], v[132:135], v[176:191]
    ds_read_b64_tr_b16 v[244:245], v9 offset:28672
    ds_read_b64_tr_b16 v[246:247], v9 offset:29184
    s_waitcnt lgkmcnt(8)
    v_mfma_f32_32x32x16_bf16 v[160:175], v[224:227], v[136:139], v[160:175]
    ds_read_b64_tr_b16 v[224:225], v9 offset:12288
    ds_read_b64_tr_b16 v[226:227], v9 offset:12800
    v_mfma_f32_32x32x16_bf16 v[176:191], v[228:231], v[136:139], v[176:191]
    ds_read_b64_tr_b16 v[228:229], v9 offset:30720
    ds_read_b64_tr_b16 v[230:231], v9 offset:31232
    s_waitcnt lgkmcnt(8)
    v_mfma_f32_32x32x16_bf16 v[160:175], v[232:235], v[140:143], v[160:175]
    ds_read_b64_tr_b16 v[232:233], v9 offset:14336
    ds_read_b64_tr_b16 v[234:235], v9 offset:14848
    v_mfma_f32_32x32x16_bf16 v[176:191], v[236:239], v[140:143], v[176:191]
    ds_read_b64_tr_b16 v[236:237], v9 offset:32768
    ds_read_b64_tr_b16 v[238:239], v9 offset:33280
    s_waitcnt lgkmcnt(8)
    v_mfma_f32_32x32x16_bf16 v[160:175], v[240:243], v[144:147], v[160:175]
    ds_read_b64_tr_b16 v[240:241], v9 offset:16384
    ds_read_b64_tr_b16 v[242:243], v9 offset:16896
    v_mfma_f32_32x32x16_bf16 v[176:191], v[244:247], v[144:147], v[176:191]
    ds_read_b64_tr_b16 v[244:245], v9 offset:34816
    ds_read_b64_tr_b16 v[246:247], v9 offset:35328
    s_waitcnt lgkmcnt(8)
    v_mfma_f32_32x32x16_bf16 v[160:175], v[224:227], v[148:151], v[160:175]
    v_add_u32 v8, 73728, v7
    ds_read_b64_tr_b16 v[224:225], v8 offset:0
    ds_read_b64_tr_b16 v[226:227], v8 offset:512
    v_mfma_f32_32x32x16_bf16 v[176:191], v[228:231], v[148:151], v[176:191]
    ds_read_b64_tr_b16 v[228:229], v8 offset:18432
    ds_read_b64_tr_b16 v[230:231], v8 offset:18944
    s_waitcnt lgkmcnt(8)
    v_mfma_f32_32x32x16_bf16 v[160:175], v[232:235], v[152:155], v[160:175]
    ds_read_b64_tr_b16 v[232:233], v8 offset:2048
    ds_read_b64_tr_b16 v[234:235], v8 offset:2560
    v_mfma_f32_32x32x16_bf16 v[176:191], v[236:239], v[152:155], v[176:191]
    ds_read_b64_tr_b16 v[236:237], v8 offset:20480
    ds_read_b64_tr_b16 v[238:239], v8 offset:20992
    s_waitcnt lgkmcnt(8)
    v_mfma_f32_32x32x16_bf16 v[160:175], v[240:243], v[156:159], v[160:175]
    ds_read_b64_tr_b16 v[240:241], v8 offset:4096
    ds_read_b64_tr_b16 v[242:243], v8 offset:4608
    v_mfma_f32_32x32x16_bf16 v[176:191], v[244:247], v[156:159], v[176:191]
    ds_read_b64_tr_b16 v[244:245], v8 offset:22528
    ds_read_b64_tr_b16 v[246:247], v8 offset:23040
    s_waitcnt lgkmcnt(8)
    v_mfma_f32_32x32x16_bf16 v[192:207], v[224:227], v[88:91], v[192:207]
    ds_read_b64_tr_b16 v[224:225], v8 offset:6144
    ds_read_b64_tr_b16 v[226:227], v8 offset:6656
    v_mfma_f32_32x32x16_bf16 v[208:223], v[228:231], v[88:91], v[208:223]
    ds_read_b64_tr_b16 v[228:229], v8 offset:24576
    ds_read_b64_tr_b16 v[230:231], v8 offset:25088
    s_waitcnt lgkmcnt(8)
    v_mfma_f32_32x32x16_bf16 v[192:207], v[232:235], v[92:95], v[192:207]
    ds_read_b64_tr_b16 v[232:233], v8 offset:8192
    ds_read_b64_tr_b16 v[234:235], v8 offset:8704
    v_mfma_f32_32x32x16_bf16 v[208:223], v[236:239], v[92:95], v[208:223]
    ds_read_b64_tr_b16 v[236:237], v8 offset:26624
    ds_read_b64_tr_b16 v[238:239], v8 offset:27136
    v_exp_f32 v248, -v160
    v_exp_f32 v249, -v161
    v_mul_f32 v176, v160, v176
    s_waitcnt lgkmcnt(8)
    v_mfma_f32_32x32x16_bf16 v[192:207], v[240:243], v[96:99], v[192:207]
    ds_read_b64_tr_b16 v[240:241], v8 offset:10240
    ds_read_b64_tr_b16 v[242:243], v8 offset:10752
    v_mul_f32 v177, v161, v177
    v_add_f32 v248, 1.0, v248
    v_add_f32 v249, 1.0, v249
    v_mfma_f32_32x32x16_bf16 v[208:223], v[244:247], v[96:99], v[208:223]
    ds_read_b64_tr_b16 v[244:245], v8 offset:28672
    ds_read_b64_tr_b16 v[246:247], v8 offset:29184
    v_rcp_f32 v248, v248
    v_rcp_f32 v249, v249
    s_nop 0
    s_waitcnt lgkmcnt(8)
    v_mfma_f32_32x32x16_bf16 v[192:207], v[224:227], v[100:103], v[192:207]
    ds_read_b64_tr_b16 v[224:225], v8 offset:12288
    ds_read_b64_tr_b16 v[226:227], v8 offset:12800
    v_mul_f32 v160, v176, v248
    v_mul_f32 v161, v177, v249
    v_exp_f32 v250, -v162
    v_mfma_f32_32x32x16_bf16 v[208:223], v[228:231], v[100:103], v[208:223]
    ds_read_b64_tr_b16 v[228:229], v8 offset:30720
    ds_read_b64_tr_b16 v[230:231], v8 offset:31232
    v_exp_f32 v251, -v163
    v_mul_f32 v178, v162, v178
    v_mul_f32 v179, v163, v179
    s_waitcnt lgkmcnt(8)
    v_mfma_f32_32x32x16_bf16 v[192:207], v[232:235], v[104:107], v[192:207]
    ds_read_b64_tr_b16 v[232:233], v8 offset:14336
    ds_read_b64_tr_b16 v[234:235], v8 offset:14848
    v_add_f32 v250, 1.0, v250
    v_add_f32 v251, 1.0, v251
    v_rcp_f32 v250, v250
    v_mfma_f32_32x32x16_bf16 v[208:223], v[236:239], v[104:107], v[208:223]
    ds_read_b64_tr_b16 v[236:237], v8 offset:32768
    ds_read_b64_tr_b16 v[238:239], v8 offset:33280
    v_rcp_f32 v251, v251
    v_cvt_pk_bf16_f32 v176, v160, v161
    v_mul_f32 v162, v178, v250
    s_waitcnt lgkmcnt(8)
    v_mfma_f32_32x32x16_bf16 v[192:207], v[240:243], v[108:111], v[192:207]
    ds_read_b64_tr_b16 v[240:241], v8 offset:16384
    ds_read_b64_tr_b16 v[242:243], v8 offset:16896
    v_mul_f32 v163, v179, v251
    v_exp_f32 v252, -v164
    v_exp_f32 v253, -v165
    v_mfma_f32_32x32x16_bf16 v[208:223], v[244:247], v[108:111], v[208:223]
    ds_read_b64_tr_b16 v[244:245], v8 offset:34816
    ds_read_b64_tr_b16 v[246:247], v8 offset:35328
    v_mul_f32 v180, v164, v180
    v_mul_f32 v181, v165, v181
    v_add_f32 v252, 1.0, v252
    s_waitcnt lgkmcnt(8)
    v_mfma_f32_32x32x16_bf16 v[192:207], v[224:227], v[112:115], v[192:207]
    v_add_u32 v9, 110592, v7
    ds_read_b64_tr_b16 v[224:225], v9 offset:0
    ds_read_b64_tr_b16 v[226:227], v9 offset:512
    v_add_f32 v253, 1.0, v253
    v_rcp_f32 v252, v252
    v_rcp_f32 v253, v253
    v_mfma_f32_32x32x16_bf16 v[208:223], v[228:231], v[112:115], v[208:223]
    ds_read_b64_tr_b16 v[228:229], v9 offset:18432
    ds_read_b64_tr_b16 v[230:231], v9 offset:18944
    v_cvt_pk_bf16_f32 v177, v162, v163
    v_mul_f32 v164, v180, v252
    v_mul_f32 v165, v181, v253
    s_waitcnt lgkmcnt(8)
    v_mfma_f32_32x32x16_bf16 v[192:207], v[232:235], v[116:119], v[192:207]
    ds_read_b64_tr_b16 v[232:233], v9 offset:2048
    ds_read_b64_tr_b16 v[234:235], v9 offset:2560
    v_exp_f32 v254, -v166
    v_exp_f32 v255, -v167
    v_mul_f32 v182, v166, v182
    v_mfma_f32_32x32x16_bf16 v[208:223], v[236:239], v[116:119], v[208:223]
    ds_read_b64_tr_b16 v[236:237], v9 offset:20480
    ds_read_b64_tr_b16 v[238:239], v9 offset:20992
    v_mul_f32 v183, v167, v183
    v_add_f32 v254, 1.0, v254
    v_add_f32 v255, 1.0, v255
    s_waitcnt lgkmcnt(8)
    v_mfma_f32_32x32x16_bf16 v[192:207], v[240:243], v[120:123], v[192:207]
    ds_read_b64_tr_b16 v[240:241], v9 offset:4096
    ds_read_b64_tr_b16 v[242:243], v9 offset:4608
    v_rcp_f32 v254, v254
    v_rcp_f32 v255, v255
    v_cvt_pk_bf16_f32 v178, v164, v165
    v_mfma_f32_32x32x16_bf16 v[208:223], v[244:247], v[120:123], v[208:223]
    ds_read_b64_tr_b16 v[244:245], v9 offset:22528
    ds_read_b64_tr_b16 v[246:247], v9 offset:23040
    v_mul_f32 v166, v182, v254
    v_mul_f32 v167, v183, v255
    v_exp_f32 v248, -v168
    s_waitcnt lgkmcnt(8)
    v_mfma_f32_32x32x16_bf16 v[192:207], v[224:227], v[124:127], v[192:207]
    ds_read_b64_tr_b16 v[224:225], v9 offset:6144
    ds_read_b64_tr_b16 v[226:227], v9 offset:6656
    v_exp_f32 v249, -v169
    v_mul_f32 v184, v168, v184
    v_mul_f32 v185, v169, v185
    v_mfma_f32_32x32x16_bf16 v[208:223], v[228:231], v[124:127], v[208:223]
    ds_read_b64_tr_b16 v[228:229], v9 offset:24576
    ds_read_b64_tr_b16 v[230:231], v9 offset:25088
    v_add_f32 v248, 1.0, v248
    v_add_f32 v249, 1.0, v249
    v_rcp_f32 v248, v248
    s_waitcnt lgkmcnt(8)
    v_mfma_f32_32x32x16_bf16 v[192:207], v[232:235], v[128:131], v[192:207]
    ds_read_b64_tr_b16 v[232:233], v9 offset:8192
    ds_read_b64_tr_b16 v[234:235], v9 offset:8704
    v_rcp_f32 v249, v249
    v_cvt_pk_bf16_f32 v179, v166, v167
    v_mul_f32 v168, v184, v248
    v_mfma_f32_32x32x16_bf16 v[208:223], v[236:239], v[128:131], v[208:223]
    ds_read_b64_tr_b16 v[236:237], v9 offset:26624
    ds_read_b64_tr_b16 v[238:239], v9 offset:27136
    v_mul_f32 v169, v185, v249
    buffer_store_dwordx4 v[176:179], v11, s[28:31], s49 offen sc0 sc1
    v_exp_f32 v250, -v170
    s_waitcnt lgkmcnt(8)
    v_mfma_f32_32x32x16_bf16 v[192:207], v[240:243], v[132:135], v[192:207]
    ds_read_b64_tr_b16 v[240:241], v9 offset:10240
    ds_read_b64_tr_b16 v[242:243], v9 offset:10752
    v_exp_f32 v251, -v171
    v_mul_f32 v186, v170, v186
    v_mul_f32 v187, v171, v187
    v_mfma_f32_32x32x16_bf16 v[208:223], v[244:247], v[132:135], v[208:223]
    ds_read_b64_tr_b16 v[244:245], v9 offset:28672
    ds_read_b64_tr_b16 v[246:247], v9 offset:29184
    v_add_f32 v250, 1.0, v250
    v_add_f32 v251, 1.0, v251
    v_rcp_f32 v250, v250
    s_waitcnt lgkmcnt(8)
    v_mfma_f32_32x32x16_bf16 v[192:207], v[224:227], v[136:139], v[192:207]
    ds_read_b64_tr_b16 v[224:225], v9 offset:12288
    ds_read_b64_tr_b16 v[226:227], v9 offset:12800
    v_rcp_f32 v251, v251
    v_cvt_pk_bf16_f32 v180, v168, v169
    v_mul_f32 v170, v186, v250
    v_mfma_f32_32x32x16_bf16 v[208:223], v[228:231], v[136:139], v[208:223]
    ds_read_b64_tr_b16 v[228:229], v9 offset:30720
    ds_read_b64_tr_b16 v[230:231], v9 offset:31232
    v_mul_f32 v171, v187, v251
    v_exp_f32 v252, -v172
    v_exp_f32 v253, -v173
    s_waitcnt lgkmcnt(8)
    v_mfma_f32_32x32x16_bf16 v[192:207], v[232:235], v[140:143], v[192:207]
    ds_read_b64_tr_b16 v[232:233], v9 offset:14336
    ds_read_b64_tr_b16 v[234:235], v9 offset:14848
    v_mul_f32 v188, v172, v188
    v_mul_f32 v189, v173, v189
    v_add_f32 v252, 1.0, v252
    v_mfma_f32_32x32x16_bf16 v[208:223], v[236:239], v[140:143], v[208:223]
    ds_read_b64_tr_b16 v[236:237], v9 offset:32768
    ds_read_b64_tr_b16 v[238:239], v9 offset:33280
    v_add_f32 v253, 1.0, v253
    v_rcp_f32 v252, v252
    v_rcp_f32 v253, v253
    s_waitcnt lgkmcnt(8)
    v_mfma_f32_32x32x16_bf16 v[192:207], v[240:243], v[144:147], v[192:207]
    ds_read_b64_tr_b16 v[240:241], v9 offset:16384
    ds_read_b64_tr_b16 v[242:243], v9 offset:16896
    v_cvt_pk_bf16_f32 v181, v170, v171
    v_mul_f32 v172, v188, v252
    v_mul_f32 v173, v189, v253
    v_mfma_f32_32x32x16_bf16 v[208:223], v[244:247], v[144:147], v[208:223]
    ds_read_b64_tr_b16 v[244:245], v9 offset:34816
    ds_read_b64_tr_b16 v[246:247], v9 offset:35328
    v_exp_f32 v254, -v174
    v_exp_f32 v255, -v175
    v_mul_f32 v190, v174, v190
    s_waitcnt lgkmcnt(8)
    v_mfma_f32_32x32x16_bf16 v[192:207], v[224:227], v[148:151], v[192:207]
    s_barrier
    v_add_u32 v8, 0, v6
    ds_read_b64_tr_b16 v[224:225], v8 offset:0
    ds_read_b64_tr_b16 v[226:227], v8 offset:512
    v_mul_f32 v191, v175, v191
    v_add_f32 v254, 1.0, v254
    v_add_f32 v255, 1.0, v255
    v_mfma_f32_32x32x16_bf16 v[208:223], v[228:231], v[148:151], v[208:223]
    ds_read_b64_tr_b16 v[228:229], v8 offset:18432
    ds_read_b64_tr_b16 v[230:231], v8 offset:18944
    v_rcp_f32 v254, v254
    v_rcp_f32 v255, v255
    v_cvt_pk_bf16_f32 v182, v172, v173
    s_waitcnt lgkmcnt(8)
    v_mfma_f32_32x32x16_bf16 v[192:207], v[232:235], v[152:155], v[192:207]
    ds_read_b64_tr_b16 v[232:233], v8 offset:2048
    ds_read_b64_tr_b16 v[234:235], v8 offset:2560
    v_mul_f32 v174, v190, v254
    v_mul_f32 v175, v191, v255
    v_cvt_pk_bf16_f32 v183, v174, v175
    v_mfma_f32_32x32x16_bf16 v[208:223], v[236:239], v[152:155], v[208:223]
    ds_read_b64_tr_b16 v[236:237], v8 offset:20480
    ds_read_b64_tr_b16 v[238:239], v8 offset:20992
    buffer_store_dwordx4 v[180:183], v11, s[28:31], s49 offen offset:1024 sc0 sc1
    s_add_u32 s49, s49, 2048
    s_waitcnt lgkmcnt(8)
    v_mfma_f32_32x32x16_bf16 v[192:207], v[240:243], v[156:159], v[192:207]
    ds_read_b64_tr_b16 v[240:241], v8 offset:4096
    ds_read_b64_tr_b16 v[242:243], v8 offset:4608
    v_mfma_f32_32x32x16_bf16 v[208:223], v[244:247], v[156:159], v[208:223]
    ds_read_b64_tr_b16 v[244:245], v8 offset:22528
    ds_read_b64_tr_b16 v[246:247], v8 offset:23040
    s_sub_u32 s46, s46, 1
    s_cmp_lg_u32 s46, 0
    s_cbranch_scc1 k1_kernel_quadloop
    s_lshl_b32 s50, s43, 1
    s_mov_b32 s32, 2359296
    s_mov_b32 s33, 4718592
    s_mov_b32 s36, 0x3e715bef
    s_mov_b32 s37, 0x3f317218
    s_cmp_ge_u32 s50, 36
    s_cbranch_scc1 k1_kernel_v_2
    s_waitcnt lgkmcnt(8)
    v_mfma_f32_32x32x16_bf16 v[160:175], v[224:227], v[16:19], 0
    ds_read_b64_tr_b16 v[224:225], v8 offset:6144
    ds_read_b64_tr_b16 v[226:227], v8 offset:6656
    v_mfma_f32_32x32x16_bf16 v[160:175], v[228:231], v[52:55], v[160:175]
    ds_read_b64_tr_b16 v[228:229], v8 offset:24576
    ds_read_b64_tr_b16 v[230:231], v8 offset:25088
    s_waitcnt lgkmcnt(8)
    v_mfma_f32_32x32x16_bf16 v[160:175], v[232:235], v[20:23], v[160:175]
    ds_read_b64_tr_b16 v[232:233], v8 offset:8192
    ds_read_b64_tr_b16 v[234:235], v8 offset:8704
    v_mfma_f32_32x32x16_bf16 v[160:175], v[236:239], v[56:59], v[160:175]
    ds_read_b64_tr_b16 v[236:237], v8 offset:26624
    ds_read_b64_tr_b16 v[238:239], v8 offset:27136
    v_exp_f32 v248, -v192
    v_exp_f32 v249, -v193
    v_mul_f32 v208, v192, v208
    v_mul_f32 v209, v193, v209
    s_waitcnt lgkmcnt(8)
    v_mfma_f32_32x32x16_bf16 v[160:175], v[240:243], v[24:27], v[160:175]
    ds_read_b64_tr_b16 v[240:241], v8 offset:10240
    ds_read_b64_tr_b16 v[242:243], v8 offset:10752
    v_add_f32 v248, 1.0, v248
    v_add_f32 v249, 1.0, v249
    v_rcp_f32 v248, v248
    v_mfma_f32_32x32x16_bf16 v[160:175], v[244:247], v[60:63], v[160:175]
    ds_read_b64_tr_b16 v[244:245], v8 offset:28672
    ds_read_b64_tr_b16 v[246:247], v8 offset:29184
    v_rcp_f32 v249, v249
    s_nop 0
    v_mul_f32 v192, v208, v248
    v_mul_f32 v193, v209, v249
    s_waitcnt lgkmcnt(8)
    v_mfma_f32_32x32x16_bf16 v[160:175], v[224:227], v[28:31], v[160:175]
    ds_read_b64_tr_b16 v[224:225], v8 offset:12288
    ds_read_b64_tr_b16 v[226:227], v8 offset:12800
    v_exp_f32 v250, -v194
    v_exp_f32 v251, -v195
    v_mul_f32 v210, v194, v210
    v_mfma_f32_32x32x16_bf16 v[160:175], v[228:231], v[64:67], v[160:175]
    ds_read_b64_tr_b16 v[228:229], v8 offset:30720
    ds_read_b64_tr_b16 v[230:231], v8 offset:31232
    v_mul_f32 v211, v195, v211
    v_add_f32 v250, 1.0, v250
    v_add_f32 v251, 1.0, v251
    v_rcp_f32 v250, v250
    s_waitcnt lgkmcnt(8)
    v_mfma_f32_32x32x16_bf16 v[160:175], v[232:235], v[32:35], v[160:175]
    ds_read_b64_tr_b16 v[232:233], v8 offset:14336
    ds_read_b64_tr_b16 v[234:235], v8 offset:14848
    v_rcp_f32 v251, v251
    v_cvt_pk_bf16_f32 v208, v192, v193
    v_mul_f32 v194, v210, v250
    v_mfma_f32_32x32x16_bf16 v[160:175], v[236:239], v[68:71], v[160:175]
    ds_read_b64_tr_b16 v[236:237], v8 offset:32768
    ds_read_b64_tr_b16 v[238:239], v8 offset:33280
    v_mul_f32 v195, v211, v251
    v_exp_f32 v252, -v196
    v_exp_f32 v253, -v197
    v_mul_f32 v212, v196, v212
    s_waitcnt lgkmcnt(8)
    v_mfma_f32_32x32x16_bf16 v[160:175], v[240:243], v[36:39], v[160:175]
    ds_read_b64_tr_b16 v[240:241], v8 offset:16384
    ds_read_b64_tr_b16 v[242:243], v8 offset:16896
    v_mul_f32 v213, v197, v213
    v_add_f32 v252, 1.0, v252
    v_add_f32 v253, 1.0, v253
    v_mfma_f32_32x32x16_bf16 v[160:175], v[244:247], v[72:75], v[160:175]
    ds_read_b64_tr_b16 v[244:245], v8 offset:34816
    ds_read_b64_tr_b16 v[246:247], v8 offset:35328
    v_rcp_f32 v252, v252
    v_rcp_f32 v253, v253
    v_cvt_pk_bf16_f32 v209, v194, v195
    v_mul_f32 v196, v212, v252
    s_waitcnt lgkmcnt(8)
    v_mfma_f32_32x32x16_bf16 v[160:175], v[224:227], v[40:43], v[160:175]
    s_barrier
    v_add_u32 v9, 36864, v6
    ds_read_b64_tr_b16 v[224:225], v9 offset:0
    ds_read_b64_tr_b16 v[226:227], v9 offset:512
    v_mul_f32 v197, v213, v253
    v_exp_f32 v254, -v198
    v_exp_f32 v255, -v199
    v_mfma_f32_32x32x16_bf16 v[160:175], v[228:231], v[76:79], v[160:175]
    ds_read_b64_tr_b16 v[228:229], v9 offset:18432
    ds_read_b64_tr_b16 v[230:231], v9 offset:18944
    v_mul_f32 v214, v198, v214
    v_mul_f32 v215, v199, v215
    v_add_f32 v254, 1.0, v254
    v_add_f32 v255, 1.0, v255
    s_waitcnt lgkmcnt(8)
    v_mfma_f32_32x32x16_bf16 v[160:175], v[232:235], v[44:47], v[160:175]
    ds_read_b64_tr_b16 v[232:233], v9 offset:2048
    ds_read_b64_tr_b16 v[234:235], v9 offset:2560
    v_rcp_f32 v254, v254
    v_rcp_f32 v255, v255
    v_cvt_pk_bf16_f32 v210, v196, v197
    v_mfma_f32_32x32x16_bf16 v[160:175], v[236:239], v[80:83], v[160:175]
    ds_read_b64_tr_b16 v[236:237], v9 offset:20480
    ds_read_b64_tr_b16 v[238:239], v9 offset:20992
    v_mul_f32 v198, v214, v254
    v_mul_f32 v199, v215, v255
    v_exp_f32 v248, -v200
    v_exp_f32 v249, -v201
    s_waitcnt lgkmcnt(8)
    v_mfma_f32_32x32x16_bf16 v[160:175], v[240:243], v[48:51], v[160:175]
    ds_read_b64_tr_b16 v[240:241], v9 offset:4096
    ds_read_b64_tr_b16 v[242:243], v9 offset:4608
    v_mul_f32 v216, v200, v216
    v_mul_f32 v217, v201, v217
    v_add_f32 v248, 1.0, v248
    v_mfma_f32_32x32x16_bf16 v[160:175], v[244:247], v[84:87], v[160:175]
    ds_read_b64_tr_b16 v[244:245], v9 offset:22528
    ds_read_b64_tr_b16 v[246:247], v9 offset:23040
    v_add_f32 v249, 1.0, v249
    v_rcp_f32 v248, v248
    v_rcp_f32 v249, v249
    v_cvt_pk_bf16_f32 v211, v198, v199
    s_waitcnt lgkmcnt(8)
    v_mfma_f32_32x32x16_bf16 v[160:175], v[224:227], v[88:91], v[160:175]
    ds_read_b64_tr_b16 v[224:225], v9 offset:6144
    ds_read_b64_tr_b16 v[226:227], v9 offset:6656
    v_mul_f32 v200, v216, v248
    v_mul_f32 v201, v217, v249
    buffer_store_dwordx4 v[208:211], v11, s[28:31], s49 offen sc0 sc1
    v_mfma_f32_32x32x16_bf16 v[160:175], v[228:231], v[124:127], v[160:175]
    ds_read_b64_tr_b16 v[228:229], v9 offset:24576
    ds_read_b64_tr_b16 v[230:231], v9 offset:25088
    v_exp_f32 v250, -v202
    v_exp_f32 v251, -v203
    v_mul_f32 v218, v202, v218
    v_mul_f32 v219, v203, v219
    s_waitcnt lgkmcnt(8)
    v_mfma_f32_32x32x16_bf16 v[160:175], v[232:235], v[92:95], v[160:175]
    ds_read_b64_tr_b16 v[232:233], v9 offset:8192
    ds_read_b64_tr_b16 v[234:235], v9 offset:8704
    v_add_f32 v250, 1.0, v250
    v_add_f32 v251, 1.0, v251
    v_rcp_f32 v250, v250
    v_mfma_f32_32x32x16_bf16 v[160:175], v[236:239], v[128:131], v[160:175]
    ds_read_b64_tr_b16 v[236:237], v9 offset:26624
    ds_read_b64_tr_b16 v[238:239], v9 offset:27136
    v_rcp_f32 v251, v251
    v_cvt_pk_bf16_f32 v212, v200, v201
    v_mul_f32 v202, v218, v250
    v_mul_f32 v203, v219, v251
    s_waitcnt lgkmcnt(8)
    v_mfma_f32_32x32x16_bf16 v[160:175], v[240:243], v[96:99], v[160:175]
    ds_read_b64_tr_b16 v[240:241], v9 offset:10240
    ds_read_b64_tr_b16 v[242:243], v9 offset:10752
    v_exp_f32 v252, -v204
    v_exp_f32 v253, -v205
    v_mul_f32 v220, v204, v220
    v_mfma_f32_32x32x16_bf16 v[160:175], v[244:247], v[132:135], v[160:175]
    ds_read_b64_tr_b16 v[244:245], v9 offset:28672
    ds_read_b64_tr_b16 v[246:247], v9 offset:29184
    v_mul_f32 v221, v205, v221
    v_add_f32 v252, 1.0, v252
    v_add_f32 v253, 1.0, v253
    v_rcp_f32 v252, v252
    s_waitcnt lgkmcnt(8)
    v_mfma_f32_32x32x16_bf16 v[160:175], v[224:227], v[100:103], v[160:175]
    ds_read_b64_tr_b16 v[224:225], v9 offset:12288
    ds_read_b64_tr_b16 v[226:227], v9 offset:12800
    v_rcp_f32 v253, v253
    v_cvt_pk_bf16_f32 v213, v202, v203
    v_mul_f32 v204, v220, v252
    v_mfma_f32_32x32x16_bf16 v[160:175], v[228:231], v[136:139], v[160:175]
    ds_read_b64_tr_b16 v[228:229], v9 offset:30720
    ds_read_b64_tr_b16 v[230:231], v9 offset:31232
    v_mul_f32 v205, v221, v253
    v_exp_f32 v254, -v206
    v_exp_f32 v255, -v207
    v_mul_f32 v222, v206, v222
    s_waitcnt lgkmcnt(8)
    v_mfma_f32_32x32x16_bf16 v[160:175], v[232:235], v[104:107], v[160:175]
    ds_read_b64_tr_b16 v[232:233], v9 offset:14336
    ds_read_b64_tr_b16 v[234:235], v9 offset:14848
    v_mul_f32 v223, v207, v223
    v_add_f32 v254, 1.0, v254
    v_add_f32 v255, 1.0, v255
    v_mfma_f32_32x32x16_bf16 v[160:175], v[236:239], v[140:143], v[160:175]
    ds_read_b64_tr_b16 v[236:237], v9 offset:32768
    ds_read_b64_tr_b16 v[238:239], v9 offset:33280
    v_rcp_f32 v254, v254
    v_rcp_f32 v255, v255
    v_cvt_pk_bf16_f32 v214, v204, v205
    v_mul_f32 v206, v222, v254
    s_waitcnt lgkmcnt(8)
    v_mfma_f32_32x32x16_bf16 v[160:175], v[240:243], v[108:111], v[160:175]
    ds_read_b64_tr_b16 v[240:241], v9 offset:16384
    ds_read_b64_tr_b16 v[242:243], v9 offset:16896
    v_mul_f32 v207, v223, v255
    v_cvt_pk_bf16_f32 v215, v206, v207
    buffer_store_dwordx4 v[212:215], v11, s[28:31], s49 offen offset:1024 sc0 sc1
    v_mfma_f32_32x32x16_bf16 v[160:175], v[244:247], v[144:147], v[160:175]
    ds_read_b64_tr_b16 v[244:245], v9 offset:34816
    ds_read_b64_tr_b16 v[246:247], v9 offset:35328
    s_add_u32 s49, s49, 2048
    s_cmp_ge_u32 s50, 36
    s_cselect_b32 s47, 36, 0
    s_cselect_b32 s48, 32, 65536
    s_waitcnt lgkmcnt(8)
    v_mfma_f32_32x32x16_bf16 v[160:175], v[224:227], v[112:115], v[160:175]
    v_add_u32 v8, 0, v7
    ds_read_b64_tr_b16 v[224:225], v8 offset:0
    ds_read_b64_tr_b16 v[226:227], v8 offset:512
    s_cselect_b32 s56, 0x600000, 0x0
    s_cselect_b32 s58, s32, s33
    s_cselect_b64 s[34:35], -1, 0
    v_mfma_f32_32x32x16_bf16 v[160:175], v[228:231], v[148:151], v[160:175]
    ds_read_b64_tr_b16 v[228:229], v8 offset:18432
    ds_read_b64_tr_b16 v[230:231], v8 offset:18944
    s_sub_u32 s52, s50, s47
    s_lshl_b32 s52, s52, 17
    s_add_u32 s53, s52, s48
    s_add_u32 s56, s12, s56
    s_waitcnt lgkmcnt(8)
    v_mfma_f32_32x32x16_bf16 v[160:175], v[232:235], v[116:119], v[160:175]
    ds_read_b64_tr_b16 v[232:233], v8 offset:2048
    ds_read_b64_tr_b16 v[234:235], v8 offset:2560
    s_addc_u32 s57, s13, 0
    s_mov_b32 s59, 0x20000
    v_cndmask_b32 v14, v12, v13, s[34:35]
    v_mfma_f32_32x32x16_bf16 v[160:175], v[236:239], v[152:155], v[160:175]
    ds_read_b64_tr_b16 v[236:237], v8 offset:20480
    ds_read_b64_tr_b16 v[238:239], v8 offset:20992
    s_cmp_lt_u32 s50, 18
    s_cselect_b32 s51, s36, s37
    s_add_u32 s50, s50, 1
    s_waitcnt lgkmcnt(8)
    v_mfma_f32_32x32x16_bf16 v[160:175], v[240:243], v[120:123], v[160:175]
    ds_read_b64_tr_b16 v[240:241], v8 offset:4096
    ds_read_b64_tr_b16 v[242:243], v8 offset:4608
    v_mfma_f32_32x32x16_bf16 v[160:175], v[244:247], v[156:159], v[160:175]
    ds_read_b64_tr_b16 v[244:245], v8 offset:22528
    ds_read_b64_tr_b16 v[246:247], v8 offset:23040
    s_branch k1_kernel_e_3
k1_kernel_v_2:
    s_waitcnt lgkmcnt(8)
    v_mfma_f32_32x32x16_bf16 v[160:175], v[16:19], v[224:227], 0
    ds_read_b64_tr_b16 v[224:225], v8 offset:6144
    ds_read_b64_tr_b16 v[226:227], v8 offset:6656
    v_mfma_f32_32x32x16_bf16 v[160:175], v[52:55], v[228:231], v[160:175]
    ds_read_b64_tr_b16 v[228:229], v8 offset:24576
    ds_read_b64_tr_b16 v[230:231], v8 offset:25088
    s_waitcnt lgkmcnt(8)
    v_mfma_f32_32x32x16_bf16 v[160:175], v[20:23], v[232:235], v[160:175]
    ds_read_b64_tr_b16 v[232:233], v8 offset:8192
    ds_read_b64_tr_b16 v[234:235], v8 offset:8704
    v_mfma_f32_32x32x16_bf16 v[160:175], v[56:59], v[236:239], v[160:175]
    ds_read_b64_tr_b16 v[236:237], v8 offset:26624
    ds_read_b64_tr_b16 v[238:239], v8 offset:27136
    v_exp_f32 v248, -v192
    v_exp_f32 v249, -v193
    v_mul_f32 v208, v192, v208
    v_mul_f32 v209, v193, v209
    s_waitcnt lgkmcnt(8)
    v_mfma_f32_32x32x16_bf16 v[160:175], v[24:27], v[240:243], v[160:175]
    ds_read_b64_tr_b16 v[240:241], v8 offset:10240
    ds_read_b64_tr_b16 v[242:243], v8 offset:10752
    v_add_f32 v248, 1.0, v248
    v_add_f32 v249, 1.0, v249
    v_rcp_f32 v248, v248
    v_mfma_f32_32x32x16_bf16 v[160:175], v[60:63], v[244:247], v[160:175]
    ds_read_b64_tr_b16 v[244:245], v8 offset:28672
    ds_read_b64_tr_b16 v[246:247], v8 offset:29184
    v_rcp_f32 v249, v249
    s_nop 0
    v_mul_f32 v192, v208, v248
    v_mul_f32 v193, v209, v249
    s_waitcnt lgkmcnt(8)
    v_mfma_f32_32x32x16_bf16 v[160:175], v[28:31], v[224:227], v[160:175]
    ds_read_b64_tr_b16 v[224:225], v8 offset:12288
    ds_read_b64_tr_b16 v[226:227], v8 offset:12800
    v_exp_f32 v250, -v194
    v_exp_f32 v251, -v195
    v_mul_f32 v210, v194, v210
    v_mfma_f32_32x32x16_bf16 v[160:175], v[64:67], v[228:231], v[160:175]
    ds_read_b64_tr_b16 v[228:229], v8 offset:30720
    ds_read_b64_tr_b16 v[230:231], v8 offset:31232
    v_mul_f32 v211, v195, v211
    v_add_f32 v250, 1.0, v250
    v_add_f32 v251, 1.0, v251
    v_rcp_f32 v250, v250
    s_waitcnt lgkmcnt(8)
    v_mfma_f32_32x32x16_bf16 v[160:175], v[32:35], v[232:235], v[160:175]
    ds_read_b64_tr_b16 v[232:233], v8 offset:14336
    ds_read_b64_tr_b16 v[234:235], v8 offset:14848
    v_rcp_f32 v251, v251
    v_cvt_pk_bf16_f32 v208, v192, v193
    v_mul_f32 v194, v210, v250
    v_mfma_f32_32x32x16_bf16 v[160:175], v[68:71], v[236:239], v[160:175]
    ds_read_b64_tr_b16 v[236:237], v8 offset:32768
    ds_read_b64_tr_b16 v[238:239], v8 offset:33280
    v_mul_f32 v195, v211, v251
    v_exp_f32 v252, -v196
    v_exp_f32 v253, -v197
    v_mul_f32 v212, v196, v212
    s_waitcnt lgkmcnt(8)
    v_mfma_f32_32x32x16_bf16 v[160:175], v[36:39], v[240:243], v[160:175]
    ds_read_b64_tr_b16 v[240:241], v8 offset:16384
    ds_read_b64_tr_b16 v[242:243], v8 offset:16896
    v_mul_f32 v213, v197, v213
    v_add_f32 v252, 1.0, v252
    v_add_f32 v253, 1.0, v253
    v_mfma_f32_32x32x16_bf16 v[160:175], v[72:75], v[244:247], v[160:175]
    ds_read_b64_tr_b16 v[244:245], v8 offset:34816
    ds_read_b64_tr_b16 v[246:247], v8 offset:35328
    v_rcp_f32 v252, v252
    v_rcp_f32 v253, v253
    v_cvt_pk_bf16_f32 v209, v194, v195
    v_mul_f32 v196, v212, v252
    s_waitcnt lgkmcnt(8)
    v_mfma_f32_32x32x16_bf16 v[160:175], v[40:43], v[224:227], v[160:175]
    s_barrier
    v_add_u32 v9, 36864, v6
    ds_read_b64_tr_b16 v[224:225], v9 offset:0
    ds_read_b64_tr_b16 v[226:227], v9 offset:512
    v_mul_f32 v197, v213, v253
    v_exp_f32 v254, -v198
    v_exp_f32 v255, -v199
    v_mfma_f32_32x32x16_bf16 v[160:175], v[76:79], v[228:231], v[160:175]
    ds_read_b64_tr_b16 v[228:229], v9 offset:18432
    ds_read_b64_tr_b16 v[230:231], v9 offset:18944
    v_mul_f32 v214, v198, v214
    v_mul_f32 v215, v199, v215
    v_add_f32 v254, 1.0, v254
    v_add_f32 v255, 1.0, v255
    s_waitcnt lgkmcnt(8)
    v_mfma_f32_32x32x16_bf16 v[160:175], v[44:47], v[232:235], v[160:175]
    ds_read_b64_tr_b16 v[232:233], v9 offset:2048
    ds_read_b64_tr_b16 v[234:235], v9 offset:2560
    v_rcp_f32 v254, v254
    v_rcp_f32 v255, v255
    v_cvt_pk_bf16_f32 v210, v196, v197
    v_mfma_f32_32x32x16_bf16 v[160:175], v[80:83], v[236:239], v[160:175]
    ds_read_b64_tr_b16 v[236:237], v9 offset:20480
    ds_read_b64_tr_b16 v[238:239], v9 offset:20992
    v_mul_f32 v198, v214, v254
    v_mul_f32 v199, v215, v255
    v_exp_f32 v248, -v200
    v_exp_f32 v249, -v201
    s_waitcnt lgkmcnt(8)
    v_mfma_f32_32x32x16_bf16 v[160:175], v[48:51], v[240:243], v[160:175]
    ds_read_b64_tr_b16 v[240:241], v9 offset:4096
    ds_read_b64_tr_b16 v[242:243], v9 offset:4608
    v_mul_f32 v216, v200, v216
    v_mul_f32 v217, v201, v217
    v_add_f32 v248, 1.0, v248
    v_mfma_f32_32x32x16_bf16 v[160:175], v[84:87], v[244:247], v[160:175]
    ds_read_b64_tr_b16 v[244:245], v9 offset:22528
    ds_read_b64_tr_b16 v[246:247], v9 offset:23040
    v_add_f32 v249, 1.0, v249
    v_rcp_f32 v248, v248
    v_rcp_f32 v249, v249
    v_cvt_pk_bf16_f32 v211, v198, v199
    s_waitcnt lgkmcnt(8)
    v_mfma_f32_32x32x16_bf16 v[160:175], v[88:91], v[224:227], v[160:175]
    ds_read_b64_tr_b16 v[224:225], v9 offset:6144
    ds_read_b64_tr_b16 v[226:227], v9 offset:6656
    v_mul_f32 v200, v216, v248
    v_mul_f32 v201, v217, v249
    buffer_store_dwordx4 v[208:211], v11, s[28:31], s49 offen sc0 sc1
    v_mfma_f32_32x32x16_bf16 v[160:175], v[124:127], v[228:231], v[160:175]
    ds_read_b64_tr_b16 v[228:229], v9 offset:24576
    ds_read_b64_tr_b16 v[230:231], v9 offset:25088
    v_exp_f32 v250, -v202
    v_exp_f32 v251, -v203
    v_mul_f32 v218, v202, v218
    v_mul_f32 v219, v203, v219
    s_waitcnt lgkmcnt(8)
    v_mfma_f32_32x32x16_bf16 v[160:175], v[92:95], v[232:235], v[160:175]
    ds_read_b64_tr_b16 v[232:233], v9 offset:8192
    ds_read_b64_tr_b16 v[234:235], v9 offset:8704
    v_add_f32 v250, 1.0, v250
    v_add_f32 v251, 1.0, v251
    v_rcp_f32 v250, v250
    v_mfma_f32_32x32x16_bf16 v[160:175], v[128:131], v[236:239], v[160:175]
    ds_read_b64_tr_b16 v[236:237], v9 offset:26624
    ds_read_b64_tr_b16 v[238:239], v9 offset:27136
    v_rcp_f32 v251, v251
    v_cvt_pk_bf16_f32 v212, v200, v201
    v_mul_f32 v202, v218, v250
    v_mul_f32 v203, v219, v251
    s_waitcnt lgkmcnt(8)
    v_mfma_f32_32x32x16_bf16 v[160:175], v[96:99], v[240:243], v[160:175]
    ds_read_b64_tr_b16 v[240:241], v9 offset:10240
    ds_read_b64_tr_b16 v[242:243], v9 offset:10752
    v_exp_f32 v252, -v204
    v_exp_f32 v253, -v205
    v_mul_f32 v220, v204, v220
    v_mfma_f32_32x32x16_bf16 v[160:175], v[132:135], v[244:247], v[160:175]
    ds_read_b64_tr_b16 v[244:245], v9 offset:28672
    ds_read_b64_tr_b16 v[246:247], v9 offset:29184
    v_mul_f32 v221, v205, v221
    v_add_f32 v252, 1.0, v252
    v_add_f32 v253, 1.0, v253
    v_rcp_f32 v252, v252
    s_waitcnt lgkmcnt(8)
    v_mfma_f32_32x32x16_bf16 v[160:175], v[100:103], v[224:227], v[160:175]
    ds_read_b64_tr_b16 v[224:225], v9 offset:12288
    ds_read_b64_tr_b16 v[226:227], v9 offset:12800
    v_rcp_f32 v253, v253
    v_cvt_pk_bf16_f32 v213, v202, v203
    v_mul_f32 v204, v220, v252
    v_mfma_f32_32x32x16_bf16 v[160:175], v[136:139], v[228:231], v[160:175]
    ds_read_b64_tr_b16 v[228:229], v9 offset:30720
    ds_read_b64_tr_b16 v[230:231], v9 offset:31232
    v_mul_f32 v205, v221, v253
    v_exp_f32 v254, -v206
    v_exp_f32 v255, -v207
    v_mul_f32 v222, v206, v222
    s_waitcnt lgkmcnt(8)
    v_mfma_f32_32x32x16_bf16 v[160:175], v[104:107], v[232:235], v[160:175]
    ds_read_b64_tr_b16 v[232:233], v9 offset:14336
    ds_read_b64_tr_b16 v[234:235], v9 offset:14848
    v_mul_f32 v223, v207, v223
    v_add_f32 v254, 1.0, v254
    v_add_f32 v255, 1.0, v255
    v_mfma_f32_32x32x16_bf16 v[160:175], v[140:143], v[236:239], v[160:175]
    ds_read_b64_tr_b16 v[236:237], v9 offset:32768
    ds_read_b64_tr_b16 v[238:239], v9 offset:33280
    v_rcp_f32 v254, v254
    v_rcp_f32 v255, v255
    v_cvt_pk_bf16_f32 v214, v204, v205
    v_mul_f32 v206, v222, v254
    s_waitcnt lgkmcnt(8)
    v_mfma_f32_32x32x16_bf16 v[160:175], v[108:111], v[240:243], v[160:175]
    ds_read_b64_tr_b16 v[240:241], v9 offset:16384
    ds_read_b64_tr_b16 v[242:243], v9 offset:16896
    v_mul_f32 v207, v223, v255
    v_cvt_pk_bf16_f32 v215, v206, v207
    buffer_store_dwordx4 v[212:215], v11, s[28:31], s49 offen offset:1024 sc0 sc1
    v_mfma_f32_32x32x16_bf16 v[160:175], v[144:147], v[244:247], v[160:175]
    ds_read_b64_tr_b16 v[244:245], v9 offset:34816
    ds_read_b64_tr_b16 v[246:247], v9 offset:35328
    s_add_u32 s49, s49, 2048
    s_cmp_ge_u32 s50, 36
    s_cselect_b32 s47, 36, 0
    s_cselect_b32 s48, 32, 65536
    s_waitcnt lgkmcnt(8)
    v_mfma_f32_32x32x16_bf16 v[160:175], v[112:115], v[224:227], v[160:175]
    v_add_u32 v8, 0, v7
    ds_read_b64_tr_b16 v[224:225], v8 offset:0
    ds_read_b64_tr_b16 v[226:227], v8 offset:512
    s_cselect_b32 s56, 0x600000, 0x0
    s_cselect_b32 s58, s32, s33
    s_cselect_b64 s[34:35], -1, 0
    v_mfma_f32_32x32x16_bf16 v[160:175], v[148:151], v[228:231], v[160:175]
    ds_read_b64_tr_b16 v[228:229], v8 offset:18432
    ds_read_b64_tr_b16 v[230:231], v8 offset:18944
    s_sub_u32 s52, s50, s47
    s_lshl_b32 s52, s52, 17
    s_add_u32 s53, s52, s48
    s_add_u32 s56, s12, s56
    s_waitcnt lgkmcnt(8)
    v_mfma_f32_32x32x16_bf16 v[160:175], v[116:119], v[232:235], v[160:175]
    ds_read_b64_tr_b16 v[232:233], v8 offset:2048
    ds_read_b64_tr_b16 v[234:235], v8 offset:2560
    s_addc_u32 s57, s13, 0
    s_mov_b32 s59, 0x20000
    v_cndmask_b32 v14, v12, v13, s[34:35]
    v_mfma_f32_32x32x16_bf16 v[160:175], v[152:155], v[236:239], v[160:175]
    ds_read_b64_tr_b16 v[236:237], v8 offset:20480
    ds_read_b64_tr_b16 v[238:239], v8 offset:20992
    s_cmp_lt_u32 s50, 18
    s_cselect_b32 s51, s36, s37
    s_add_u32 s50, s50, 1
    s_waitcnt lgkmcnt(8)
    v_mfma_f32_32x32x16_bf16 v[160:175], v[120:123], v[240:243], v[160:175]
    ds_read_b64_tr_b16 v[240:241], v8 offset:4096
    ds_read_b64_tr_b16 v[242:243], v8 offset:4608
    v_mfma_f32_32x32x16_bf16 v[160:175], v[156:159], v[244:247], v[160:175]
    ds_read_b64_tr_b16 v[244:245], v8 offset:22528
    ds_read_b64_tr_b16 v[246:247], v8 offset:23040
k1_kernel_e_3:
    s_cmp_ge_u32 s50, 36
    s_cbranch_scc1 k1_kernel_v_4
    s_waitcnt lgkmcnt(8)
    v_mfma_f32_32x32x16_bf16 v[176:191], v[224:227], v[16:19], 0
    ds_read_b64_tr_b16 v[224:225], v8 offset:6144
    ds_read_b64_tr_b16 v[226:227], v8 offset:6656
    v_mfma_f32_32x32x16_bf16 v[176:191], v[228:231], v[52:55], v[176:191]
    ds_read_b64_tr_b16 v[228:229], v8 offset:24576
    ds_read_b64_tr_b16 v[230:231], v8 offset:25088
    s_waitcnt lgkmcnt(8)
    v_mfma_f32_32x32x16_bf16 v[176:191], v[232:235], v[20:23], v[176:191]
    ds_read_b64_tr_b16 v[232:233], v8 offset:8192
    ds_read_b64_tr_b16 v[234:235], v8 offset:8704
    v_mfma_f32_32x32x16_bf16 v[176:191], v[236:239], v[56:59], v[176:191]
    ds_read_b64_tr_b16 v[236:237], v8 offset:26624
    ds_read_b64_tr_b16 v[238:239], v8 offset:27136
    v_mul_f32 v160, s51, v160
    v_mul_f32 v161, s51, v161
    s_waitcnt lgkmcnt(8)
    v_mfma_f32_32x32x16_bf16 v[176:191], v[240:243], v[24:27], v[176:191]
    ds_read_b64_tr_b16 v[240:241], v8 offset:10240
    ds_read_b64_tr_b16 v[242:243], v8 offset:10752
    v_cvt_pk_bf16_f32 v160, v160, v161
    v_mfma_f32_32x32x16_bf16 v[176:191], v[244:247], v[60:63], v[176:191]
    ds_read_b64_tr_b16 v[244:245], v8 offset:28672
    ds_read_b64_tr_b16 v[246:247], v8 offset:29184
    v_mul_f32 v162, s51, v162
    v_mul_f32 v163, s51, v163
    s_waitcnt lgkmcnt(8)
    v_mfma_f32_32x32x16_bf16 v[176:191], v[224:227], v[28:31], v[176:191]
    ds_read_b64_tr_b16 v[224:225], v8 offset:12288
    ds_read_b64_tr_b16 v[226:227], v8 offset:12800
    v_cvt_pk_bf16_f32 v161, v162, v163
    v_mfma_f32_32x32x16_bf16 v[176:191], v[228:231], v[64:67], v[176:191]
    ds_read_b64_tr_b16 v[228:229], v8 offset:30720
    ds_read_b64_tr_b16 v[230:231], v8 offset:31232
    v_mul_f32 v164, s51, v164
    s_waitcnt lgkmcnt(8)
    v_mfma_f32_32x32x16_bf16 v[176:191], v[232:235], v[32:35], v[176:191]
    ds_read_b64_tr_b16 v[232:233], v8 offset:14336
    ds_read_b64_tr_b16 v[234:235], v8 offset:14848
    v_mul_f32 v165, s51, v165
    v_cvt_pk_bf16_f32 v162, v164, v165
    v_mfma_f32_32x32x16_bf16 v[176:191], v[236:239], v[68:71], v[176:191]
    ds_read_b64_tr_b16 v[236:237], v8 offset:32768
    ds_read_b64_tr_b16 v[238:239], v8 offset:33280
    v_mul_f32 v166, s51, v166
    s_waitcnt lgkmcnt(8)
    v_mfma_f32_32x32x16_bf16 v[176:191], v[240:243], v[36:39], v[176:191]
    ds_read_b64_tr_b16 v[240:241], v8 offset:16384
    ds_read_b64_tr_b16 v[242:243], v8 offset:16896
    v_mul_f32 v167, s51, v167
    v_mfma_f32_32x32x16_bf16 v[176:191], v[244:247], v[72:75], v[176:191]
    ds_read_b64_tr_b16 v[244:245], v8 offset:34816
    ds_read_b64_tr_b16 v[246:247], v8 offset:35328
    v_cvt_pk_bf16_f32 v163, v166, v167
    v_mul_f32 v168, s51, v168
    s_waitcnt lgkmcnt(8)
    v_mfma_f32_32x32x16_bf16 v[176:191], v[224:227], v[40:43], v[176:191]
    v_add_u32 v9, 36864, v7
    ds_read_b64_tr_b16 v[224:225], v9 offset:0
    ds_read_b64_tr_b16 v[226:227], v9 offset:512
    v_mul_f32 v169, s51, v169
    v_mfma_f32_32x32x16_bf16 v[176:191], v[228:231], v[76:79], v[176:191]
    ds_read_b64_tr_b16 v[228:229], v9 offset:18432
    ds_read_b64_tr_b16 v[230:231], v9 offset:18944
    v_cvt_pk_bf16_f32 v164, v168, v169
    s_waitcnt lgkmcnt(8)
    v_mfma_f32_32x32x16_bf16 v[176:191], v[232:235], v[44:47], v[176:191]
    ds_read_b64_tr_b16 v[232:233], v9 offset:2048
    ds_read_b64_tr_b16 v[234:235], v9 offset:2560
    v_mul_f32 v170, s51, v170
    v_mul_f32 v171, s51, v171
    v_mfma_f32_32x32x16_bf16 v[176:191], v[236:239], v[80:83], v[176:191]
    ds_read_b64_tr_b16 v[236:237], v9 offset:20480
    ds_read_b64_tr_b16 v[238:239], v9 offset:20992
    v_cvt_pk_bf16_f32 v165, v170, v171
    s_waitcnt lgkmcnt(8)
    v_mfma_f32_32x32x16_bf16 v[176:191], v[240:243], v[48:51], v[176:191]
    ds_read_b64_tr_b16 v[240:241], v9 offset:4096
    ds_read_b64_tr_b16 v[242:243], v9 offset:4608
    v_mul_f32 v172, s51, v172
    v_mfma_f32_32x32x16_bf16 v[176:191], v[244:247], v[84:87], v[176:191]
    ds_read_b64_tr_b16 v[244:245], v9 offset:22528
    ds_read_b64_tr_b16 v[246:247], v9 offset:23040
    v_mul_f32 v173, s51, v173
    v_cvt_pk_bf16_f32 v166, v172, v173
    s_waitcnt lgkmcnt(8)
    v_mfma_f32_32x32x16_bf16 v[176:191], v[224:227], v[88:91], v[176:191]
    ds_read_b64_tr_b16 v[224:225], v9 offset:6144
    ds_read_b64_tr_b16 v[226:227], v9 offset:6656
    v_mul_f32 v174, s51, v174
    v_mfma_f32_32x32x16_bf16 v[176:191], v[228:231], v[124:127], v[176:191]
    ds_read_b64_tr_b16 v[228:229], v9 offset:24576
    ds_read_b64_tr_b16 v[230:231], v9 offset:25088
    v_mul_f32 v175, s51, v175
    v_cvt_pk_bf16_f32 v167, v174, v175
    s_waitcnt lgkmcnt(8)
    v_mfma_f32_32x32x16_bf16 v[176:191], v[232:235], v[92:95], v[176:191]
    ds_read_b64_tr_b16 v[232:233], v9 offset:8192
    ds_read_b64_tr_b16 v[234:235], v9 offset:8704
    buffer_store_dwordx4 v[160:163], v14, s[56:59], s52 offen sc0 sc1
    v_mfma_f32_32x32x16_bf16 v[176:191], v[236:239], v[128:131], v[176:191]
    ds_read_b64_tr_b16 v[236:237], v9 offset:26624
    ds_read_b64_tr_b16 v[238:239], v9 offset:27136
    buffer_store_dwordx4 v[164:167], v14, s[56:59], s53 offen sc0 sc1
    s_waitcnt lgkmcnt(8)
    v_mfma_f32_32x32x16_bf16 v[176:191], v[240:243], v[96:99], v[176:191]
    ds_read_b64_tr_b16 v[240:241], v9 offset:10240
    ds_read_b64_tr_b16 v[242:243], v9 offset:10752
    s_cmp_ge_u32 s50, 36
    s_cselect_b32 s47, 36, 0
    v_mfma_f32_32x32x16_bf16 v[176:191], v[244:247], v[132:135], v[176:191]
    ds_read_b64_tr_b16 v[244:245], v9 offset:28672
    ds_read_b64_tr_b16 v[246:247], v9 offset:29184
    s_cselect_b32 s48, 32, 65536
    s_waitcnt lgkmcnt(8)
    v_mfma_f32_32x32x16_bf16 v[176:191], v[224:227], v[100:103], v[176:191]
    ds_read_b64_tr_b16 v[224:225], v9 offset:12288
    ds_read_b64_tr_b16 v[226:227], v9 offset:12800
    s_cselect_b32 s56, 0x600000, 0x0
    v_mfma_f32_32x32x16_bf16 v[176:191], v[228:231], v[136:139], v[176:191]
    ds_read_b64_tr_b16 v[228:229], v9 offset:30720
    ds_read_b64_tr_b16 v[230:231], v9 offset:31232
    s_cselect_b32 s58, s32, s33
    s_cselect_b64 s[34:35], -1, 0
    s_waitcnt lgkmcnt(8)
    v_mfma_f32_32x32x16_bf16 v[176:191], v[232:235], v[104:107], v[176:191]
    ds_read_b64_tr_b16 v[232:233], v9 offset:14336
    ds_read_b64_tr_b16 v[234:235], v9 offset:14848
    s_sub_u32 s52, s50, s47
    v_mfma_f32_32x32x16_bf16 v[176:191], v[236:239], v[140:143], v[176:191]
    ds_read_b64_tr_b16 v[236:237], v9 offset:32768
    ds_read_b64_tr_b16 v[238:239], v9 offset:33280
    s_lshl_b32 s52, s52, 17
    s_waitcnt lgkmcnt(8)
    v_mfma_f32_32x32x16_bf16 v[176:191], v[240:243], v[108:111], v[176:191]
    ds_read_b64_tr_b16 v[240:241], v9 offset:16384
    ds_read_b64_tr_b16 v[242:243], v9 offset:16896
    s_add_u32 s53, s52, s48
    s_add_u32 s56, s12, s56
    v_mfma_f32_32x32x16_bf16 v[176:191], v[244:247], v[144:147], v[176:191]
    ds_read_b64_tr_b16 v[244:245], v9 offset:34816
    ds_read_b64_tr_b16 v[246:247], v9 offset:35328
    s_addc_u32 s57, s13, 0
    s_waitcnt lgkmcnt(8)
    v_mfma_f32_32x32x16_bf16 v[176:191], v[224:227], v[112:115], v[176:191]
    s_barrier
    v_add_u32 v8, 73728, v6
    ds_read_b64_tr_b16 v[224:225], v8 offset:0
    ds_read_b64_tr_b16 v[226:227], v8 offset:512
    s_mov_b32 s59, 0x20000
    v_mfma_f32_32x32x16_bf16 v[176:191], v[228:231], v[148:151], v[176:191]
    ds_read_b64_tr_b16 v[228:229], v8 offset:18432
    ds_read_b64_tr_b16 v[230:231], v8 offset:18944
    v_cndmask_b32 v14, v12, v13, s[34:35]
    s_cmp_lt_u32 s50, 18
    s_waitcnt lgkmcnt(8)
    v_mfma_f32_32x32x16_bf16 v[176:191], v[232:235], v[116:119], v[176:191]
    ds_read_b64_tr_b16 v[232:233], v8 offset:2048
    ds_read_b64_tr_b16 v[234:235], v8 offset:2560
    s_cselect_b32 s51, s36, s37
    v_mfma_f32_32x32x16_bf16 v[176:191], v[236:239], v[152:155], v[176:191]
    ds_read_b64_tr_b16 v[236:237], v8 offset:20480
    ds_read_b64_tr_b16 v[238:239], v8 offset:20992
    s_add_u32 s50, s50, 1
    s_waitcnt lgkmcnt(8)
    v_mfma_f32_32x32x16_bf16 v[176:191], v[240:243], v[120:123], v[176:191]
    ds_read_b64_tr_b16 v[240:241], v8 offset:4096
    ds_read_b64_tr_b16 v[242:243], v8 offset:4608
    v_mfma_f32_32x32x16_bf16 v[176:191], v[244:247], v[156:159], v[176:191]
    ds_read_b64_tr_b16 v[244:245], v8 offset:22528
    ds_read_b64_tr_b16 v[246:247], v8 offset:23040
    s_branch k1_kernel_e_5
k1_kernel_v_4:
    s_waitcnt lgkmcnt(8)
    v_mfma_f32_32x32x16_bf16 v[176:191], v[16:19], v[224:227], 0
    ds_read_b64_tr_b16 v[224:225], v8 offset:6144
    ds_read_b64_tr_b16 v[226:227], v8 offset:6656
    v_mfma_f32_32x32x16_bf16 v[176:191], v[52:55], v[228:231], v[176:191]
    ds_read_b64_tr_b16 v[228:229], v8 offset:24576
    ds_read_b64_tr_b16 v[230:231], v8 offset:25088
    s_waitcnt lgkmcnt(8)
    v_mfma_f32_32x32x16_bf16 v[176:191], v[20:23], v[232:235], v[176:191]
    ds_read_b64_tr_b16 v[232:233], v8 offset:8192
    ds_read_b64_tr_b16 v[234:235], v8 offset:8704
    v_mfma_f32_32x32x16_bf16 v[176:191], v[56:59], v[236:239], v[176:191]
    ds_read_b64_tr_b16 v[236:237], v8 offset:26624
    ds_read_b64_tr_b16 v[238:239], v8 offset:27136
    v_mul_f32 v160, s51, v160
    v_mul_f32 v161, s51, v161
    s_waitcnt lgkmcnt(8)
    v_mfma_f32_32x32x16_bf16 v[176:191], v[24:27], v[240:243], v[176:191]
    ds_read_b64_tr_b16 v[240:241], v8 offset:10240
    ds_read_b64_tr_b16 v[242:243], v8 offset:10752
    v_cvt_pk_bf16_f32 v160, v160, v161
    v_mfma_f32_32x32x16_bf16 v[176:191], v[60:63], v[244:247], v[176:191]
    ds_read_b64_tr_b16 v[244:245], v8 offset:28672
    ds_read_b64_tr_b16 v[246:247], v8 offset:29184
    v_mul_f32 v162, s51, v162
    v_mul_f32 v163, s51, v163
    s_waitcnt lgkmcnt(8)
    v_mfma_f32_32x32x16_bf16 v[176:191], v[28:31], v[224:227], v[176:191]
    ds_read_b64_tr_b16 v[224:225], v8 offset:12288
    ds_read_b64_tr_b16 v[226:227], v8 offset:12800
    v_cvt_pk_bf16_f32 v161, v162, v163
    v_mfma_f32_32x32x16_bf16 v[176:191], v[64:67], v[228:231], v[176:191]
    ds_read_b64_tr_b16 v[228:229], v8 offset:30720
    ds_read_b64_tr_b16 v[230:231], v8 offset:31232
    v_mul_f32 v164, s51, v164
    s_waitcnt lgkmcnt(8)
    v_mfma_f32_32x32x16_bf16 v[176:191], v[32:35], v[232:235], v[176:191]
    ds_read_b64_tr_b16 v[232:233], v8 offset:14336
    ds_read_b64_tr_b16 v[234:235], v8 offset:14848
    v_mul_f32 v165, s51, v165
    v_cvt_pk_bf16_f32 v162, v164, v165
    v_mfma_f32_32x32x16_bf16 v[176:191], v[68:71], v[236:239], v[176:191]
    ds_read_b64_tr_b16 v[236:237], v8 offset:32768
    ds_read_b64_tr_b16 v[238:239], v8 offset:33280
    v_mul_f32 v166, s51, v166
    s_waitcnt lgkmcnt(8)
    v_mfma_f32_32x32x16_bf16 v[176:191], v[36:39], v[240:243], v[176:191]
    ds_read_b64_tr_b16 v[240:241], v8 offset:16384
    ds_read_b64_tr_b16 v[242:243], v8 offset:16896
    v_mul_f32 v167, s51, v167
    v_mfma_f32_32x32x16_bf16 v[176:191], v[72:75], v[244:247], v[176:191]
    ds_read_b64_tr_b16 v[244:245], v8 offset:34816
    ds_read_b64_tr_b16 v[246:247], v8 offset:35328
    v_cvt_pk_bf16_f32 v163, v166, v167
    v_mul_f32 v168, s51, v168
    s_waitcnt lgkmcnt(8)
    v_mfma_f32_32x32x16_bf16 v[176:191], v[40:43], v[224:227], v[176:191]
    v_add_u32 v9, 36864, v7
    ds_read_b64_tr_b16 v[224:225], v9 offset:0
    ds_read_b64_tr_b16 v[226:227], v9 offset:512
    v_mul_f32 v169, s51, v169
    v_mfma_f32_32x32x16_bf16 v[176:191], v[76:79], v[228:231], v[176:191]
    ds_read_b64_tr_b16 v[228:229], v9 offset:18432
    ds_read_b64_tr_b16 v[230:231], v9 offset:18944
    v_cvt_pk_bf16_f32 v164, v168, v169
    s_waitcnt lgkmcnt(8)
    v_mfma_f32_32x32x16_bf16 v[176:191], v[44:47], v[232:235], v[176:191]
    ds_read_b64_tr_b16 v[232:233], v9 offset:2048
    ds_read_b64_tr_b16 v[234:235], v9 offset:2560
    v_mul_f32 v170, s51, v170
    v_mul_f32 v171, s51, v171
    v_mfma_f32_32x32x16_bf16 v[176:191], v[80:83], v[236:239], v[176:191]
    ds_read_b64_tr_b16 v[236:237], v9 offset:20480
    ds_read_b64_tr_b16 v[238:239], v9 offset:20992
    v_cvt_pk_bf16_f32 v165, v170, v171
    s_waitcnt lgkmcnt(8)
    v_mfma_f32_32x32x16_bf16 v[176:191], v[48:51], v[240:243], v[176:191]
    ds_read_b64_tr_b16 v[240:241], v9 offset:4096
    ds_read_b64_tr_b16 v[242:243], v9 offset:4608
    v_mul_f32 v172, s51, v172
    v_mfma_f32_32x32x16_bf16 v[176:191], v[84:87], v[244:247], v[176:191]
    ds_read_b64_tr_b16 v[244:245], v9 offset:22528
    ds_read_b64_tr_b16 v[246:247], v9 offset:23040
    v_mul_f32 v173, s51, v173
    v_cvt_pk_bf16_f32 v166, v172, v173
    s_waitcnt lgkmcnt(8)
    v_mfma_f32_32x32x16_bf16 v[176:191], v[88:91], v[224:227], v[176:191]
    ds_read_b64_tr_b16 v[224:225], v9 offset:6144
    ds_read_b64_tr_b16 v[226:227], v9 offset:6656
    v_mul_f32 v174, s51, v174
    v_mfma_f32_32x32x16_bf16 v[176:191], v[124:127], v[228:231], v[176:191]
    ds_read_b64_tr_b16 v[228:229], v9 offset:24576
    ds_read_b64_tr_b16 v[230:231], v9 offset:25088
    v_mul_f32 v175, s51, v175
    v_cvt_pk_bf16_f32 v167, v174, v175
    s_waitcnt lgkmcnt(8)
    v_mfma_f32_32x32x16_bf16 v[176:191], v[92:95], v[232:235], v[176:191]
    ds_read_b64_tr_b16 v[232:233], v9 offset:8192
    ds_read_b64_tr_b16 v[234:235], v9 offset:8704
    buffer_store_dwordx4 v[160:163], v14, s[56:59], s52 offen sc0 sc1
    v_mfma_f32_32x32x16_bf16 v[176:191], v[128:131], v[236:239], v[176:191]
    ds_read_b64_tr_b16 v[236:237], v9 offset:26624
    ds_read_b64_tr_b16 v[238:239], v9 offset:27136
    buffer_store_dwordx4 v[164:167], v14, s[56:59], s53 offen sc0 sc1
    s_waitcnt lgkmcnt(8)
    v_mfma_f32_32x32x16_bf16 v[176:191], v[96:99], v[240:243], v[176:191]
    ds_read_b64_tr_b16 v[240:241], v9 offset:10240
    ds_read_b64_tr_b16 v[242:243], v9 offset:10752
    s_cmp_ge_u32 s50, 36
    s_cselect_b32 s47, 36, 0
    v_mfma_f32_32x32x16_bf16 v[176:191], v[132:135], v[244:247], v[176:191]
    ds_read_b64_tr_b16 v[244:245], v9 offset:28672
    ds_read_b64_tr_b16 v[246:247], v9 offset:29184
    s_cselect_b32 s48, 32, 65536
    s_waitcnt lgkmcnt(8)
    v_mfma_f32_32x32x16_bf16 v[176:191], v[100:103], v[224:227], v[176:191]
    ds_read_b64_tr_b16 v[224:225], v9 offset:12288
    ds_read_b64_tr_b16 v[226:227], v9 offset:12800
    s_cselect_b32 s56, 0x600000, 0x0
    v_mfma_f32_32x32x16_bf16 v[176:191], v[136:139], v[228:231], v[176:191]
    ds_read_b64_tr_b16 v[228:229], v9 offset:30720
    ds_read_b64_tr_b16 v[230:231], v9 offset:31232
    s_cselect_b32 s58, s32, s33
    s_cselect_b64 s[34:35], -1, 0
    s_waitcnt lgkmcnt(8)
    v_mfma_f32_32x32x16_bf16 v[176:191], v[104:107], v[232:235], v[176:191]
    ds_read_b64_tr_b16 v[232:233], v9 offset:14336
    ds_read_b64_tr_b16 v[234:235], v9 offset:14848
    s_sub_u32 s52, s50, s47
    v_mfma_f32_32x32x16_bf16 v[176:191], v[140:143], v[236:239], v[176:191]
    ds_read_b64_tr_b16 v[236:237], v9 offset:32768
    ds_read_b64_tr_b16 v[238:239], v9 offset:33280
    s_lshl_b32 s52, s52, 17
    s_waitcnt lgkmcnt(8)
    v_mfma_f32_32x32x16_bf16 v[176:191], v[108:111], v[240:243], v[176:191]
    ds_read_b64_tr_b16 v[240:241], v9 offset:16384
    ds_read_b64_tr_b16 v[242:243], v9 offset:16896
    s_add_u32 s53, s52, s48
    s_add_u32 s56, s12, s56
    v_mfma_f32_32x32x16_bf16 v[176:191], v[144:147], v[244:247], v[176:191]
    ds_read_b64_tr_b16 v[244:245], v9 offset:34816
    ds_read_b64_tr_b16 v[246:247], v9 offset:35328
    s_addc_u32 s57, s13, 0
    s_waitcnt lgkmcnt(8)
    v_mfma_f32_32x32x16_bf16 v[176:191], v[112:115], v[224:227], v[176:191]
    s_barrier
    v_add_u32 v8, 73728, v6
    ds_read_b64_tr_b16 v[224:225], v8 offset:0
    ds_read_b64_tr_b16 v[226:227], v8 offset:512
    s_mov_b32 s59, 0x20000
    v_mfma_f32_32x32x16_bf16 v[176:191], v[148:151], v[228:231], v[176:191]
    ds_read_b64_tr_b16 v[228:229], v8 offset:18432
    ds_read_b64_tr_b16 v[230:231], v8 offset:18944
    v_cndmask_b32 v14, v12, v13, s[34:35]
    s_cmp_lt_u32 s50, 18
    s_waitcnt lgkmcnt(8)
    v_mfma_f32_32x32x16_bf16 v[176:191], v[116:119], v[232:235], v[176:191]
    ds_read_b64_tr_b16 v[232:233], v8 offset:2048
    ds_read_b64_tr_b16 v[234:235], v8 offset:2560
    s_cselect_b32 s51, s36, s37
    v_mfma_f32_32x32x16_bf16 v[176:191], v[152:155], v[236:239], v[176:191]
    ds_read_b64_tr_b16 v[236:237], v8 offset:20480
    ds_read_b64_tr_b16 v[238:239], v8 offset:20992
    s_add_u32 s50, s50, 1
    s_waitcnt lgkmcnt(8)
    v_mfma_f32_32x32x16_bf16 v[176:191], v[120:123], v[240:243], v[176:191]
    ds_read_b64_tr_b16 v[240:241], v8 offset:4096
    ds_read_b64_tr_b16 v[242:243], v8 offset:4608
    v_mfma_f32_32x32x16_bf16 v[176:191], v[156:159], v[244:247], v[176:191]
    ds_read_b64_tr_b16 v[244:245], v8 offset:22528
    ds_read_b64_tr_b16 v[246:247], v8 offset:23040
k1_kernel_e_5:
    s_cmp_le_u32 s42, 1
    s_cbranch_scc1 k1_kernel_fin1
    s_cmp_ge_u32 s50, 36
    s_cbranch_scc1 k1_kernel_v_6
    s_waitcnt lgkmcnt(8)
    v_mfma_f32_32x32x16_bf16 v[192:207], v[224:227], v[16:19], 0
    ds_read_b64_tr_b16 v[224:225], v8 offset:6144
    ds_read_b64_tr_b16 v[226:227], v8 offset:6656
    v_mfma_f32_32x32x16_bf16 v[192:207], v[228:231], v[52:55], v[192:207]
    ds_read_b64_tr_b16 v[228:229], v8 offset:24576
    ds_read_b64_tr_b16 v[230:231], v8 offset:25088
    s_waitcnt lgkmcnt(8)
    v_mfma_f32_32x32x16_bf16 v[192:207], v[232:235], v[20:23], v[192:207]
    ds_read_b64_tr_b16 v[232:233], v8 offset:8192
    ds_read_b64_tr_b16 v[234:235], v8 offset:8704
    v_mfma_f32_32x32x16_bf16 v[192:207], v[236:239], v[56:59], v[192:207]
    ds_read_b64_tr_b16 v[236:237], v8 offset:26624
    ds_read_b64_tr_b16 v[238:239], v8 offset:27136
    v_mul_f32 v176, s51, v176
    v_mul_f32 v177, s51, v177
    s_waitcnt lgkmcnt(8)
    v_mfma_f32_32x32x16_bf16 v[192:207], v[240:243], v[24:27], v[192:207]
    ds_read_b64_tr_b16 v[240:241], v8 offset:10240
    ds_read_b64_tr_b16 v[242:243], v8 offset:10752
    v_cvt_pk_bf16_f32 v176, v176, v177
    v_mfma_f32_32x32x16_bf16 v[192:207], v[244:247], v[60:63], v[192:207]
    ds_read_b64_tr_b16 v[244:245], v8 offset:28672
    ds_read_b64_tr_b16 v[246:247], v8 offset:29184
    v_mul_f32 v178, s51, v178
    v_mul_f32 v179, s51, v179
    s_waitcnt lgkmcnt(8)
    v_mfma_f32_32x32x16_bf16 v[192:207], v[224:227], v[28:31], v[192:207]
    ds_read_b64_tr_b16 v[224:225], v8 offset:12288
    ds_read_b64_tr_b16 v[226:227], v8 offset:12800
    v_cvt_pk_bf16_f32 v177, v178, v179
    v_mfma_f32_32x32x16_bf16 v[192:207], v[228:231], v[64:67], v[192:207]
    ds_read_b64_tr_b16 v[228:229], v8 offset:30720
    ds_read_b64_tr_b16 v[230:231], v8 offset:31232
    v_mul_f32 v180, s51, v180
    s_waitcnt lgkmcnt(8)
    v_mfma_f32_32x32x16_bf16 v[192:207], v[232:235], v[32:35], v[192:207]
    ds_read_b64_tr_b16 v[232:233], v8 offset:14336
    ds_read_b64_tr_b16 v[234:235], v8 offset:14848
    v_mul_f32 v181, s51, v181
    v_cvt_pk_bf16_f32 v178, v180, v181
    v_mfma_f32_32x32x16_bf16 v[192:207], v[236:239], v[68:71], v[192:207]
    ds_read_b64_tr_b16 v[236:237], v8 offset:32768
    ds_read_b64_tr_b16 v[238:239], v8 offset:33280
    v_mul_f32 v182, s51, v182
    s_waitcnt lgkmcnt(8)
    v_mfma_f32_32x32x16_bf16 v[192:207], v[240:243], v[36:39], v[192:207]
    ds_read_b64_tr_b16 v[240:241], v8 offset:16384
    ds_read_b64_tr_b16 v[242:243], v8 offset:16896
    v_mul_f32 v183, s51, v183
    v_mfma_f32_32x32x16_bf16 v[192:207], v[244:247], v[72:75], v[192:207]
    ds_read_b64_tr_b16 v[244:245], v8 offset:34816
    ds_read_b64_tr_b16 v[246:247], v8 offset:35328
    v_cvt_pk_bf16_f32 v179, v182, v183
    v_mul_f32 v184, s51, v184
    s_waitcnt lgkmcnt(8)
    v_mfma_f32_32x32x16_bf16 v[192:207], v[224:227], v[40:43], v[192:207]
    s_barrier
    v_add_u32 v9, 110592, v6
    ds_read_b64_tr_b16 v[224:225], v9 offset:0
    ds_read_b64_tr_b16 v[226:227], v9 offset:512
    v_mul_f32 v185, s51, v185
    v_mfma_f32_32x32x16_bf16 v[192:207], v[228:231], v[76:79], v[192:207]
    ds_read_b64_tr_b16 v[228:229], v9 offset:18432
    ds_read_b64_tr_b16 v[230:231], v9 offset:18944
    v_cvt_pk_bf16_f32 v180, v184, v185
    s_waitcnt lgkmcnt(8)
    v_mfma_f32_32x32x16_bf16 v[192:207], v[232:235], v[44:47], v[192:207]
    ds_read_b64_tr_b16 v[232:233], v9 offset:2048
    ds_read_b64_tr_b16 v[234:235], v9 offset:2560
    v_mul_f32 v186, s51, v186
    v_mul_f32 v187, s51, v187
    v_mfma_f32_32x32x16_bf16 v[192:207], v[236:239], v[80:83], v[192:207]
    ds_read_b64_tr_b16 v[236:237], v9 offset:20480
    ds_read_b64_tr_b16 v[238:239], v9 offset:20992
    v_cvt_pk_bf16_f32 v181, v186, v187
    s_waitcnt lgkmcnt(8)
    v_mfma_f32_32x32x16_bf16 v[192:207], v[240:243], v[48:51], v[192:207]
    ds_read_b64_tr_b16 v[240:241], v9 offset:4096
    ds_read_b64_tr_b16 v[242:243], v9 offset:4608
    v_mul_f32 v188, s51, v188
    v_mfma_f32_32x32x16_bf16 v[192:207], v[244:247], v[84:87], v[192:207]
    ds_read_b64_tr_b16 v[244:245], v9 offset:22528
    ds_read_b64_tr_b16 v[246:247], v9 offset:23040
    v_mul_f32 v189, s51, v189
    v_cvt_pk_bf16_f32 v182, v188, v189
    s_waitcnt lgkmcnt(8)
    v_mfma_f32_32x32x16_bf16 v[192:207], v[224:227], v[88:91], v[192:207]
    ds_read_b64_tr_b16 v[224:225], v9 offset:6144
    ds_read_b64_tr_b16 v[226:227], v9 offset:6656
    v_mul_f32 v190, s51, v190
    v_mfma_f32_32x32x16_bf16 v[192:207], v[228:231], v[124:127], v[192:207]
    ds_read_b64_tr_b16 v[228:229], v9 offset:24576
    ds_read_b64_tr_b16 v[230:231], v9 offset:25088
    v_mul_f32 v191, s51, v191
    v_cvt_pk_bf16_f32 v183, v190, v191
    s_waitcnt lgkmcnt(8)
    v_mfma_f32_32x32x16_bf16 v[192:207], v[232:235], v[92:95], v[192:207]
    ds_read_b64_tr_b16 v[232:233], v9 offset:8192
    ds_read_b64_tr_b16 v[234:235], v9 offset:8704
    buffer_store_dwordx4 v[176:179], v14, s[56:59], s52 offen sc0 sc1
    v_mfma_f32_32x32x16_bf16 v[192:207], v[236:239], v[128:131], v[192:207]
    ds_read_b64_tr_b16 v[236:237], v9 offset:26624
    ds_read_b64_tr_b16 v[238:239], v9 offset:27136
    buffer_store_dwordx4 v[180:183], v14, s[56:59], s53 offen sc0 sc1
    s_waitcnt lgkmcnt(8)
    v_mfma_f32_32x32x16_bf16 v[192:207], v[240:243], v[96:99], v[192:207]
    ds_read_b64_tr_b16 v[240:241], v9 offset:10240
    ds_read_b64_tr_b16 v[242:243], v9 offset:10752
    s_cmp_ge_u32 s50, 36
    s_cselect_b32 s47, 36, 0
    v_mfma_f32_32x32x16_bf16 v[192:207], v[244:247], v[132:135], v[192:207]
    ds_read_b64_tr_b16 v[244:245], v9 offset:28672
    ds_read_b64_tr_b16 v[246:247], v9 offset:29184
    s_cselect_b32 s48, 32, 65536
    s_waitcnt lgkmcnt(8)
    v_mfma_f32_32x32x16_bf16 v[192:207], v[224:227], v[100:103], v[192:207]
    ds_read_b64_tr_b16 v[224:225], v9 offset:12288
    ds_read_b64_tr_b16 v[226:227], v9 offset:12800
    s_cselect_b32 s56, 0x600000, 0x0
    v_mfma_f32_32x32x16_bf16 v[192:207], v[228:231], v[136:139], v[192:207]
    ds_read_b64_tr_b16 v[228:229], v9 offset:30720
    ds_read_b64_tr_b16 v[230:231], v9 offset:31232
    s_cselect_b32 s58, s32, s33
    s_cselect_b64 s[34:35], -1, 0
    s_waitcnt lgkmcnt(8)
    v_mfma_f32_32x32x16_bf16 v[192:207], v[232:235], v[104:107], v[192:207]
    ds_read_b64_tr_b16 v[232:233], v9 offset:14336
    ds_read_b64_tr_b16 v[234:235], v9 offset:14848
    s_sub_u32 s52, s50, s47
    v_mfma_f32_32x32x16_bf16 v[192:207], v[236:239], v[140:143], v[192:207]
    ds_read_b64_tr_b16 v[236:237], v9 offset:32768
    ds_read_b64_tr_b16 v[238:239], v9 offset:33280
    s_lshl_b32 s52, s52, 17
    s_waitcnt lgkmcnt(8)
    v_mfma_f32_32x32x16_bf16 v[192:207], v[240:243], v[108:111], v[192:207]
    ds_read_b64_tr_b16 v[240:241], v9 offset:16384
    ds_read_b64_tr_b16 v[242:243], v9 offset:16896
    s_add_u32 s53, s52, s48
    s_add_u32 s56, s12, s56
    v_mfma_f32_32x32x16_bf16 v[192:207], v[244:247], v[144:147], v[192:207]
    ds_read_b64_tr_b16 v[244:245], v9 offset:34816
    ds_read_b64_tr_b16 v[246:247], v9 offset:35328
    s_addc_u32 s57, s13, 0
    s_waitcnt lgkmcnt(8)
    v_mfma_f32_32x32x16_bf16 v[192:207], v[224:227], v[112:115], v[192:207]
    v_add_u32 v8, 73728, v7
    ds_read_b64_tr_b16 v[224:225], v8 offset:0
    ds_read_b64_tr_b16 v[226:227], v8 offset:512
    s_mov_b32 s59, 0x20000
    v_mfma_f32_32x32x16_bf16 v[192:207], v[228:231], v[148:151], v[192:207]
    ds_read_b64_tr_b16 v[228:229], v8 offset:18432
    ds_read_b64_tr_b16 v[230:231], v8 offset:18944
    v_cndmask_b32 v14, v12, v13, s[34:35]
    s_cmp_lt_u32 s50, 18
    s_waitcnt lgkmcnt(8)
    v_mfma_f32_32x32x16_bf16 v[192:207], v[232:235], v[116:119], v[192:207]
    ds_read_b64_tr_b16 v[232:233], v8 offset:2048
    ds_read_b64_tr_b16 v[234:235], v8 offset:2560
    s_cselect_b32 s51, s36, s37
    v_mfma_f32_32x32x16_bf16 v[192:207], v[236:239], v[152:155], v[192:207]
    ds_read_b64_tr_b16 v[236:237], v8 offset:20480
    ds_read_b64_tr_b16 v[238:239], v8 offset:20992
    s_add_u32 s50, s50, 1
    s_waitcnt lgkmcnt(8)
    v_mfma_f32_32x32x16_bf16 v[192:207], v[240:243], v[120:123], v[192:207]
    ds_read_b64_tr_b16 v[240:241], v8 offset:4096
    ds_read_b64_tr_b16 v[242:243], v8 offset:4608
    v_mfma_f32_32x32x16_bf16 v[192:207], v[244:247], v[156:159], v[192:207]
    ds_read_b64_tr_b16 v[244:245], v8 offset:22528
    ds_read_b64_tr_b16 v[246:247], v8 offset:23040
    s_branch k1_kernel_e_7
k1_kernel_v_6:
    s_waitcnt lgkmcnt(8)
    v_mfma_f32_32x32x16_bf16 v[192:207], v[16:19], v[224:227], 0
    ds_read_b64_tr_b16 v[224:225], v8 offset:6144
    ds_read_b64_tr_b16 v[226:227], v8 offset:6656
    v_mfma_f32_32x32x16_bf16 v[192:207], v[52:55], v[228:231], v[192:207]
    ds_read_b64_tr_b16 v[228:229], v8 offset:24576
    ds_read_b64_tr_b16 v[230:231], v8 offset:25088
    s_waitcnt lgkmcnt(8)
    v_mfma_f32_32x32x16_bf16 v[192:207], v[20:23], v[232:235], v[192:207]
    ds_read_b64_tr_b16 v[232:233], v8 offset:8192
    ds_read_b64_tr_b16 v[234:235], v8 offset:8704
    v_mfma_f32_32x32x16_bf16 v[192:207], v[56:59], v[236:239], v[192:207]
    ds_read_b64_tr_b16 v[236:237], v8 offset:26624
    ds_read_b64_tr_b16 v[238:239], v8 offset:27136
    v_mul_f32 v176, s51, v176
    v_mul_f32 v177, s51, v177
    s_waitcnt lgkmcnt(8)
    v_mfma_f32_32x32x16_bf16 v[192:207], v[24:27], v[240:243], v[192:207]
    ds_read_b64_tr_b16 v[240:241], v8 offset:10240
    ds_read_b64_tr_b16 v[242:243], v8 offset:10752
    v_cvt_pk_bf16_f32 v176, v176, v177
    v_mfma_f32_32x32x16_bf16 v[192:207], v[60:63], v[244:247], v[192:207]
    ds_read_b64_tr_b16 v[244:245], v8 offset:28672
    ds_read_b64_tr_b16 v[246:247], v8 offset:29184
    v_mul_f32 v178, s51, v178
    v_mul_f32 v179, s51, v179
    s_waitcnt lgkmcnt(8)
    v_mfma_f32_32x32x16_bf16 v[192:207], v[28:31], v[224:227], v[192:207]
    ds_read_b64_tr_b16 v[224:225], v8 offset:12288
    ds_read_b64_tr_b16 v[226:227], v8 offset:12800
    v_cvt_pk_bf16_f32 v177, v178, v179
    v_mfma_f32_32x32x16_bf16 v[192:207], v[64:67], v[228:231], v[192:207]
    ds_read_b64_tr_b16 v[228:229], v8 offset:30720
    ds_read_b64_tr_b16 v[230:231], v8 offset:31232
    v_mul_f32 v180, s51, v180
    s_waitcnt lgkmcnt(8)
    v_mfma_f32_32x32x16_bf16 v[192:207], v[32:35], v[232:235], v[192:207]
    ds_read_b64_tr_b16 v[232:233], v8 offset:14336
    ds_read_b64_tr_b16 v[234:235], v8 offset:14848
    v_mul_f32 v181, s51, v181
    v_cvt_pk_bf16_f32 v178, v180, v181
    v_mfma_f32_32x32x16_bf16 v[192:207], v[68:71], v[236:239], v[192:207]
    ds_read_b64_tr_b16 v[236:237], v8 offset:32768
    ds_read_b64_tr_b16 v[238:239], v8 offset:33280
    v_mul_f32 v182, s51, v182
    s_waitcnt lgkmcnt(8)
    v_mfma_f32_32x32x16_bf16 v[192:207], v[36:39], v[240:243], v[192:207]
    ds_read_b64_tr_b16 v[240:241], v8 offset:16384
    ds_read_b64_tr_b16 v[242:243], v8 offset:16896
    v_mul_f32 v183, s51, v183
    v_mfma_f32_32x32x16_bf16 v[192:207], v[72:75], v[244:247], v[192:207]
    ds_read_b64_tr_b16 v[244:245], v8 offset:34816
    ds_read_b64_tr_b16 v[246:247], v8 offset:35328
    v_cvt_pk_bf16_f32 v179, v182, v183
    v_mul_f32 v184, s51, v184
    s_waitcnt lgkmcnt(8)
    v_mfma_f32_32x32x16_bf16 v[192:207], v[40:43], v[224:227], v[192:207]
    s_barrier
    v_add_u32 v9, 110592, v6
    ds_read_b64_tr_b16 v[224:225], v9 offset:0
    ds_read_b64_tr_b16 v[226:227], v9 offset:512
    v_mul_f32 v185, s51, v185
    v_mfma_f32_32x32x16_bf16 v[192:207], v[76:79], v[228:231], v[192:207]
    ds_read_b64_tr_b16 v[228:229], v9 offset:18432
    ds_read_b64_tr_b16 v[230:231], v9 offset:18944
    v_cvt_pk_bf16_f32 v180, v184, v185
    s_waitcnt lgkmcnt(8)
    v_mfma_f32_32x32x16_bf16 v[192:207], v[44:47], v[232:235], v[192:207]
    ds_read_b64_tr_b16 v[232:233], v9 offset:2048
    ds_read_b64_tr_b16 v[234:235], v9 offset:2560
    v_mul_f32 v186, s51, v186
    v_mul_f32 v187, s51, v187
    v_mfma_f32_32x32x16_bf16 v[192:207], v[80:83], v[236:239], v[192:207]
    ds_read_b64_tr_b16 v[236:237], v9 offset:20480
    ds_read_b64_tr_b16 v[238:239], v9 offset:20992
    v_cvt_pk_bf16_f32 v181, v186, v187
    s_waitcnt lgkmcnt(8)
    v_mfma_f32_32x32x16_bf16 v[192:207], v[48:51], v[240:243], v[192:207]
    ds_read_b64_tr_b16 v[240:241], v9 offset:4096
    ds_read_b64_tr_b16 v[242:243], v9 offset:4608
    v_mul_f32 v188, s51, v188
    v_mfma_f32_32x32x16_bf16 v[192:207], v[84:87], v[244:247], v[192:207]
    ds_read_b64_tr_b16 v[244:245], v9 offset:22528
    ds_read_b64_tr_b16 v[246:247], v9 offset:23040
    v_mul_f32 v189, s51, v189
    v_cvt_pk_bf16_f32 v182, v188, v189
    s_waitcnt lgkmcnt(8)
    v_mfma_f32_32x32x16_bf16 v[192:207], v[88:91], v[224:227], v[192:207]
    ds_read_b64_tr_b16 v[224:225], v9 offset:6144
    ds_read_b64_tr_b16 v[226:227], v9 offset:6656
    v_mul_f32 v190, s51, v190
    v_mfma_f32_32x32x16_bf16 v[192:207], v[124:127], v[228:231], v[192:207]
    ds_read_b64_tr_b16 v[228:229], v9 offset:24576
    ds_read_b64_tr_b16 v[230:231], v9 offset:25088
    v_mul_f32 v191, s51, v191
    v_cvt_pk_bf16_f32 v183, v190, v191
    s_waitcnt lgkmcnt(8)
    v_mfma_f32_32x32x16_bf16 v[192:207], v[92:95], v[232:235], v[192:207]
    ds_read_b64_tr_b16 v[232:233], v9 offset:8192
    ds_read_b64_tr_b16 v[234:235], v9 offset:8704
    buffer_store_dwordx4 v[176:179], v14, s[56:59], s52 offen sc0 sc1
    v_mfma_f32_32x32x16_bf16 v[192:207], v[128:131], v[236:239], v[192:207]
    ds_read_b64_tr_b16 v[236:237], v9 offset:26624
    ds_read_b64_tr_b16 v[238:239], v9 offset:27136
    buffer_store_dwordx4 v[180:183], v14, s[56:59], s53 offen sc0 sc1
    s_waitcnt lgkmcnt(8)
    v_mfma_f32_32x32x16_bf16 v[192:207], v[96:99], v[240:243], v[192:207]
    ds_read_b64_tr_b16 v[240:241], v9 offset:10240
    ds_read_b64_tr_b16 v[242:243], v9 offset:10752
    s_cmp_ge_u32 s50, 36
    s_cselect_b32 s47, 36, 0
    v_mfma_f32_32x32x16_bf16 v[192:207], v[132:135], v[244:247], v[192:207]
    ds_read_b64_tr_b16 v[244:245], v9 offset:28672
    ds_read_b64_tr_b16 v[246:247], v9 offset:29184
    s_cselect_b32 s48, 32, 65536
    s_waitcnt lgkmcnt(8)
    v_mfma_f32_32x32x16_bf16 v[192:207], v[100:103], v[224:227], v[192:207]
    ds_read_b64_tr_b16 v[224:225], v9 offset:12288
    ds_read_b64_tr_b16 v[226:227], v9 offset:12800
    s_cselect_b32 s56, 0x600000, 0x0
    v_mfma_f32_32x32x16_bf16 v[192:207], v[136:139], v[228:231], v[192:207]
    ds_read_b64_tr_b16 v[228:229], v9 offset:30720
    ds_read_b64_tr_b16 v[230:231], v9 offset:31232
    s_cselect_b32 s58, s32, s33
    s_cselect_b64 s[34:35], -1, 0
    s_waitcnt lgkmcnt(8)
    v_mfma_f32_32x32x16_bf16 v[192:207], v[104:107], v[232:235], v[192:207]
    ds_read_b64_tr_b16 v[232:233], v9 offset:14336
    ds_read_b64_tr_b16 v[234:235], v9 offset:14848
    s_sub_u32 s52, s50, s47
    v_mfma_f32_32x32x16_bf16 v[192:207], v[140:143], v[236:239], v[192:207]
    ds_read_b64_tr_b16 v[236:237], v9 offset:32768
    ds_read_b64_tr_b16 v[238:239], v9 offset:33280
    s_lshl_b32 s52, s52, 17
    s_waitcnt lgkmcnt(8)
    v_mfma_f32_32x32x16_bf16 v[192:207], v[108:111], v[240:243], v[192:207]
    ds_read_b64_tr_b16 v[240:241], v9 offset:16384
    ds_read_b64_tr_b16 v[242:243], v9 offset:16896
    s_add_u32 s53, s52, s48
    s_add_u32 s56, s12, s56
    v_mfma_f32_32x32x16_bf16 v[192:207], v[144:147], v[244:247], v[192:207]
    ds_read_b64_tr_b16 v[244:245], v9 offset:34816
    ds_read_b64_tr_b16 v[246:247], v9 offset:35328
    s_addc_u32 s57, s13, 0
    s_waitcnt lgkmcnt(8)
    v_mfma_f32_32x32x16_bf16 v[192:207], v[112:115], v[224:227], v[192:207]
    v_add_u32 v8, 73728, v7
    ds_read_b64_tr_b16 v[224:225], v8 offset:0
    ds_read_b64_tr_b16 v[226:227], v8 offset:512
    s_mov_b32 s59, 0x20000
    v_mfma_f32_32x32x16_bf16 v[192:207], v[148:151], v[228:231], v[192:207]
    ds_read_b64_tr_b16 v[228:229], v8 offset:18432
    ds_read_b64_tr_b16 v[230:231], v8 offset:18944
    v_cndmask_b32 v14, v12, v13, s[34:35]
    s_cmp_lt_u32 s50, 18
    s_waitcnt lgkmcnt(8)
    v_mfma_f32_32x32x16_bf16 v[192:207], v[116:119], v[232:235], v[192:207]
    ds_read_b64_tr_b16 v[232:233], v8 offset:2048
    ds_read_b64_tr_b16 v[234:235], v8 offset:2560
    s_cselect_b32 s51, s36, s37
    v_mfma_f32_32x32x16_bf16 v[192:207], v[152:155], v[236:239], v[192:207]
    ds_read_b64_tr_b16 v[236:237], v8 offset:20480
    ds_read_b64_tr_b16 v[238:239], v8 offset:20992
    s_add_u32 s50, s50, 1
    s_waitcnt lgkmcnt(8)
    v_mfma_f32_32x32x16_bf16 v[192:207], v[120:123], v[240:243], v[192:207]
    ds_read_b64_tr_b16 v[240:241], v8 offset:4096
    ds_read_b64_tr_b16 v[242:243], v8 offset:4608
    v_mfma_f32_32x32x16_bf16 v[192:207], v[156:159], v[244:247], v[192:207]
    ds_read_b64_tr_b16 v[244:245], v8 offset:22528
    ds_read_b64_tr_b16 v[246:247], v8 offset:23040
k1_kernel_e_7:
    s_cmp_ge_u32 s50, 36
    s_cbranch_scc1 k1_kernel_v_8
    s_waitcnt lgkmcnt(8)
    v_mfma_f32_32x32x16_bf16 v[208:223], v[224:227], v[16:19], 0
    ds_read_b64_tr_b16 v[224:225], v8 offset:6144
    ds_read_b64_tr_b16 v[226:227], v8 offset:6656
    v_mfma_f32_32x32x16_bf16 v[208:223], v[228:231], v[52:55], v[208:223]
    ds_read_b64_tr_b16 v[228:229], v8 offset:24576
    ds_read_b64_tr_b16 v[230:231], v8 offset:25088
    s_waitcnt lgkmcnt(8)
    v_mfma_f32_32x32x16_bf16 v[208:223], v[232:235], v[20:23], v[208:223]
    ds_read_b64_tr_b16 v[232:233], v8 offset:8192
    ds_read_b64_tr_b16 v[234:235], v8 offset:8704
    v_mfma_f32_32x32x16_bf16 v[208:223], v[236:239], v[56:59], v[208:223]
    ds_read_b64_tr_b16 v[236:237], v8 offset:26624
    ds_read_b64_tr_b16 v[238:239], v8 offset:27136
    v_mul_f32 v192, s51, v192
    v_mul_f32 v193, s51, v193
    s_waitcnt lgkmcnt(8)
    v_mfma_f32_32x32x16_bf16 v[208:223], v[240:243], v[24:27], v[208:223]
    ds_read_b64_tr_b16 v[240:241], v8 offset:10240
    ds_read_b64_tr_b16 v[242:243], v8 offset:10752
    v_cvt_pk_bf16_f32 v192, v192, v193
    v_mfma_f32_32x32x16_bf16 v[208:223], v[244:247], v[60:63], v[208:223]
    ds_read_b64_tr_b16 v[244:245], v8 offset:28672
    ds_read_b64_tr_b16 v[246:247], v8 offset:29184
    v_mul_f32 v194, s51, v194
    v_mul_f32 v195, s51, v195
    s_waitcnt lgkmcnt(8)
    v_mfma_f32_32x32x16_bf16 v[208:223], v[224:227], v[28:31], v[208:223]
    ds_read_b64_tr_b16 v[224:225], v8 offset:12288
    ds_read_b64_tr_b16 v[226:227], v8 offset:12800
    v_cvt_pk_bf16_f32 v193, v194, v195
    v_mfma_f32_32x32x16_bf16 v[208:223], v[228:231], v[64:67], v[208:223]
    ds_read_b64_tr_b16 v[228:229], v8 offset:30720
    ds_read_b64_tr_b16 v[230:231], v8 offset:31232
    v_mul_f32 v196, s51, v196
    s_waitcnt lgkmcnt(8)
    v_mfma_f32_32x32x16_bf16 v[208:223], v[232:235], v[32:35], v[208:223]
    ds_read_b64_tr_b16 v[232:233], v8 offset:14336
    ds_read_b64_tr_b16 v[234:235], v8 offset:14848
    v_mul_f32 v197, s51, v197
    v_cvt_pk_bf16_f32 v194, v196, v197
    v_mfma_f32_32x32x16_bf16 v[208:223], v[236:239], v[68:71], v[208:223]
    ds_read_b64_tr_b16 v[236:237], v8 offset:32768
    ds_read_b64_tr_b16 v[238:239], v8 offset:33280
    v_mul_f32 v198, s51, v198
    s_waitcnt lgkmcnt(8)
    v_mfma_f32_32x32x16_bf16 v[208:223], v[240:243], v[36:39], v[208:223]
    ds_read_b64_tr_b16 v[240:241], v8 offset:16384
    ds_read_b64_tr_b16 v[242:243], v8 offset:16896
    v_mul_f32 v199, s51, v199
    v_mfma_f32_32x32x16_bf16 v[208:223], v[244:247], v[72:75], v[208:223]
    ds_read_b64_tr_b16 v[244:245], v8 offset:34816
    ds_read_b64_tr_b16 v[246:247], v8 offset:35328
    v_cvt_pk_bf16_f32 v195, v198, v199
    v_mul_f32 v200, s51, v200
    s_waitcnt lgkmcnt(8)
    v_mfma_f32_32x32x16_bf16 v[208:223], v[224:227], v[40:43], v[208:223]
    v_add_u32 v9, 110592, v7
    ds_read_b64_tr_b16 v[224:225], v9 offset:0
    ds_read_b64_tr_b16 v[226:227], v9 offset:512
    v_mul_f32 v201, s51, v201
    v_mfma_f32_32x32x16_bf16 v[208:223], v[228:231], v[76:79], v[208:223]
    ds_read_b64_tr_b16 v[228:229], v9 offset:18432
    ds_read_b64_tr_b16 v[230:231], v9 offset:18944
    v_cvt_pk_bf16_f32 v196, v200, v201
    s_waitcnt lgkmcnt(8)
    v_mfma_f32_32x32x16_bf16 v[208:223], v[232:235], v[44:47], v[208:223]
    ds_read_b64_tr_b16 v[232:233], v9 offset:2048
    ds_read_b64_tr_b16 v[234:235], v9 offset:2560
    v_mul_f32 v202, s51, v202
    v_mul_f32 v203, s51, v203
    v_mfma_f32_32x32x16_bf16 v[208:223], v[236:239], v[80:83], v[208:223]
    ds_read_b64_tr_b16 v[236:237], v9 offset:20480
    ds_read_b64_tr_b16 v[238:239], v9 offset:20992
    v_cvt_pk_bf16_f32 v197, v202, v203
    s_waitcnt lgkmcnt(8)
    v_mfma_f32_32x32x16_bf16 v[208:223], v[240:243], v[48:51], v[208:223]
    ds_read_b64_tr_b16 v[240:241], v9 offset:4096
    ds_read_b64_tr_b16 v[242:243], v9 offset:4608
    v_mul_f32 v204, s51, v204
    v_mfma_f32_32x32x16_bf16 v[208:223], v[244:247], v[84:87], v[208:223]
    ds_read_b64_tr_b16 v[244:245], v9 offset:22528
    ds_read_b64_tr_b16 v[246:247], v9 offset:23040
    v_mul_f32 v205, s51, v205
    v_cvt_pk_bf16_f32 v198, v204, v205
    s_waitcnt lgkmcnt(8)
    v_mfma_f32_32x32x16_bf16 v[208:223], v[224:227], v[88:91], v[208:223]
    ds_read_b64_tr_b16 v[224:225], v9 offset:6144
    ds_read_b64_tr_b16 v[226:227], v9 offset:6656
    v_mul_f32 v206, s51, v206
    v_mfma_f32_32x32x16_bf16 v[208:223], v[228:231], v[124:127], v[208:223]
    ds_read_b64_tr_b16 v[228:229], v9 offset:24576
    ds_read_b64_tr_b16 v[230:231], v9 offset:25088
    v_mul_f32 v207, s51, v207
    v_cvt_pk_bf16_f32 v199, v206, v207
    s_waitcnt lgkmcnt(8)
    v_mfma_f32_32x32x16_bf16 v[208:223], v[232:235], v[92:95], v[208:223]
    ds_read_b64_tr_b16 v[232:233], v9 offset:8192
    ds_read_b64_tr_b16 v[234:235], v9 offset:8704
    buffer_store_dwordx4 v[192:195], v14, s[56:59], s52 offen sc0 sc1
    v_mfma_f32_32x32x16_bf16 v[208:223], v[236:239], v[128:131], v[208:223]
    ds_read_b64_tr_b16 v[236:237], v9 offset:26624
    ds_read_b64_tr_b16 v[238:239], v9 offset:27136
    buffer_store_dwordx4 v[196:199], v14, s[56:59], s53 offen sc0 sc1
    s_waitcnt lgkmcnt(8)
    v_mfma_f32_32x32x16_bf16 v[208:223], v[240:243], v[96:99], v[208:223]
    ds_read_b64_tr_b16 v[240:241], v9 offset:10240
    ds_read_b64_tr_b16 v[242:243], v9 offset:10752
    s_cmp_ge_u32 s50, 36
    s_cselect_b32 s47, 36, 0
    v_mfma_f32_32x32x16_bf16 v[208:223], v[244:247], v[132:135], v[208:223]
    ds_read_b64_tr_b16 v[244:245], v9 offset:28672
    ds_read_b64_tr_b16 v[246:247], v9 offset:29184
    s_cselect_b32 s48, 32, 65536
    s_waitcnt lgkmcnt(8)
    v_mfma_f32_32x32x16_bf16 v[208:223], v[224:227], v[100:103], v[208:223]
    ds_read_b64_tr_b16 v[224:225], v9 offset:12288
    ds_read_b64_tr_b16 v[226:227], v9 offset:12800
    s_cselect_b32 s56, 0x600000, 0x0
    v_mfma_f32_32x32x16_bf16 v[208:223], v[228:231], v[136:139], v[208:223]
    ds_read_b64_tr_b16 v[228:229], v9 offset:30720
    ds_read_b64_tr_b16 v[230:231], v9 offset:31232
    s_cselect_b32 s58, s32, s33
    s_cselect_b64 s[34:35], -1, 0
    s_waitcnt lgkmcnt(8)
    v_mfma_f32_32x32x16_bf16 v[208:223], v[232:235], v[104:107], v[208:223]
    ds_read_b64_tr_b16 v[232:233], v9 offset:14336
    ds_read_b64_tr_b16 v[234:235], v9 offset:14848
    s_sub_u32 s52, s50, s47
    v_mfma_f32_32x32x16_bf16 v[208:223], v[236:239], v[140:143], v[208:223]
    ds_read_b64_tr_b16 v[236:237], v9 offset:32768
    ds_read_b64_tr_b16 v[238:239], v9 offset:33280
    s_lshl_b32 s52, s52, 17
    s_waitcnt lgkmcnt(8)
    v_mfma_f32_32x32x16_bf16 v[208:223], v[240:243], v[108:111], v[208:223]
    ds_read_b64_tr_b16 v[240:241], v9 offset:16384
    ds_read_b64_tr_b16 v[242:243], v9 offset:16896
    s_add_u32 s53, s52, s48
    s_add_u32 s56, s12, s56
    v_mfma_f32_32x32x16_bf16 v[208:223], v[244:247], v[144:147], v[208:223]
    ds_read_b64_tr_b16 v[244:245], v9 offset:34816
    ds_read_b64_tr_b16 v[246:247], v9 offset:35328
    s_addc_u32 s57, s13, 0
    s_waitcnt lgkmcnt(8)
    v_mfma_f32_32x32x16_bf16 v[208:223], v[224:227], v[112:115], v[208:223]
    s_barrier
    v_add_u32 v8, 0, v6
    ds_read_b64_tr_b16 v[224:225], v8 offset:0
    ds_read_b64_tr_b16 v[226:227], v8 offset:512
    s_mov_b32 s59, 0x20000
    v_mfma_f32_32x32x16_bf16 v[208:223], v[228:231], v[148:151], v[208:223]
    ds_read_b64_tr_b16 v[228:229], v8 offset:18432
    ds_read_b64_tr_b16 v[230:231], v8 offset:18944
    v_cndmask_b32 v14, v12, v13, s[34:35]
    s_cmp_lt_u32 s50, 18
    s_waitcnt lgkmcnt(8)
    v_mfma_f32_32x32x16_bf16 v[208:223], v[232:235], v[116:119], v[208:223]
    ds_read_b64_tr_b16 v[232:233], v8 offset:2048
    ds_read_b64_tr_b16 v[234:235], v8 offset:2560
    s_cselect_b32 s51, s36, s37
    v_mfma_f32_32x32x16_bf16 v[208:223], v[236:239], v[152:155], v[208:223]
    ds_read_b64_tr_b16 v[236:237], v8 offset:20480
    ds_read_b64_tr_b16 v[238:239], v8 offset:20992
    s_add_u32 s50, s50, 1
    s_waitcnt lgkmcnt(8)
    v_mfma_f32_32x32x16_bf16 v[208:223], v[240:243], v[120:123], v[208:223]
    ds_read_b64_tr_b16 v[240:241], v8 offset:4096
    ds_read_b64_tr_b16 v[242:243], v8 offset:4608
    v_mfma_f32_32x32x16_bf16 v[208:223], v[244:247], v[156:159], v[208:223]
    ds_read_b64_tr_b16 v[244:245], v8 offset:22528
    ds_read_b64_tr_b16 v[246:247], v8 offset:23040
    s_branch k1_kernel_e_9
k1_kernel_v_8:
    s_waitcnt lgkmcnt(8)
    v_mfma_f32_32x32x16_bf16 v[208:223], v[16:19], v[224:227], 0
    ds_read_b64_tr_b16 v[224:225], v8 offset:6144
    ds_read_b64_tr_b16 v[226:227], v8 offset:6656
    v_mfma_f32_32x32x16_bf16 v[208:223], v[52:55], v[228:231], v[208:223]
    ds_read_b64_tr_b16 v[228:229], v8 offset:24576
    ds_read_b64_tr_b16 v[230:231], v8 offset:25088
    s_waitcnt lgkmcnt(8)
    v_mfma_f32_32x32x16_bf16 v[208:223], v[20:23], v[232:235], v[208:223]
    ds_read_b64_tr_b16 v[232:233], v8 offset:8192
    ds_read_b64_tr_b16 v[234:235], v8 offset:8704
    v_mfma_f32_32x32x16_bf16 v[208:223], v[56:59], v[236:239], v[208:223]
    ds_read_b64_tr_b16 v[236:237], v8 offset:26624
    ds_read_b64_tr_b16 v[238:239], v8 offset:27136
    v_mul_f32 v192, s51, v192
    v_mul_f32 v193, s51, v193
    s_waitcnt lgkmcnt(8)
    v_mfma_f32_32x32x16_bf16 v[208:223], v[24:27], v[240:243], v[208:223]
    ds_read_b64_tr_b16 v[240:241], v8 offset:10240
    ds_read_b64_tr_b16 v[242:243], v8 offset:10752
    v_cvt_pk_bf16_f32 v192, v192, v193
    v_mfma_f32_32x32x16_bf16 v[208:223], v[60:63], v[244:247], v[208:223]
    ds_read_b64_tr_b16 v[244:245], v8 offset:28672
    ds_read_b64_tr_b16 v[246:247], v8 offset:29184
    v_mul_f32 v194, s51, v194
    v_mul_f32 v195, s51, v195
    s_waitcnt lgkmcnt(8)
    v_mfma_f32_32x32x16_bf16 v[208:223], v[28:31], v[224:227], v[208:223]
    ds_read_b64_tr_b16 v[224:225], v8 offset:12288
    ds_read_b64_tr_b16 v[226:227], v8 offset:12800
    v_cvt_pk_bf16_f32 v193, v194, v195
    v_mfma_f32_32x32x16_bf16 v[208:223], v[64:67], v[228:231], v[208:223]
    ds_read_b64_tr_b16 v[228:229], v8 offset:30720
    ds_read_b64_tr_b16 v[230:231], v8 offset:31232
    v_mul_f32 v196, s51, v196
    s_waitcnt lgkmcnt(8)
    v_mfma_f32_32x32x16_bf16 v[208:223], v[32:35], v[232:235], v[208:223]
    ds_read_b64_tr_b16 v[232:233], v8 offset:14336
    ds_read_b64_tr_b16 v[234:235], v8 offset:14848
    v_mul_f32 v197, s51, v197
    v_cvt_pk_bf16_f32 v194, v196, v197
    v_mfma_f32_32x32x16_bf16 v[208:223], v[68:71], v[236:239], v[208:223]
    ds_read_b64_tr_b16 v[236:237], v8 offset:32768
    ds_read_b64_tr_b16 v[238:239], v8 offset:33280
    v_mul_f32 v198, s51, v198
    s_waitcnt lgkmcnt(8)
    v_mfma_f32_32x32x16_bf16 v[208:223], v[36:39], v[240:243], v[208:223]
    ds_read_b64_tr_b16 v[240:241], v8 offset:16384
    ds_read_b64_tr_b16 v[242:243], v8 offset:16896
    v_mul_f32 v199, s51, v199
    v_mfma_f32_32x32x16_bf16 v[208:223], v[72:75], v[244:247], v[208:223]
    ds_read_b64_tr_b16 v[244:245], v8 offset:34816
    ds_read_b64_tr_b16 v[246:247], v8 offset:35328
    v_cvt_pk_bf16_f32 v195, v198, v199
    v_mul_f32 v200, s51, v200
    s_waitcnt lgkmcnt(8)
    v_mfma_f32_32x32x16_bf16 v[208:223], v[40:43], v[224:227], v[208:223]
    v_add_u32 v9, 110592, v7
    ds_read_b64_tr_b16 v[224:225], v9 offset:0
    ds_read_b64_tr_b16 v[226:227], v9 offset:512
    v_mul_f32 v201, s51, v201
    v_mfma_f32_32x32x16_bf16 v[208:223], v[76:79], v[228:231], v[208:223]
    ds_read_b64_tr_b16 v[228:229], v9 offset:18432
    ds_read_b64_tr_b16 v[230:231], v9 offset:18944
    v_cvt_pk_bf16_f32 v196, v200, v201
    s_waitcnt lgkmcnt(8)
    v_mfma_f32_32x32x16_bf16 v[208:223], v[44:47], v[232:235], v[208:223]
    ds_read_b64_tr_b16 v[232:233], v9 offset:2048
    ds_read_b64_tr_b16 v[234:235], v9 offset:2560
    v_mul_f32 v202, s51, v202
    v_mul_f32 v203, s51, v203
    v_mfma_f32_32x32x16_bf16 v[208:223], v[80:83], v[236:239], v[208:223]
    ds_read_b64_tr_b16 v[236:237], v9 offset:20480
    ds_read_b64_tr_b16 v[238:239], v9 offset:20992
    v_cvt_pk_bf16_f32 v197, v202, v203
    s_waitcnt lgkmcnt(8)
    v_mfma_f32_32x32x16_bf16 v[208:223], v[48:51], v[240:243], v[208:223]
    ds_read_b64_tr_b16 v[240:241], v9 offset:4096
    ds_read_b64_tr_b16 v[242:243], v9 offset:4608
    v_mul_f32 v204, s51, v204
    v_mfma_f32_32x32x16_bf16 v[208:223], v[84:87], v[244:247], v[208:223]
    ds_read_b64_tr_b16 v[244:245], v9 offset:22528
    ds_read_b64_tr_b16 v[246:247], v9 offset:23040
    v_mul_f32 v205, s51, v205
    v_cvt_pk_bf16_f32 v198, v204, v205
    s_waitcnt lgkmcnt(8)
    v_mfma_f32_32x32x16_bf16 v[208:223], v[88:91], v[224:227], v[208:223]
    ds_read_b64_tr_b16 v[224:225], v9 offset:6144
    ds_read_b64_tr_b16 v[226:227], v9 offset:6656
    v_mul_f32 v206, s51, v206
    v_mfma_f32_32x32x16_bf16 v[208:223], v[124:127], v[228:231], v[208:223]
    ds_read_b64_tr_b16 v[228:229], v9 offset:24576
    ds_read_b64_tr_b16 v[230:231], v9 offset:25088
    v_mul_f32 v207, s51, v207
    v_cvt_pk_bf16_f32 v199, v206, v207
    s_waitcnt lgkmcnt(8)
    v_mfma_f32_32x32x16_bf16 v[208:223], v[92:95], v[232:235], v[208:223]
    ds_read_b64_tr_b16 v[232:233], v9 offset:8192
    ds_read_b64_tr_b16 v[234:235], v9 offset:8704
    buffer_store_dwordx4 v[192:195], v14, s[56:59], s52 offen sc0 sc1
    v_mfma_f32_32x32x16_bf16 v[208:223], v[128:131], v[236:239], v[208:223]
    ds_read_b64_tr_b16 v[236:237], v9 offset:26624
    ds_read_b64_tr_b16 v[238:239], v9 offset:27136
    buffer_store_dwordx4 v[196:199], v14, s[56:59], s53 offen sc0 sc1
    s_waitcnt lgkmcnt(8)
    v_mfma_f32_32x32x16_bf16 v[208:223], v[96:99], v[240:243], v[208:223]
    ds_read_b64_tr_b16 v[240:241], v9 offset:10240
    ds_read_b64_tr_b16 v[242:243], v9 offset:10752
    s_cmp_ge_u32 s50, 36
    s_cselect_b32 s47, 36, 0
    v_mfma_f32_32x32x16_bf16 v[208:223], v[132:135], v[244:247], v[208:223]
    ds_read_b64_tr_b16 v[244:245], v9 offset:28672
    ds_read_b64_tr_b16 v[246:247], v9 offset:29184
    s_cselect_b32 s48, 32, 65536
    s_waitcnt lgkmcnt(8)
    v_mfma_f32_32x32x16_bf16 v[208:223], v[100:103], v[224:227], v[208:223]
    ds_read_b64_tr_b16 v[224:225], v9 offset:12288
    ds_read_b64_tr_b16 v[226:227], v9 offset:12800
    s_cselect_b32 s56, 0x600000, 0x0
    v_mfma_f32_32x32x16_bf16 v[208:223], v[136:139], v[228:231], v[208:223]
    ds_read_b64_tr_b16 v[228:229], v9 offset:30720
    ds_read_b64_tr_b16 v[230:231], v9 offset:31232
    s_cselect_b32 s58, s32, s33
    s_cselect_b64 s[34:35], -1, 0
    s_waitcnt lgkmcnt(8)
    v_mfma_f32_32x32x16_bf16 v[208:223], v[104:107], v[232:235], v[208:223]
    ds_read_b64_tr_b16 v[232:233], v9 offset:14336
    ds_read_b64_tr_b16 v[234:235], v9 offset:14848
    s_sub_u32 s52, s50, s47
    v_mfma_f32_32x32x16_bf16 v[208:223], v[140:143], v[236:239], v[208:223]
    ds_read_b64_tr_b16 v[236:237], v9 offset:32768
    ds_read_b64_tr_b16 v[238:239], v9 offset:33280
    s_lshl_b32 s52, s52, 17
    s_waitcnt lgkmcnt(8)
    v_mfma_f32_32x32x16_bf16 v[208:223], v[108:111], v[240:243], v[208:223]
    ds_read_b64_tr_b16 v[240:241], v9 offset:16384
    ds_read_b64_tr_b16 v[242:243], v9 offset:16896
    s_add_u32 s53, s52, s48
    s_add_u32 s56, s12, s56
    v_mfma_f32_32x32x16_bf16 v[208:223], v[144:147], v[244:247], v[208:223]
    ds_read_b64_tr_b16 v[244:245], v9 offset:34816
    ds_read_b64_tr_b16 v[246:247], v9 offset:35328
    s_addc_u32 s57, s13, 0
    s_waitcnt lgkmcnt(8)
    v_mfma_f32_32x32x16_bf16 v[208:223], v[112:115], v[224:227], v[208:223]
    s_barrier
    v_add_u32 v8, 0, v6
    ds_read_b64_tr_b16 v[224:225], v8 offset:0
    ds_read_b64_tr_b16 v[226:227], v8 offset:512
    s_mov_b32 s59, 0x20000
    v_mfma_f32_32x32x16_bf16 v[208:223], v[148:151], v[228:231], v[208:223]
    ds_read_b64_tr_b16 v[228:229], v8 offset:18432
    ds_read_b64_tr_b16 v[230:231], v8 offset:18944
    v_cndmask_b32 v14, v12, v13, s[34:35]
    s_cmp_lt_u32 s50, 18
    s_waitcnt lgkmcnt(8)
    v_mfma_f32_32x32x16_bf16 v[208:223], v[116:119], v[232:235], v[208:223]
    ds_read_b64_tr_b16 v[232:233], v8 offset:2048
    ds_read_b64_tr_b16 v[234:235], v8 offset:2560
    s_cselect_b32 s51, s36, s37
    v_mfma_f32_32x32x16_bf16 v[208:223], v[152:155], v[236:239], v[208:223]
    ds_read_b64_tr_b16 v[236:237], v8 offset:20480
    ds_read_b64_tr_b16 v[238:239], v8 offset:20992
    s_add_u32 s50, s50, 1
    s_waitcnt lgkmcnt(8)
    v_mfma_f32_32x32x16_bf16 v[208:223], v[120:123], v[240:243], v[208:223]
    ds_read_b64_tr_b16 v[240:241], v8 offset:4096
    ds_read_b64_tr_b16 v[242:243], v8 offset:4608
    v_mfma_f32_32x32x16_bf16 v[208:223], v[156:159], v[244:247], v[208:223]
    ds_read_b64_tr_b16 v[244:245], v8 offset:22528
    ds_read_b64_tr_b16 v[246:247], v8 offset:23040
k1_kernel_e_9:
    s_cmp_le_u32 s42, 2
    s_cbranch_scc1 k1_kernel_fin2
    s_cmp_ge_u32 s50, 36
    s_cbranch_scc1 k1_kernel_v_10
    s_waitcnt lgkmcnt(8)
    v_mfma_f32_32x32x16_bf16 v[160:175], v[224:227], v[16:19], 0
    ds_read_b64_tr_b16 v[224:225], v8 offset:6144
    ds_read_b64_tr_b16 v[226:227], v8 offset:6656
    v_mfma_f32_32x32x16_bf16 v[160:175], v[228:231], v[52:55], v[160:175]
    ds_read_b64_tr_b16 v[228:229], v8 offset:24576
    ds_read_b64_tr_b16 v[230:231], v8 offset:25088
    s_waitcnt lgkmcnt(8)
    v_mfma_f32_32x32x16_bf16 v[160:175], v[232:235], v[20:23], v[160:175]
    ds_read_b64_tr_b16 v[232:233], v8 offset:8192
    ds_read_b64_tr_b16 v[234:235], v8 offset:8704
    v_mfma_f32_32x32x16_bf16 v[160:175], v[236:239], v[56:59], v[160:175]
    ds_read_b64_tr_b16 v[236:237], v8 offset:26624
    ds_read_b64_tr_b16 v[238:239], v8 offset:27136
    v_mul_f32 v208, s51, v208
    v_mul_f32 v209, s51, v209
    s_waitcnt lgkmcnt(8)
    v_mfma_f32_32x32x16_bf16 v[160:175], v[240:243], v[24:27], v[160:175]
    ds_read_b64_tr_b16 v[240:241], v8 offset:10240
    ds_read_b64_tr_b16 v[242:243], v8 offset:10752
    v_cvt_pk_bf16_f32 v208, v208, v209
    v_mfma_f32_32x32x16_bf16 v[160:175], v[244:247], v[60:63], v[160:175]
    ds_read_b64_tr_b16 v[244:245], v8 offset:28672
    ds_read_b64_tr_b16 v[246:247], v8 offset:29184
    v_mul_f32 v210, s51, v210
    v_mul_f32 v211, s51, v211
    s_waitcnt lgkmcnt(8)
    v_mfma_f32_32x32x16_bf16 v[160:175], v[224:227], v[28:31], v[160:175]
    ds_read_b64_tr_b16 v[224:225], v8 offset:12288
    ds_read_b64_tr_b16 v[226:227], v8 offset:12800
    v_cvt_pk_bf16_f32 v209, v210, v211
    v_mfma_f32_32x32x16_bf16 v[160:175], v[228:231], v[64:67], v[160:175]
    ds_read_b64_tr_b16 v[228:229], v8 offset:30720
    ds_read_b64_tr_b16 v[230:231], v8 offset:31232
    v_mul_f32 v212, s51, v212
    s_waitcnt lgkmcnt(8)
    v_mfma_f32_32x32x16_bf16 v[160:175], v[232:235], v[32:35], v[160:175]
    ds_read_b64_tr_b16 v[232:233], v8 offset:14336
    ds_read_b64_tr_b16 v[234:235], v8 offset:14848
    v_mul_f32 v213, s51, v213
    v_cvt_pk_bf16_f32 v210, v212, v213
    v_mfma_f32_32x32x16_bf16 v[160:175], v[236:239], v[68:71], v[160:175]
    ds_read_b64_tr_b16 v[236:237], v8 offset:32768
    ds_read_b64_tr_b16 v[238:239], v8 offset:33280
    v_mul_f32 v214, s51, v214
    s_waitcnt lgkmcnt(8)
    v_mfma_f32_32x32x16_bf16 v[160:175], v[240:243], v[36:39], v[160:175]
    ds_read_b64_tr_b16 v[240:241], v8 offset:16384
    ds_read_b64_tr_b16 v[242:243], v8 offset:16896
    v_mul_f32 v215, s51, v215
    v_mfma_f32_32x32x16_bf16 v[160:175], v[244:247], v[72:75], v[160:175]
    ds_read_b64_tr_b16 v[244:245], v8 offset:34816
    ds_read_b64_tr_b16 v[246:247], v8 offset:35328
    v_cvt_pk_bf16_f32 v211, v214, v215
    v_mul_f32 v216, s51, v216
    s_waitcnt lgkmcnt(8)
    v_mfma_f32_32x32x16_bf16 v[160:175], v[224:227], v[40:43], v[160:175]
    s_barrier
    v_add_u32 v9, 36864, v6
    ds_read_b64_tr_b16 v[224:225], v9 offset:0
    ds_read_b64_tr_b16 v[226:227], v9 offset:512
    v_mul_f32 v217, s51, v217
    v_mfma_f32_32x32x16_bf16 v[160:175], v[228:231], v[76:79], v[160:175]
    ds_read_b64_tr_b16 v[228:229], v9 offset:18432
    ds_read_b64_tr_b16 v[230:231], v9 offset:18944
    v_cvt_pk_bf16_f32 v212, v216, v217
    s_waitcnt lgkmcnt(8)
    v_mfma_f32_32x32x16_bf16 v[160:175], v[232:235], v[44:47], v[160:175]
    ds_read_b64_tr_b16 v[232:233], v9 offset:2048
    ds_read_b64_tr_b16 v[234:235], v9 offset:2560
    v_mul_f32 v218, s51, v218
    v_mul_f32 v219, s51, v219
    v_mfma_f32_32x32x16_bf16 v[160:175], v[236:239], v[80:83], v[160:175]
    ds_read_b64_tr_b16 v[236:237], v9 offset:20480
    ds_read_b64_tr_b16 v[238:239], v9 offset:20992
    v_cvt_pk_bf16_f32 v213, v218, v219
    s_waitcnt lgkmcnt(8)
    v_mfma_f32_32x32x16_bf16 v[160:175], v[240:243], v[48:51], v[160:175]
    ds_read_b64_tr_b16 v[240:241], v9 offset:4096
    ds_read_b64_tr_b16 v[242:243], v9 offset:4608
    v_mul_f32 v220, s51, v220
    v_mfma_f32_32x32x16_bf16 v[160:175], v[244:247], v[84:87], v[160:175]
    ds_read_b64_tr_b16 v[244:245], v9 offset:22528
    ds_read_b64_tr_b16 v[246:247], v9 offset:23040
    v_mul_f32 v221, s51, v221
    v_cvt_pk_bf16_f32 v214, v220, v221
    s_waitcnt lgkmcnt(8)
    v_mfma_f32_32x32x16_bf16 v[160:175], v[224:227], v[88:91], v[160:175]
    ds_read_b64_tr_b16 v[224:225], v9 offset:6144
    ds_read_b64_tr_b16 v[226:227], v9 offset:6656
    v_mul_f32 v222, s51, v222
    v_mfma_f32_32x32x16_bf16 v[160:175], v[228:231], v[124:127], v[160:175]
    ds_read_b64_tr_b16 v[228:229], v9 offset:24576
    ds_read_b64_tr_b16 v[230:231], v9 offset:25088
    v_mul_f32 v223, s51, v223
    v_cvt_pk_bf16_f32 v215, v222, v223
    s_waitcnt lgkmcnt(8)
    v_mfma_f32_32x32x16_bf16 v[160:175], v[232:235], v[92:95], v[160:175]
    ds_read_b64_tr_b16 v[232:233], v9 offset:8192
    ds_read_b64_tr_b16 v[234:235], v9 offset:8704
    buffer_store_dwordx4 v[208:211], v14, s[56:59], s52 offen sc0 sc1
    v_mfma_f32_32x32x16_bf16 v[160:175], v[236:239], v[128:131], v[160:175]
    ds_read_b64_tr_b16 v[236:237], v9 offset:26624
    ds_read_b64_tr_b16 v[238:239], v9 offset:27136
    buffer_store_dwordx4 v[212:215], v14, s[56:59], s53 offen sc0 sc1
    s_waitcnt lgkmcnt(8)
    v_mfma_f32_32x32x16_bf16 v[160:175], v[240:243], v[96:99], v[160:175]
    ds_read_b64_tr_b16 v[240:241], v9 offset:10240
    ds_read_b64_tr_b16 v[242:243], v9 offset:10752
    s_cmp_ge_u32 s50, 36
    s_cselect_b32 s47, 36, 0
    v_mfma_f32_32x32x16_bf16 v[160:175], v[244:247], v[132:135], v[160:175]
    ds_read_b64_tr_b16 v[244:245], v9 offset:28672
    ds_read_b64_tr_b16 v[246:247], v9 offset:29184
    s_cselect_b32 s48, 32, 65536
    s_waitcnt lgkmcnt(8)
    v_mfma_f32_32x32x16_bf16 v[160:175], v[224:227], v[100:103], v[160:175]
    ds_read_b64_tr_b16 v[224:225], v9 offset:12288
    ds_read_b64_tr_b16 v[226:227], v9 offset:12800
    s_cselect_b32 s56, 0x600000, 0x0
    v_mfma_f32_32x32x16_bf16 v[160:175], v[228:231], v[136:139], v[160:175]
    ds_read_b64_tr_b16 v[228:229], v9 offset:30720
    ds_read_b64_tr_b16 v[230:231], v9 offset:31232
    s_cselect_b32 s58, s32, s33
    s_cselect_b64 s[34:35], -1, 0
    s_waitcnt lgkmcnt(8)
    v_mfma_f32_32x32x16_bf16 v[160:175], v[232:235], v[104:107], v[160:175]
    ds_read_b64_tr_b16 v[232:233], v9 offset:14336
    ds_read_b64_tr_b16 v[234:235], v9 offset:14848
    s_sub_u32 s52, s50, s47
    v_mfma_f32_32x32x16_bf16 v[160:175], v[236:239], v[140:143], v[160:175]
    ds_read_b64_tr_b16 v[236:237], v9 offset:32768
    ds_read_b64_tr_b16 v[238:239], v9 offset:33280
    s_lshl_b32 s52, s52, 17
    s_waitcnt lgkmcnt(8)
    v_mfma_f32_32x32x16_bf16 v[160:175], v[240:243], v[108:111], v[160:175]
    ds_read_b64_tr_b16 v[240:241], v9 offset:16384
    ds_read_b64_tr_b16 v[242:243], v9 offset:16896
    s_add_u32 s53, s52, s48
    s_add_u32 s56, s12, s56
    v_mfma_f32_32x32x16_bf16 v[160:175], v[244:247], v[144:147], v[160:175]
    ds_read_b64_tr_b16 v[244:245], v9 offset:34816
    ds_read_b64_tr_b16 v[246:247], v9 offset:35328
    s_addc_u32 s57, s13, 0
    s_waitcnt lgkmcnt(8)
    v_mfma_f32_32x32x16_bf16 v[160:175], v[224:227], v[112:115], v[160:175]
    v_add_u32 v8, 0, v7
    ds_read_b64_tr_b16 v[224:225], v8 offset:0
    ds_read_b64_tr_b16 v[226:227], v8 offset:512
    s_mov_b32 s59, 0x20000
    v_mfma_f32_32x32x16_bf16 v[160:175], v[228:231], v[148:151], v[160:175]
    ds_read_b64_tr_b16 v[228:229], v8 offset:18432
    ds_read_b64_tr_b16 v[230:231], v8 offset:18944
    v_cndmask_b32 v14, v12, v13, s[34:35]
    s_cmp_lt_u32 s50, 18
    s_waitcnt lgkmcnt(8)
    v_mfma_f32_32x32x16_bf16 v[160:175], v[232:235], v[116:119], v[160:175]
    ds_read_b64_tr_b16 v[232:233], v8 offset:2048
    ds_read_b64_tr_b16 v[234:235], v8 offset:2560
    s_cselect_b32 s51, s36, s37
    v_mfma_f32_32x32x16_bf16 v[160:175], v[236:239], v[152:155], v[160:175]
    ds_read_b64_tr_b16 v[236:237], v8 offset:20480
    ds_read_b64_tr_b16 v[238:239], v8 offset:20992
    s_add_u32 s50, s50, 1
    s_waitcnt lgkmcnt(8)
    v_mfma_f32_32x32x16_bf16 v[160:175], v[240:243], v[120:123], v[160:175]
    ds_read_b64_tr_b16 v[240:241], v8 offset:4096
    ds_read_b64_tr_b16 v[242:243], v8 offset:4608
    v_mfma_f32_32x32x16_bf16 v[160:175], v[244:247], v[156:159], v[160:175]
    ds_read_b64_tr_b16 v[244:245], v8 offset:22528
    ds_read_b64_tr_b16 v[246:247], v8 offset:23040
    s_branch k1_kernel_e_11
k1_kernel_v_10:
    s_waitcnt lgkmcnt(8)
    v_mfma_f32_32x32x16_bf16 v[160:175], v[16:19], v[224:227], 0
    ds_read_b64_tr_b16 v[224:225], v8 offset:6144
    ds_read_b64_tr_b16 v[226:227], v8 offset:6656
    v_mfma_f32_32x32x16_bf16 v[160:175], v[52:55], v[228:231], v[160:175]
    ds_read_b64_tr_b16 v[228:229], v8 offset:24576
    ds_read_b64_tr_b16 v[230:231], v8 offset:25088
    s_waitcnt lgkmcnt(8)
    v_mfma_f32_32x32x16_bf16 v[160:175], v[20:23], v[232:235], v[160:175]
    ds_read_b64_tr_b16 v[232:233], v8 offset:8192
    ds_read_b64_tr_b16 v[234:235], v8 offset:8704
    v_mfma_f32_32x32x16_bf16 v[160:175], v[56:59], v[236:239], v[160:175]
    ds_read_b64_tr_b16 v[236:237], v8 offset:26624
    ds_read_b64_tr_b16 v[238:239], v8 offset:27136
    v_mul_f32 v208, s51, v208
    v_mul_f32 v209, s51, v209
    s_waitcnt lgkmcnt(8)
    v_mfma_f32_32x32x16_bf16 v[160:175], v[24:27], v[240:243], v[160:175]
    ds_read_b64_tr_b16 v[240:241], v8 offset:10240
    ds_read_b64_tr_b16 v[242:243], v8 offset:10752
    v_cvt_pk_bf16_f32 v208, v208, v209
    v_mfma_f32_32x32x16_bf16 v[160:175], v[60:63], v[244:247], v[160:175]
    ds_read_b64_tr_b16 v[244:245], v8 offset:28672
    ds_read_b64_tr_b16 v[246:247], v8 offset:29184
    v_mul_f32 v210, s51, v210
    v_mul_f32 v211, s51, v211
    s_waitcnt lgkmcnt(8)
    v_mfma_f32_32x32x16_bf16 v[160:175], v[28:31], v[224:227], v[160:175]
    ds_read_b64_tr_b16 v[224:225], v8 offset:12288
    ds_read_b64_tr_b16 v[226:227], v8 offset:12800
    v_cvt_pk_bf16_f32 v209, v210, v211
    v_mfma_f32_32x32x16_bf16 v[160:175], v[64:67], v[228:231], v[160:175]
    ds_read_b64_tr_b16 v[228:229], v8 offset:30720
    ds_read_b64_tr_b16 v[230:231], v8 offset:31232
    v_mul_f32 v212, s51, v212
    s_waitcnt lgkmcnt(8)
    v_mfma_f32_32x32x16_bf16 v[160:175], v[32:35], v[232:235], v[160:175]
    ds_read_b64_tr_b16 v[232:233], v8 offset:14336
    ds_read_b64_tr_b16 v[234:235], v8 offset:14848
    v_mul_f32 v213, s51, v213
    v_cvt_pk_bf16_f32 v210, v212, v213
    v_mfma_f32_32x32x16_bf16 v[160:175], v[68:71], v[236:239], v[160:175]
    ds_read_b64_tr_b16 v[236:237], v8 offset:32768
    ds_read_b64_tr_b16 v[238:239], v8 offset:33280
    v_mul_f32 v214, s51, v214
    s_waitcnt lgkmcnt(8)
    v_mfma_f32_32x32x16_bf16 v[160:175], v[36:39], v[240:243], v[160:175]
    ds_read_b64_tr_b16 v[240:241], v8 offset:16384
    ds_read_b64_tr_b16 v[242:243], v8 offset:16896
    v_mul_f32 v215, s51, v215
    v_mfma_f32_32x32x16_bf16 v[160:175], v[72:75], v[244:247], v[160:175]
    ds_read_b64_tr_b16 v[244:245], v8 offset:34816
    ds_read_b64_tr_b16 v[246:247], v8 offset:35328
    v_cvt_pk_bf16_f32 v211, v214, v215
    v_mul_f32 v216, s51, v216
    s_waitcnt lgkmcnt(8)
    v_mfma_f32_32x32x16_bf16 v[160:175], v[40:43], v[224:227], v[160:175]
    s_barrier
    v_add_u32 v9, 36864, v6
    ds_read_b64_tr_b16 v[224:225], v9 offset:0
    ds_read_b64_tr_b16 v[226:227], v9 offset:512
    v_mul_f32 v217, s51, v217
    v_mfma_f32_32x32x16_bf16 v[160:175], v[76:79], v[228:231], v[160:175]
    ds_read_b64_tr_b16 v[228:229], v9 offset:18432
    ds_read_b64_tr_b16 v[230:231], v9 offset:18944
    v_cvt_pk_bf16_f32 v212, v216, v217
    s_waitcnt lgkmcnt(8)
    v_mfma_f32_32x32x16_bf16 v[160:175], v[44:47], v[232:235], v[160:175]
    ds_read_b64_tr_b16 v[232:233], v9 offset:2048
    ds_read_b64_tr_b16 v[234:235], v9 offset:2560
    v_mul_f32 v218, s51, v218
    v_mul_f32 v219, s51, v219
    v_mfma_f32_32x32x16_bf16 v[160:175], v[80:83], v[236:239], v[160:175]
    ds_read_b64_tr_b16 v[236:237], v9 offset:20480
    ds_read_b64_tr_b16 v[238:239], v9 offset:20992
    v_cvt_pk_bf16_f32 v213, v218, v219
    s_waitcnt lgkmcnt(8)
    v_mfma_f32_32x32x16_bf16 v[160:175], v[48:51], v[240:243], v[160:175]
    ds_read_b64_tr_b16 v[240:241], v9 offset:4096
    ds_read_b64_tr_b16 v[242:243], v9 offset:4608
    v_mul_f32 v220, s51, v220
    v_mfma_f32_32x32x16_bf16 v[160:175], v[84:87], v[244:247], v[160:175]
    ds_read_b64_tr_b16 v[244:245], v9 offset:22528
    ds_read_b64_tr_b16 v[246:247], v9 offset:23040
    v_mul_f32 v221, s51, v221
    v_cvt_pk_bf16_f32 v214, v220, v221
    s_waitcnt lgkmcnt(8)
    v_mfma_f32_32x32x16_bf16 v[160:175], v[88:91], v[224:227], v[160:175]
    ds_read_b64_tr_b16 v[224:225], v9 offset:6144
    ds_read_b64_tr_b16 v[226:227], v9 offset:6656
    v_mul_f32 v222, s51, v222
    v_mfma_f32_32x32x16_bf16 v[160:175], v[124:127], v[228:231], v[160:175]
    ds_read_b64_tr_b16 v[228:229], v9 offset:24576
    ds_read_b64_tr_b16 v[230:231], v9 offset:25088
    v_mul_f32 v223, s51, v223
    v_cvt_pk_bf16_f32 v215, v222, v223
    s_waitcnt lgkmcnt(8)
    v_mfma_f32_32x32x16_bf16 v[160:175], v[92:95], v[232:235], v[160:175]
    ds_read_b64_tr_b16 v[232:233], v9 offset:8192
    ds_read_b64_tr_b16 v[234:235], v9 offset:8704
    buffer_store_dwordx4 v[208:211], v14, s[56:59], s52 offen sc0 sc1
    v_mfma_f32_32x32x16_bf16 v[160:175], v[128:131], v[236:239], v[160:175]
    ds_read_b64_tr_b16 v[236:237], v9 offset:26624
    ds_read_b64_tr_b16 v[238:239], v9 offset:27136
    buffer_store_dwordx4 v[212:215], v14, s[56:59], s53 offen sc0 sc1
    s_waitcnt lgkmcnt(8)
    v_mfma_f32_32x32x16_bf16 v[160:175], v[96:99], v[240:243], v[160:175]
    ds_read_b64_tr_b16 v[240:241], v9 offset:10240
    ds_read_b64_tr_b16 v[242:243], v9 offset:10752
    s_cmp_ge_u32 s50, 36
    s_cselect_b32 s47, 36, 0
    v_mfma_f32_32x32x16_bf16 v[160:175], v[132:135], v[244:247], v[160:175]
    ds_read_b64_tr_b16 v[244:245], v9 offset:28672
    ds_read_b64_tr_b16 v[246:247], v9 offset:29184
    s_cselect_b32 s48, 32, 65536
    s_waitcnt lgkmcnt(8)
    v_mfma_f32_32x32x16_bf16 v[160:175], v[100:103], v[224:227], v[160:175]
    ds_read_b64_tr_b16 v[224:225], v9 offset:12288
    ds_read_b64_tr_b16 v[226:227], v9 offset:12800
    s_cselect_b32 s56, 0x600000, 0x0
    v_mfma_f32_32x32x16_bf16 v[160:175], v[136:139], v[228:231], v[160:175]
    ds_read_b64_tr_b16 v[228:229], v9 offset:30720
    ds_read_b64_tr_b16 v[230:231], v9 offset:31232
    s_cselect_b32 s58, s32, s33
    s_cselect_b64 s[34:35], -1, 0
    s_waitcnt lgkmcnt(8)
    v_mfma_f32_32x32x16_bf16 v[160:175], v[104:107], v[232:235], v[160:175]
    ds_read_b64_tr_b16 v[232:233], v9 offset:14336
    ds_read_b64_tr_b16 v[234:235], v9 offset:14848
    s_sub_u32 s52, s50, s47
    v_mfma_f32_32x32x16_bf16 v[160:175], v[140:143], v[236:239], v[160:175]
    ds_read_b64_tr_b16 v[236:237], v9 offset:32768
    ds_read_b64_tr_b16 v[238:239], v9 offset:33280
    s_lshl_b32 s52, s52, 17
    s_waitcnt lgkmcnt(8)
    v_mfma_f32_32x32x16_bf16 v[160:175], v[108:111], v[240:243], v[160:175]
    ds_read_b64_tr_b16 v[240:241], v9 offset:16384
    ds_read_b64_tr_b16 v[242:243], v9 offset:16896
    s_add_u32 s53, s52, s48
    s_add_u32 s56, s12, s56
    v_mfma_f32_32x32x16_bf16 v[160:175], v[144:147], v[244:247], v[160:175]
    ds_read_b64_tr_b16 v[244:245], v9 offset:34816
    ds_read_b64_tr_b16 v[246:247], v9 offset:35328
    s_addc_u32 s57, s13, 0
    s_waitcnt lgkmcnt(8)
    v_mfma_f32_32x32x16_bf16 v[160:175], v[112:115], v[224:227], v[160:175]
    v_add_u32 v8, 0, v7
    ds_read_b64_tr_b16 v[224:225], v8 offset:0
    ds_read_b64_tr_b16 v[226:227], v8 offset:512
    s_mov_b32 s59, 0x20000
    v_mfma_f32_32x32x16_bf16 v[160:175], v[148:151], v[228:231], v[160:175]
    ds_read_b64_tr_b16 v[228:229], v8 offset:18432
    ds_read_b64_tr_b16 v[230:231], v8 offset:18944
    v_cndmask_b32 v14, v12, v13, s[34:35]
    s_cmp_lt_u32 s50, 18
    s_waitcnt lgkmcnt(8)
    v_mfma_f32_32x32x16_bf16 v[160:175], v[116:119], v[232:235], v[160:175]
    ds_read_b64_tr_b16 v[232:233], v8 offset:2048
    ds_read_b64_tr_b16 v[234:235], v8 offset:2560
    s_cselect_b32 s51, s36, s37
    v_mfma_f32_32x32x16_bf16 v[160:175], v[152:155], v[236:239], v[160:175]
    ds_read_b64_tr_b16 v[236:237], v8 offset:20480
    ds_read_b64_tr_b16 v[238:239], v8 offset:20992
    s_add_u32 s50, s50, 1
    s_waitcnt lgkmcnt(8)
    v_mfma_f32_32x32x16_bf16 v[160:175], v[120:123], v[240:243], v[160:175]
    ds_read_b64_tr_b16 v[240:241], v8 offset:4096
    ds_read_b64_tr_b16 v[242:243], v8 offset:4608
    v_mfma_f32_32x32x16_bf16 v[160:175], v[156:159], v[244:247], v[160:175]
    ds_read_b64_tr_b16 v[244:245], v8 offset:22528
    ds_read_b64_tr_b16 v[246:247], v8 offset:23040
k1_kernel_e_11:
    s_cmp_ge_u32 s50, 36
    s_cbranch_scc1 k1_kernel_v_12
    s_waitcnt lgkmcnt(8)
    v_mfma_f32_32x32x16_bf16 v[176:191], v[224:227], v[16:19], 0
    ds_read_b64_tr_b16 v[224:225], v8 offset:6144
    ds_read_b64_tr_b16 v[226:227], v8 offset:6656
    v_mfma_f32_32x32x16_bf16 v[176:191], v[228:231], v[52:55], v[176:191]
    ds_read_b64_tr_b16 v[228:229], v8 offset:24576
    ds_read_b64_tr_b16 v[230:231], v8 offset:25088
    s_waitcnt lgkmcnt(8)
    v_mfma_f32_32x32x16_bf16 v[176:191], v[232:235], v[20:23], v[176:191]
    ds_read_b64_tr_b16 v[232:233], v8 offset:8192
    ds_read_b64_tr_b16 v[234:235], v8 offset:8704
    v_mfma_f32_32x32x16_bf16 v[176:191], v[236:239], v[56:59], v[176:191]
    ds_read_b64_tr_b16 v[236:237], v8 offset:26624
    ds_read_b64_tr_b16 v[238:239], v8 offset:27136
    v_mul_f32 v160, s51, v160
    v_mul_f32 v161, s51, v161
    s_waitcnt lgkmcnt(8)
    v_mfma_f32_32x32x16_bf16 v[176:191], v[240:243], v[24:27], v[176:191]
    ds_read_b64_tr_b16 v[240:241], v8 offset:10240
    ds_read_b64_tr_b16 v[242:243], v8 offset:10752
    v_cvt_pk_bf16_f32 v160, v160, v161
    v_mfma_f32_32x32x16_bf16 v[176:191], v[244:247], v[60:63], v[176:191]
    ds_read_b64_tr_b16 v[244:245], v8 offset:28672
    ds_read_b64_tr_b16 v[246:247], v8 offset:29184
    v_mul_f32 v162, s51, v162
    v_mul_f32 v163, s51, v163
    s_waitcnt lgkmcnt(8)
    v_mfma_f32_32x32x16_bf16 v[176:191], v[224:227], v[28:31], v[176:191]
    ds_read_b64_tr_b16 v[224:225], v8 offset:12288
    ds_read_b64_tr_b16 v[226:227], v8 offset:12800
    v_cvt_pk_bf16_f32 v161, v162, v163
    v_mfma_f32_32x32x16_bf16 v[176:191], v[228:231], v[64:67], v[176:191]
    ds_read_b64_tr_b16 v[228:229], v8 offset:30720
    ds_read_b64_tr_b16 v[230:231], v8 offset:31232
    v_mul_f32 v164, s51, v164
    s_waitcnt lgkmcnt(8)
    v_mfma_f32_32x32x16_bf16 v[176:191], v[232:235], v[32:35], v[176:191]
    ds_read_b64_tr_b16 v[232:233], v8 offset:14336
    ds_read_b64_tr_b16 v[234:235], v8 offset:14848
    v_mul_f32 v165, s51, v165
    v_cvt_pk_bf16_f32 v162, v164, v165
    v_mfma_f32_32x32x16_bf16 v[176:191], v[236:239], v[68:71], v[176:191]
    ds_read_b64_tr_b16 v[236:237], v8 offset:32768
    ds_read_b64_tr_b16 v[238:239], v8 offset:33280
    v_mul_f32 v166, s51, v166
    s_waitcnt lgkmcnt(8)
    v_mfma_f32_32x32x16_bf16 v[176:191], v[240:243], v[36:39], v[176:191]
    ds_read_b64_tr_b16 v[240:241], v8 offset:16384
    ds_read_b64_tr_b16 v[242:243], v8 offset:16896
    v_mul_f32 v167, s51, v167
    v_mfma_f32_32x32x16_bf16 v[176:191], v[244:247], v[72:75], v[176:191]
    ds_read_b64_tr_b16 v[244:245], v8 offset:34816
    ds_read_b64_tr_b16 v[246:247], v8 offset:35328
    v_cvt_pk_bf16_f32 v163, v166, v167
    v_mul_f32 v168, s51, v168
    s_waitcnt lgkmcnt(8)
    v_mfma_f32_32x32x16_bf16 v[176:191], v[224:227], v[40:43], v[176:191]
    v_add_u32 v9, 36864, v7
    ds_read_b64_tr_b16 v[224:225], v9 offset:0
    ds_read_b64_tr_b16 v[226:227], v9 offset:512
    v_mul_f32 v169, s51, v169
    v_mfma_f32_32x32x16_bf16 v[176:191], v[228:231], v[76:79], v[176:191]
    ds_read_b64_tr_b16 v[228:229], v9 offset:18432
    ds_read_b64_tr_b16 v[230:231], v9 offset:18944
    v_cvt_pk_bf16_f32 v164, v168, v169
    s_waitcnt lgkmcnt(8)
    v_mfma_f32_32x32x16_bf16 v[176:191], v[232:235], v[44:47], v[176:191]
    ds_read_b64_tr_b16 v[232:233], v9 offset:2048
    ds_read_b64_tr_b16 v[234:235], v9 offset:2560
    v_mul_f32 v170, s51, v170
    v_mul_f32 v171, s51, v171
    v_mfma_f32_32x32x16_bf16 v[176:191], v[236:239], v[80:83], v[176:191]
    ds_read_b64_tr_b16 v[236:237], v9 offset:20480
    ds_read_b64_tr_b16 v[238:239], v9 offset:20992
    v_cvt_pk_bf16_f32 v165, v170, v171
    s_waitcnt lgkmcnt(8)
    v_mfma_f32_32x32x16_bf16 v[176:191], v[240:243], v[48:51], v[176:191]
    ds_read_b64_tr_b16 v[240:241], v9 offset:4096
    ds_read_b64_tr_b16 v[242:243], v9 offset:4608
    v_mul_f32 v172, s51, v172
    v_mfma_f32_32x32x16_bf16 v[176:191], v[244:247], v[84:87], v[176:191]
    ds_read_b64_tr_b16 v[244:245], v9 offset:22528
    ds_read_b64_tr_b16 v[246:247], v9 offset:23040
    v_mul_f32 v173, s51, v173
    v_cvt_pk_bf16_f32 v166, v172, v173
    s_waitcnt lgkmcnt(8)
    v_mfma_f32_32x32x16_bf16 v[176:191], v[224:227], v[88:91], v[176:191]
    ds_read_b64_tr_b16 v[224:225], v9 offset:6144
    ds_read_b64_tr_b16 v[226:227], v9 offset:6656
    v_mul_f32 v174, s51, v174
    v_mfma_f32_32x32x16_bf16 v[176:191], v[228:231], v[124:127], v[176:191]
    ds_read_b64_tr_b16 v[228:229], v9 offset:24576
    ds_read_b64_tr_b16 v[230:231], v9 offset:25088
    v_mul_f32 v175, s51, v175
    v_cvt_pk_bf16_f32 v167, v174, v175
    s_waitcnt lgkmcnt(8)
    v_mfma_f32_32x32x16_bf16 v[176:191], v[232:235], v[92:95], v[176:191]
    ds_read_b64_tr_b16 v[232:233], v9 offset:8192
    ds_read_b64_tr_b16 v[234:235], v9 offset:8704
    buffer_store_dwordx4 v[160:163], v14, s[56:59], s52 offen sc0 sc1
    v_mfma_f32_32x32x16_bf16 v[176:191], v[236:239], v[128:131], v[176:191]
    ds_read_b64_tr_b16 v[236:237], v9 offset:26624
    ds_read_b64_tr_b16 v[238:239], v9 offset:27136
    buffer_store_dwordx4 v[164:167], v14, s[56:59], s53 offen sc0 sc1
    s_waitcnt lgkmcnt(8)
    v_mfma_f32_32x32x16_bf16 v[176:191], v[240:243], v[96:99], v[176:191]
    ds_read_b64_tr_b16 v[240:241], v9 offset:10240
    ds_read_b64_tr_b16 v[242:243], v9 offset:10752
    s_cmp_ge_u32 s50, 36
    s_cselect_b32 s47, 36, 0
    v_mfma_f32_32x32x16_bf16 v[176:191], v[244:247], v[132:135], v[176:191]
    ds_read_b64_tr_b16 v[244:245], v9 offset:28672
    ds_read_b64_tr_b16 v[246:247], v9 offset:29184
    s_cselect_b32 s48, 32, 65536
    s_waitcnt lgkmcnt(8)
    v_mfma_f32_32x32x16_bf16 v[176:191], v[224:227], v[100:103], v[176:191]
    ds_read_b64_tr_b16 v[224:225], v9 offset:12288
    ds_read_b64_tr_b16 v[226:227], v9 offset:12800
    s_cselect_b32 s56, 0x600000, 0x0
    v_mfma_f32_32x32x16_bf16 v[176:191], v[228:231], v[136:139], v[176:191]
    ds_read_b64_tr_b16 v[228:229], v9 offset:30720
    ds_read_b64_tr_b16 v[230:231], v9 offset:31232
    s_cselect_b32 s58, s32, s33
    s_cselect_b64 s[34:35], -1, 0
    s_waitcnt lgkmcnt(8)
    v_mfma_f32_32x32x16_bf16 v[176:191], v[232:235], v[104:107], v[176:191]
    ds_read_b64_tr_b16 v[232:233], v9 offset:14336
    ds_read_b64_tr_b16 v[234:235], v9 offset:14848
    s_sub_u32 s52, s50, s47
    v_mfma_f32_32x32x16_bf16 v[176:191], v[236:239], v[140:143], v[176:191]
    ds_read_b64_tr_b16 v[236:237], v9 offset:32768
    ds_read_b64_tr_b16 v[238:239], v9 offset:33280
    s_lshl_b32 s52, s52, 17
    s_waitcnt lgkmcnt(8)
    v_mfma_f32_32x32x16_bf16 v[176:191], v[240:243], v[108:111], v[176:191]
    ds_read_b64_tr_b16 v[240:241], v9 offset:16384
    ds_read_b64_tr_b16 v[242:243], v9 offset:16896
    s_add_u32 s53, s52, s48
    s_add_u32 s56, s12, s56
    v_mfma_f32_32x32x16_bf16 v[176:191], v[244:247], v[144:147], v[176:191]
    ds_read_b64_tr_b16 v[244:245], v9 offset:34816
    ds_read_b64_tr_b16 v[246:247], v9 offset:35328
    s_addc_u32 s57, s13, 0
    s_waitcnt lgkmcnt(8)
    v_mfma_f32_32x32x16_bf16 v[176:191], v[224:227], v[112:115], v[176:191]
    s_mov_b32 s59, 0x20000
    v_mfma_f32_32x32x16_bf16 v[176:191], v[228:231], v[148:151], v[176:191]
    v_cndmask_b32 v14, v12, v13, s[34:35]
    s_cmp_lt_u32 s50, 18
    s_waitcnt lgkmcnt(4)
    v_mfma_f32_32x32x16_bf16 v[176:191], v[232:235], v[116:119], v[176:191]
    s_cselect_b32 s51, s36, s37
    v_mfma_f32_32x32x16_bf16 v[176:191], v[236:239], v[152:155], v[176:191]
    s_add_u32 s50, s50, 1
    s_waitcnt lgkmcnt(0)
    v_mfma_f32_32x32x16_bf16 v[176:191], v[240:243], v[120:123], v[176:191]
    v_mfma_f32_32x32x16_bf16 v[176:191], v[244:247], v[156:159], v[176:191]
    s_branch k1_kernel_e_13
k1_kernel_v_12:
    s_waitcnt lgkmcnt(8)
    v_mfma_f32_32x32x16_bf16 v[176:191], v[16:19], v[224:227], 0
    ds_read_b64_tr_b16 v[224:225], v8 offset:6144
    ds_read_b64_tr_b16 v[226:227], v8 offset:6656
    v_mfma_f32_32x32x16_bf16 v[176:191], v[52:55], v[228:231], v[176:191]
    ds_read_b64_tr_b16 v[228:229], v8 offset:24576
    ds_read_b64_tr_b16 v[230:231], v8 offset:25088
    s_waitcnt lgkmcnt(8)
    v_mfma_f32_32x32x16_bf16 v[176:191], v[20:23], v[232:235], v[176:191]
    ds_read_b64_tr_b16 v[232:233], v8 offset:8192
    ds_read_b64_tr_b16 v[234:235], v8 offset:8704
    v_mfma_f32_32x32x16_bf16 v[176:191], v[56:59], v[236:239], v[176:191]
    ds_read_b64_tr_b16 v[236:237], v8 offset:26624
    ds_read_b64_tr_b16 v[238:239], v8 offset:27136
    v_mul_f32 v160, s51, v160
    v_mul_f32 v161, s51, v161
    s_waitcnt lgkmcnt(8)
    v_mfma_f32_32x32x16_bf16 v[176:191], v[24:27], v[240:243], v[176:191]
    ds_read_b64_tr_b16 v[240:241], v8 offset:10240
    ds_read_b64_tr_b16 v[242:243], v8 offset:10752
    v_cvt_pk_bf16_f32 v160, v160, v161
    v_mfma_f32_32x32x16_bf16 v[176:191], v[60:63], v[244:247], v[176:191]
    ds_read_b64_tr_b16 v[244:245], v8 offset:28672
    ds_read_b64_tr_b16 v[246:247], v8 offset:29184
    v_mul_f32 v162, s51, v162
    v_mul_f32 v163, s51, v163
    s_waitcnt lgkmcnt(8)
    v_mfma_f32_32x32x16_bf16 v[176:191], v[28:31], v[224:227], v[176:191]
    ds_read_b64_tr_b16 v[224:225], v8 offset:12288
    ds_read_b64_tr_b16 v[226:227], v8 offset:12800
    v_cvt_pk_bf16_f32 v161, v162, v163
    v_mfma_f32_32x32x16_bf16 v[176:191], v[64:67], v[228:231], v[176:191]
    ds_read_b64_tr_b16 v[228:229], v8 offset:30720
    ds_read_b64_tr_b16 v[230:231], v8 offset:31232
    v_mul_f32 v164, s51, v164
    s_waitcnt lgkmcnt(8)
    v_mfma_f32_32x32x16_bf16 v[176:191], v[32:35], v[232:235], v[176:191]
    ds_read_b64_tr_b16 v[232:233], v8 offset:14336
    ds_read_b64_tr_b16 v[234:235], v8 offset:14848
    v_mul_f32 v165, s51, v165
    v_cvt_pk_bf16_f32 v162, v164, v165
    v_mfma_f32_32x32x16_bf16 v[176:191], v[68:71], v[236:239], v[176:191]
    ds_read_b64_tr_b16 v[236:237], v8 offset:32768
    ds_read_b64_tr_b16 v[238:239], v8 offset:33280
    v_mul_f32 v166, s51, v166
    s_waitcnt lgkmcnt(8)
    v_mfma_f32_32x32x16_bf16 v[176:191], v[36:39], v[240:243], v[176:191]
    ds_read_b64_tr_b16 v[240:241], v8 offset:16384
    ds_read_b64_tr_b16 v[242:243], v8 offset:16896
    v_mul_f32 v167, s51, v167
    v_mfma_f32_32x32x16_bf16 v[176:191], v[72:75], v[244:247], v[176:191]
    ds_read_b64_tr_b16 v[244:245], v8 offset:34816
    ds_read_b64_tr_b16 v[246:247], v8 offset:35328
    v_cvt_pk_bf16_f32 v163, v166, v167
    v_mul_f32 v168, s51, v168
    s_waitcnt lgkmcnt(8)
    v_mfma_f32_32x32x16_bf16 v[176:191], v[40:43], v[224:227], v[176:191]
    v_add_u32 v9, 36864, v7
    ds_read_b64_tr_b16 v[224:225], v9 offset:0
    ds_read_b64_tr_b16 v[226:227], v9 offset:512
    v_mul_f32 v169, s51, v169
    v_mfma_f32_32x32x16_bf16 v[176:191], v[76:79], v[228:231], v[176:191]
    ds_read_b64_tr_b16 v[228:229], v9 offset:18432
    ds_read_b64_tr_b16 v[230:231], v9 offset:18944
    v_cvt_pk_bf16_f32 v164, v168, v169
    s_waitcnt lgkmcnt(8)
    v_mfma_f32_32x32x16_bf16 v[176:191], v[44:47], v[232:235], v[176:191]
    ds_read_b64_tr_b16 v[232:233], v9 offset:2048
    ds_read_b64_tr_b16 v[234:235], v9 offset:2560
    v_mul_f32 v170, s51, v170
    v_mul_f32 v171, s51, v171
    v_mfma_f32_32x32x16_bf16 v[176:191], v[80:83], v[236:239], v[176:191]
    ds_read_b64_tr_b16 v[236:237], v9 offset:20480
    ds_read_b64_tr_b16 v[238:239], v9 offset:20992
    v_cvt_pk_bf16_f32 v165, v170, v171
    s_waitcnt lgkmcnt(8)
    v_mfma_f32_32x32x16_bf16 v[176:191], v[48:51], v[240:243], v[176:191]
    ds_read_b64_tr_b16 v[240:241], v9 offset:4096
    ds_read_b64_tr_b16 v[242:243], v9 offset:4608
    v_mul_f32 v172, s51, v172
    v_mfma_f32_32x32x16_bf16 v[176:191], v[84:87], v[244:247], v[176:191]
    ds_read_b64_tr_b16 v[244:245], v9 offset:22528
    ds_read_b64_tr_b16 v[246:247], v9 offset:23040
    v_mul_f32 v173, s51, v173
    v_cvt_pk_bf16_f32 v166, v172, v173
    s_waitcnt lgkmcnt(8)
    v_mfma_f32_32x32x16_bf16 v[176:191], v[88:91], v[224:227], v[176:191]
    ds_read_b64_tr_b16 v[224:225], v9 offset:6144
    ds_read_b64_tr_b16 v[226:227], v9 offset:6656
    v_mul_f32 v174, s51, v174
    v_mfma_f32_32x32x16_bf16 v[176:191], v[124:127], v[228:231], v[176:191]
    ds_read_b64_tr_b16 v[228:229], v9 offset:24576
    ds_read_b64_tr_b16 v[230:231], v9 offset:25088
    v_mul_f32 v175, s51, v175
    v_cvt_pk_bf16_f32 v167, v174, v175
    s_waitcnt lgkmcnt(8)
    v_mfma_f32_32x32x16_bf16 v[176:191], v[92:95], v[232:235], v[176:191]
    ds_read_b64_tr_b16 v[232:233], v9 offset:8192
    ds_read_b64_tr_b16 v[234:235], v9 offset:8704
    buffer_store_dwordx4 v[160:163], v14, s[56:59], s52 offen sc0 sc1
    v_mfma_f32_32x32x16_bf16 v[176:191], v[128:131], v[236:239], v[176:191]
    ds_read_b64_tr_b16 v[236:237], v9 offset:26624
    ds_read_b64_tr_b16 v[238:239], v9 offset:27136
    buffer_store_dwordx4 v[164:167], v14, s[56:59], s53 offen sc0 sc1
    s_waitcnt lgkmcnt(8)
    v_mfma_f32_32x32x16_bf16 v[176:191], v[96:99], v[240:243], v[176:191]
    ds_read_b64_tr_b16 v[240:241], v9 offset:10240
    ds_read_b64_tr_b16 v[242:243], v9 offset:10752
    s_cmp_ge_u32 s50, 36
    s_cselect_b32 s47, 36, 0
    v_mfma_f32_32x32x16_bf16 v[176:191], v[132:135], v[244:247], v[176:191]
    ds_read_b64_tr_b16 v[244:245], v9 offset:28672
    ds_read_b64_tr_b16 v[246:247], v9 offset:29184
    s_cselect_b32 s48, 32, 65536
    s_waitcnt lgkmcnt(8)
    v_mfma_f32_32x32x16_bf16 v[176:191], v[100:103], v[224:227], v[176:191]
    ds_read_b64_tr_b16 v[224:225], v9 offset:12288
    ds_read_b64_tr_b16 v[226:227], v9 offset:12800
    s_cselect_b32 s56, 0x600000, 0x0
    v_mfma_f32_32x32x16_bf16 v[176:191], v[136:139], v[228:231], v[176:191]
    ds_read_b64_tr_b16 v[228:229], v9 offset:30720
    ds_read_b64_tr_b16 v[230:231], v9 offset:31232
    s_cselect_b32 s58, s32, s33
    s_cselect_b64 s[34:35], -1, 0
    s_waitcnt lgkmcnt(8)
    v_mfma_f32_32x32x16_bf16 v[176:191], v[104:107], v[232:235], v[176:191]
    ds_read_b64_tr_b16 v[232:233], v9 offset:14336
    ds_read_b64_tr_b16 v[234:235], v9 offset:14848
    s_sub_u32 s52, s50, s47
    v_mfma_f32_32x32x16_bf16 v[176:191], v[140:143], v[236:239], v[176:191]
    ds_read_b64_tr_b16 v[236:237], v9 offset:32768
    ds_read_b64_tr_b16 v[238:239], v9 offset:33280
    s_lshl_b32 s52, s52, 17
    s_waitcnt lgkmcnt(8)
    v_mfma_f32_32x32x16_bf16 v[176:191], v[108:111], v[240:243], v[176:191]
    ds_read_b64_tr_b16 v[240:241], v9 offset:16384
    ds_read_b64_tr_b16 v[242:243], v9 offset:16896
    s_add_u32 s53, s52, s48
    s_add_u32 s56, s12, s56
    v_mfma_f32_32x32x16_bf16 v[176:191], v[144:147], v[244:247], v[176:191]
    ds_read_b64_tr_b16 v[244:245], v9 offset:34816
    ds_read_b64_tr_b16 v[246:247], v9 offset:35328
    s_addc_u32 s57, s13, 0
    s_waitcnt lgkmcnt(8)
    v_mfma_f32_32x32x16_bf16 v[176:191], v[112:115], v[224:227], v[176:191]
    s_mov_b32 s59, 0x20000
    v_mfma_f32_32x32x16_bf16 v[176:191], v[148:151], v[228:231], v[176:191]
    v_cndmask_b32 v14, v12, v13, s[34:35]
    s_cmp_lt_u32 s50, 18
    s_waitcnt lgkmcnt(4)
    v_mfma_f32_32x32x16_bf16 v[176:191], v[116:119], v[232:235], v[176:191]
    s_cselect_b32 s51, s36, s37
    v_mfma_f32_32x32x16_bf16 v[176:191], v[152:155], v[236:239], v[176:191]
    s_add_u32 s50, s50, 1
    s_waitcnt lgkmcnt(0)
    v_mfma_f32_32x32x16_bf16 v[176:191], v[120:123], v[240:243], v[176:191]
    v_mfma_f32_32x32x16_bf16 v[176:191], v[156:159], v[244:247], v[176:191]
k1_kernel_e_13:
    s_nop 7
    s_nop 3
    v_mul_f32 v176, s51, v176
    v_mul_f32 v177, s51, v177
    v_cvt_pk_bf16_f32 v176, v176, v177
    v_mul_f32 v178, s51, v178
    v_mul_f32 v179, s51, v179
    v_cvt_pk_bf16_f32 v177, v178, v179
    v_mul_f32 v180, s51, v180
    v_mul_f32 v181, s51, v181
    v_cvt_pk_bf16_f32 v178, v180, v181
    v_mul_f32 v182, s51, v182
    v_mul_f32 v183, s51, v183
    v_cvt_pk_bf16_f32 v179, v182, v183
    v_mul_f32 v184, s51, v184
    v_mul_f32 v185, s51, v185
    v_cvt_pk_bf16_f32 v180, v184, v185
    v_mul_f32 v186, s51, v186
    v_mul_f32 v187, s51, v187
    v_cvt_pk_bf16_f32 v181, v186, v187
    v_mul_f32 v188, s51, v188
    v_mul_f32 v189, s51, v189
    v_cvt_pk_bf16_f32 v182, v188, v189
    v_mul_f32 v190, s51, v190
    v_mul_f32 v191, s51, v191
    v_cvt_pk_bf16_f32 v183, v190, v191
    buffer_store_dwordx4 v[176:179], v14, s[56:59], s52 offen sc0 sc1
    buffer_store_dwordx4 v[180:183], v14, s[56:59], s53 offen sc0 sc1
    s_branch k1_kernel_done
k1_kernel_fin2:
    s_nop 7
    s_nop 3
    v_mul_f32 v208, s51, v208
    v_mul_f32 v209, s51, v209
    v_cvt_pk_bf16_f32 v208, v208, v209
    v_mul_f32 v210, s51, v210
    v_mul_f32 v211, s51, v211
    v_cvt_pk_bf16_f32 v209, v210, v211
    v_mul_f32 v212, s51, v212
    v_mul_f32 v213, s51, v213
    v_cvt_pk_bf16_f32 v210, v212, v213
    v_mul_f32 v214, s51, v214
    v_mul_f32 v215, s51, v215
    v_cvt_pk_bf16_f32 v211, v214, v215
    v_mul_f32 v216, s51, v216
    v_mul_f32 v217, s51, v217
    v_cvt_pk_bf16_f32 v212, v216, v217
    v_mul_f32 v218, s51, v218
    v_mul_f32 v219, s51, v219
    v_cvt_pk_bf16_f32 v213, v218, v219
    v_mul_f32 v220, s51, v220
    v_mul_f32 v221, s51, v221
    v_cvt_pk_bf16_f32 v214, v220, v221
    v_mul_f32 v222, s51, v222
    v_mul_f32 v223, s51, v223
    v_cvt_pk_bf16_f32 v215, v222, v223
    buffer_store_dwordx4 v[208:211], v14, s[56:59], s52 offen sc0 sc1
    buffer_store_dwordx4 v[212:215], v14, s[56:59], s53 offen sc0 sc1
    s_branch k1_kernel_done
k1_kernel_fin1:
    s_nop 7
    s_nop 3
    v_mul_f32 v176, s51, v176
    v_mul_f32 v177, s51, v177
    v_cvt_pk_bf16_f32 v176, v176, v177
    v_mul_f32 v178, s51, v178
    v_mul_f32 v179, s51, v179
    v_cvt_pk_bf16_f32 v177, v178, v179
    v_mul_f32 v180, s51, v180
    v_mul_f32 v181, s51, v181
    v_cvt_pk_bf16_f32 v178, v180, v181
    v_mul_f32 v182, s51, v182
    v_mul_f32 v183, s51, v183
    v_cvt_pk_bf16_f32 v179, v182, v183
    v_mul_f32 v184, s51, v184
    v_mul_f32 v185, s51, v185
    v_cvt_pk_bf16_f32 v180, v184, v185
    v_mul_f32 v186, s51, v186
    v_mul_f32 v187, s51, v187
    v_cvt_pk_bf16_f32 v181, v186, v187
    v_mul_f32 v188, s51, v188
    v_mul_f32 v189, s51, v189
    v_cvt_pk_bf16_f32 v182, v188, v189
    v_mul_f32 v190, s51, v190
    v_mul_f32 v191, s51, v191
    v_cvt_pk_bf16_f32 v183, v190, v191
    buffer_store_dwordx4 v[176:179], v14, s[56:59], s52 offen sc0 sc1
    buffer_store_dwordx4 v[180:183], v14, s[56:59], s53 offen sc0 sc1
    s_branch k1_kernel_done
k1_kernel_done:
    s_endpgm
k1_kernel_loader:
    s_cmp_eq_u32 s2, 0
    s_cbranch_scc0 k1_kernel_lz_14
    s_add_u32 s28, s12, 0x3400000
    s_addc_u32 s29, s13, 0
    s_mov_b32 s30, 0x3000
    s_mov_b32 s31, 0x20000
    v_lshlrev_b32 v20, 4, v0
    v_subrev_u32 v20, 4096, v20
    v_mov_b32 v24, 0
    v_mov_b32 v25, 0
    v_mov_b32 v26, 0
    v_mov_b32 v27, 0
    s_mov_b32 s32, 0
    buffer_store_dwordx4 v[24:27], v20, s[28:31], s32 offen sc0 sc1
    s_mov_b32 s32, 4096
    buffer_store_dwordx4 v[24:27], v20, s[28:31], s32 offen sc0 sc1
    s_mov_b32 s32, 8192
    buffer_store_dwordx4 v[24:27], v20, s[28:31], s32 offen sc0 sc1
k1_kernel_lz_14:
    s_sub_u32 s3, s3, 4
    s_cmp_ge_u32 s3, 2
    s_cselect_b32 s20, s10, s8
    s_cselect_b32 s21, s11, s9
    s_mov_b32 s22, 0x510000
    s_mov_b32 s23, 0x20000
    s_mov_b32 s24, s6
    s_mov_b32 s25, s7
    s_mov_b32 s26, 0x1e6000
    s_mov_b32 s27, 0x20000
    s_movk_i32 s47, 9216
    v_lshrrev_b32 v4, 3, v1
    v_mul_lo_u32 v10, v4, s47
    v_bfe_u32 v4, v1, 4, 1
    v_lshlrev_b32 v4, 2, v4
    v_and_b32 v5, 7, v1
    v_xor_b32 v4, v4, v5
    v_lshl_add_u32 v10, v4, 4, v10
    s_movk_i32 s48, 3456
    v_lshrrev_b32 v4, 3, v1
    v_mul_lo_u32 v11, v4, s48
    v_bfe_u32 v4, v1, 4, 1
    v_lshlrev_b32 v4, 2, v4
    v_and_b32 v5, 7, v1
    v_xor_b32 v4, v4, v5
    v_lshl_add_u32 v11, v4, 4, v11
    s_and_b32 s53, s15, 7
    s_mul_i32 s53, s53, 9
    v_add_u32 v4, s53, v1
    v_mul_lo_u32 v12, v4, s47
    v_mul_lo_u32 v13, v4, s48
    v_cmp_gt_u32 vcc, 9, v1
    v_mov_b32 v5, 0x7fffffff
    s_nop 1
    v_cndmask_b32 v12, v5, v12, vcc
    v_cndmask_b32 v13, v5, v13, vcc
    s_and_b32 s47, s3, 1
    s_mul_i32 s50, s47, 663552
    s_lshl_b32 s48, s41, 7
    s_add_u32 s50, s50, s48
    s_mul_i32 s51, s47, 248832
    s_lshr_b32 s47, s3, 1
    s_mul_i32 s47, s47, 497664
    s_add_u32 s51, s51, s47
    s_lshl_b32 s48, s43, 7
    s_add_u32 s51, s51, s48
    s_mul_i32 s52, s3, 9216
    s_add_u32 s28, s12, 0x1000000
    s_addc_u32 s29, s13, 0
    s_mov_b32 s30, 0x1200000
    s_mov_b32 s31, 0x20000
    s_lshl_b32 s47, s15, 2
    s_add_u32 s47, s47, s3
    s_mul_i32 s55, s47, 294912
    s_lshl_b32 s47, s41, 12
    s_add_u32 s55, s55, s47
    v_lshlrev_b32 v15, 4, v1
    s_lshl_b32 s47, s3, 11
    s_add_u32 s47, s47, 147456
    v_add_u32 v14, s47, v15
    s_lshl_b32 s44, s40, 1
    s_add_u32 s44, s44, s42
    s_lshl_b32 s44, s44, 1
    s_mov_b32 s49, 0
    s_lshl_b32 s47, s40, 2
    s_cmp_ge_u32 s49, s47
    s_cbranch_scc1 k1_kernel_pq_15
    s_lshr_b32 s47, s49, 2
    s_lshl_b32 s47, s47, 7
    s_and_b32 s48, s49, 3
    s_mul_i32 s48, s48, 1327104
    s_add_u32 s54, s50, s47
    s_add_u32 s54, s54, s48
    buffer_load_dword v20, v12, s[20:23], s54 offen
    s_branch k1_kernel_pd_16
k1_kernel_pq_15:
    s_sub_u32 s47, s49, s47
    s_and_b32 s48, s47, 1
    s_mul_i32 s48, s48, 995328
    s_lshr_b32 s47, s47, 1
    s_lshl_b32 s47, s47, 7
    s_add_u32 s54, s51, s47
    s_add_u32 s54, s54, s48
    s_cmp_ge_u32 s49, s44
    s_cselect_b32 s54, 0x7ffff000, s54
    buffer_load_dword v20, v13, s[24:27], s54 offen
k1_kernel_pd_16:
    s_mov_b32 s49, 1
    s_lshl_b32 s47, s40, 2
    s_cmp_ge_u32 s49, s47
    s_cbranch_scc1 k1_kernel_pq_17
    s_lshr_b32 s47, s49, 2
    s_lshl_b32 s47, s47, 7
    s_and_b32 s48, s49, 3
    s_mul_i32 s48, s48, 1327104
    s_add_u32 s54, s50, s47
    s_add_u32 s54, s54, s48
    buffer_load_dword v20, v12, s[20:23], s54 offen
    s_branch k1_kernel_pd_18
k1_kernel_pq_17:
    s_sub_u32 s47, s49, s47
    s_and_b32 s48, s47, 1
    s_mul_i32 s48, s48, 995328
    s_lshr_b32 s47, s47, 1
    s_lshl_b32 s47, s47, 7
    s_add_u32 s54, s51, s47
    s_add_u32 s54, s54, s48
    s_cmp_ge_u32 s49, s44
    s_cselect_b32 s54, 0x7ffff000, s54
    buffer_load_dword v20, v13, s[24:27], s54 offen
k1_kernel_pd_18:
    s_mov_b32 s49, 2
    s_lshl_b32 s47, s40, 2
    s_cmp_ge_u32 s49, s47
    s_cbranch_scc1 k1_kernel_pq_19
    s_lshr_b32 s47, s49, 2
    s_lshl_b32 s47, s47, 7
    s_and_b32 s48, s49, 3
    s_mul_i32 s48, s48, 1327104
    s_add_u32 s54, s50, s47
    s_add_u32 s54, s54, s48
    buffer_load_dword v20, v12, s[20:23], s54 offen
    s_branch k1_kernel_pd_20
k1_kernel_pq_19:
    s_sub_u32 s47, s49, s47
    s_and_b32 s48, s47, 1
    s_mul_i32 s48, s48, 995328
    s_lshr_b32 s47, s47, 1
    s_lshl_b32 s47, s47, 7
    s_add_u32 s54, s51, s47
    s_add_u32 s54, s54, s48
    s_cmp_ge_u32 s49, s44
    s_cselect_b32 s54, 0x7ffff000, s54
    buffer_load_dword v20, v13, s[24:27], s54 offen
k1_kernel_pd_20:
    s_barrier
    s_mov_b32 s45, 0
k1_kernel_lpro:
    s_and_b32 s47, s45, 3
    s_mul_i32 s47, s47, 36864
    s_add_u32 m0, s47, s52
    s_lshl_b32 s47, s40, 2
    s_cmp_ge_u32 s45, s47
    s_cbranch_scc1 k1_kernel_iq_21
    s_lshr_b32 s47, s45, 2
    s_lshl_b32 s47, s47, 7
    s_and_b32 s48, s45, 3
    s_mul_i32 s48, s48, 1327104
    s_add_u32 s54, s50, s47
    s_add_u32 s54, s54, s48
    buffer_load_dwordx4 v10, s[20:23], s54 offen lds
    s_add_u32 m0, m0, 1024
    s_add_u32 s54, s54, 73728
    buffer_load_dwordx4 v10, s[20:23], s54 offen lds
    s_add_u32 m0, m0, 1024
    s_add_u32 s54, s54, 73728
    buffer_load_dwordx4 v10, s[20:23], s54 offen lds
    s_add_u32 m0, m0, 1024
    s_add_u32 s54, s54, 73728
    buffer_load_dwordx4 v10, s[20:23], s54 offen lds
    s_add_u32 m0, m0, 1024
    s_add_u32 s54, s54, 73728
    buffer_load_dwordx4 v10, s[20:23], s54 offen lds
    s_add_u32 m0, m0, 1024
    s_add_u32 s54, s54, 73728
    buffer_load_dwordx4 v10, s[20:23], s54 offen lds
    s_add_u32 m0, m0, 1024
    s_add_u32 s54, s54, 73728
    buffer_load_dwordx4 v10, s[20:23], s54 offen lds
    s_add_u32 m0, m0, 1024
    s_add_u32 s54, s54, 73728
    buffer_load_dwordx4 v10, s[20:23], s54 offen lds
    s_add_u32 m0, m0, 1024
    s_add_u32 s54, s54, 73728
    buffer_load_dwordx4 v10, s[20:23], s54 offen lds
    s_branch k1_kernel_id_22
k1_kernel_iq_21:
    s_sub_u32 s47, s45, s47
    s_and_b32 s48, s47, 1
    s_mul_i32 s48, s48, 995328
    s_lshr_b32 s47, s47, 1
    s_lshl_b32 s47, s47, 7
    s_add_u32 s54, s51, s47
    s_add_u32 s54, s54, s48
    buffer_load_dwordx4 v11, s[24:27], s54 offen lds
    s_add_u32 m0, m0, 1024
    s_add_u32 s54, s54, 27648
    buffer_load_dwordx4 v11, s[24:27], s54 offen lds
    s_add_u32 m0, m0, 1024
    s_add_u32 s54, s54, 27648
    buffer_load_dwordx4 v11, s[24:27], s54 offen lds
    s_add_u32 m0, m0, 1024
    s_add_u32 s54, s54, 27648
    buffer_load_dwordx4 v11, s[24:27], s54 offen lds
    s_add_u32 m0, m0, 1024
    s_add_u32 s54, s54, 27648
    buffer_load_dwordx4 v11, s[24:27], s54 offen lds
    s_add_u32 m0, m0, 1024
    s_add_u32 s54, s54, 27648
    buffer_load_dwordx4 v11, s[24:27], s54 offen lds
    s_add_u32 m0, m0, 1024
    s_add_u32 s54, s54, 27648
    buffer_load_dwordx4 v11, s[24:27], s54 offen lds
    s_add_u32 m0, m0, 1024
    s_add_u32 s54, s54, 27648
    buffer_load_dwordx4 v11, s[24:27], s54 offen lds
    s_add_u32 m0, m0, 1024
    s_add_u32 s54, s54, 27648
    buffer_load_dwordx4 v11, s[24:27], s54 offen lds
k1_kernel_id_22:
    s_add_u32 s49, s45, 3
    s_lshl_b32 s47, s40, 2
    s_cmp_ge_u32 s49, s47
    s_cbranch_scc1 k1_kernel_pq_23
    s_lshr_b32 s47, s49, 2
    s_lshl_b32 s47, s47, 7
    s_and_b32 s48, s49, 3
    s_mul_i32 s48, s48, 1327104
    s_add_u32 s54, s50, s47
    s_add_u32 s54, s54, s48
    buffer_load_dword v20, v12, s[20:23], s54 offen
    s_branch k1_kernel_pd_24
k1_kernel_pq_23:
    s_sub_u32 s47, s49, s47
    s_and_b32 s48, s47, 1
    s_mul_i32 s48, s48, 995328
    s_lshr_b32 s47, s47, 1
    s_lshl_b32 s47, s47, 7
    s_add_u32 s54, s51, s47
    s_add_u32 s54, s54, s48
    s_cmp_ge_u32 s49, s44
    s_cselect_b32 s54, 0x7ffff000, s54
    buffer_load_dword v20, v13, s[24:27], s54 offen
k1_kernel_pd_24:
    s_add_u32 s45, s45, 1
    s_cmp_lt_u32 s45, 3
    s_cbranch_scc1 k1_kernel_lpro
    s_waitcnt vmcnt(21)
    s_barrier
    s_mov_b32 s45, 1
k1_kernel_lloop:
    s_add_u32 s49, s45, 1
    s_cmp_ge_u32 s49, s44
    s_cbranch_scc1 k1_kernel_llast
    s_waitcnt vmcnt(11)
    s_barrier
    s_add_u32 s49, s45, 2
    s_cmp_ge_u32 s49, s44
    s_cbranch_scc1 k1_kernel_lnoi
    s_and_b32 s47, s49, 3
    s_mul_i32 s47, s47, 36864
    s_add_u32 m0, s47, s52
    s_lshl_b32 s47, s40, 2
    s_cmp_ge_u32 s49, s47
    s_cbranch_scc1 k1_kernel_iq_25
    s_lshr_b32 s47, s49, 2
    s_lshl_b32 s47, s47, 7
    s_and_b32 s48, s49, 3
    s_mul_i32 s48, s48, 1327104
    s_add_u32 s54, s50, s47
    s_add_u32 s54, s54, s48
    buffer_load_dwordx4 v10, s[20:23], s54 offen lds
    s_add_u32 m0, m0, 1024
    s_add_u32 s54, s54, 73728
    buffer_load_dwordx4 v10, s[20:23], s54 offen lds
    s_add_u32 m0, m0, 1024
    s_add_u32 s54, s54, 73728
    buffer_load_dwordx4 v10, s[20:23], s54 offen lds
    s_add_u32 m0, m0, 1024
    s_add_u32 s54, s54, 73728
    buffer_load_dwordx4 v10, s[20:23], s54 offen lds
    s_add_u32 m0, m0, 1024
    s_add_u32 s54, s54, 73728
    buffer_load_dwordx4 v10, s[20:23], s54 offen lds
    s_add_u32 m0, m0, 1024
    s_add_u32 s54, s54, 73728
    buffer_load_dwordx4 v10, s[20:23], s54 offen lds
    s_add_u32 m0, m0, 1024
    s_add_u32 s54, s54, 73728
    buffer_load_dwordx4 v10, s[20:23], s54 offen lds
    s_add_u32 m0, m0, 1024
    s_add_u32 s54, s54, 73728
    buffer_load_dwordx4 v10, s[20:23], s54 offen lds
    s_add_u32 m0, m0, 1024
    s_add_u32 s54, s54, 73728
    buffer_load_dwordx4 v10, s[20:23], s54 offen lds
    s_branch k1_kernel_id_26
k1_kernel_iq_25:
    s_sub_u32 s47, s49, s47
    s_and_b32 s48, s47, 1
    s_mul_i32 s48, s48, 995328
    s_lshr_b32 s47, s47, 1
    s_lshl_b32 s47, s47, 7
    s_add_u32 s54, s51, s47
    s_add_u32 s54, s54, s48
    buffer_load_dwordx4 v11, s[24:27], s54 offen lds
    s_add_u32 m0, m0, 1024
    s_add_u32 s54, s54, 27648
    buffer_load_dwordx4 v11, s[24:27], s54 offen lds
    s_add_u32 m0, m0, 1024
    s_add_u32 s54, s54, 27648
    buffer_load_dwordx4 v11, s[24:27], s54 offen lds
    s_add_u32 m0, m0, 1024
    s_add_u32 s54, s54, 27648
    buffer_load_dwordx4 v11, s[24:27], s54 offen lds
    s_add_u32 m0, m0, 1024
    s_add_u32 s54, s54, 27648
    buffer_load_dwordx4 v11, s[24:27], s54 offen lds
    s_add_u32 m0, m0, 1024
    s_add_u32 s54, s54, 27648
    buffer_load_dwordx4 v11, s[24:27], s54 offen lds
    s_add_u32 m0, m0, 1024
    s_add_u32 s54, s54, 27648
    buffer_load_dwordx4 v11, s[24:27], s54 offen lds
    s_add_u32 m0, m0, 1024
    s_add_u32 s54, s54, 27648
    buffer_load_dwordx4 v11, s[24:27], s54 offen lds
    s_add_u32 m0, m0, 1024
    s_add_u32 s54, s54, 27648
    buffer_load_dwordx4 v11, s[24:27], s54 offen lds
k1_kernel_id_26:
    s_add_u32 s49, s49, 3
    s_lshl_b32 s47, s40, 2
    s_cmp_ge_u32 s49, s47
    s_cbranch_scc1 k1_kernel_pq_27
    s_lshr_b32 s47, s49, 2
    s_lshl_b32 s47, s47, 7
    s_and_b32 s48, s49, 3
    s_mul_i32 s48, s48, 1327104
    s_add_u32 s54, s50, s47
    s_add_u32 s54, s54, s48
    buffer_load_dword v20, v12, s[20:23], s54 offen
    s_branch k1_kernel_pd_28
k1_kernel_pq_27:
    s_sub_u32 s47, s49, s47
    s_and_b32 s48, s47, 1
    s_mul_i32 s48, s48, 995328
    s_lshr_b32 s47, s47, 1
    s_lshl_b32 s47, s47, 7
    s_add_u32 s54, s51, s47
    s_add_u32 s54, s54, s48
    s_cmp_ge_u32 s49, s44
    s_cselect_b32 s54, 0x7ffff000, s54
    buffer_load_dword v20, v13, s[24:27], s54 offen
k1_kernel_pd_28:
k1_kernel_lnoi:
k1_kernel_lnext:
    s_add_u32 s45, s45, 1
    s_branch k1_kernel_lloop
k1_kernel_llast:
    s_waitcnt vmcnt(0)
    s_barrier
    s_cmp_ge_u32 s42, 3
    s_cbranch_scc1 k1_kernel_lx_29
    s_barrier
k1_kernel_lx_29:
    s_load_dwordx2 s[4:5], s[0:1], 48
    s_load_dwordx2 s[6:7], s[0:1], 16
    s_lshl_b32 s47, s2, 2
    s_add_u32 s47, s47, s3
    s_mul_i32 s48, s47, 5248
    v_lshlrev_b32 v4, 7, v1
    v_cmp_gt_u32 vcc, 41, v1
    v_mov_b32 v5, 0x7fffffff
    s_waitcnt lgkmcnt(0)
    v_cndmask_b32 v21, v5, v4, vcc
    s_mov_b32 s28, s4
    s_mov_b32 s29, s5
    s_mov_b32 s30, 0x510000
    s_mov_b32 s31, 0x20000
    buffer_load_dword v20, v21, s[28:31], s48 offen
    s_mul_i32 s48, s47, 768
    v_cmp_gt_u32 vcc, 6, v1
    s_mov_b32 s32, s6
    s_mov_b32 s33, s7
    s_mov_b32 s34, 0xa2000
    s_mov_b32 s35, 0x20000
    v_cndmask_b32 v22, v5, v4, vcc
    buffer_load_dword v20, v22, s[32:35], s48 offen
k1_kernel_end:
    s_endpgm
.section .rodata,"a"
.p2align 6
.amdhsa_kernel k1_kernel
  .amdhsa_next_free_vgpr 256
  .amdhsa_next_free_sgpr 96
  .amdhsa_accum_offset 256
  .amdhsa_group_segment_fixed_size 0
  .amdhsa_kernarg_size 80
  .amdhsa_user_sgpr_count 2
  .amdhsa_user_sgpr_kernarg_segment_ptr 1
  .amdhsa_system_sgpr_workgroup_id_x 1
  .amdhsa_float_denorm_mode_32 3
.end_amdhsa_kernel
.text
.globl k2_kernel
.p2align 8
.type k2_kernel,@function
k2_kernel:
    s_load_dwordx2 s[76:77], s[0:1], 0
    s_load_dwordx2 s[78:79], s[0:1], 16
    s_load_dwordx2 s[80:81], s[0:1], 56
    s_load_dwordx2 s[82:83], s[0:1], 72
    s_cmp_ge_u32 s2, 256
    s_cbranch_scc1 k2_kernel_down
    s_load_dwordx2 s[12:13], s[0:1], 72
    v_lshrrev_b32 v1, 6, v0
    s_and_b32 s14, s2, 7
    v_readfirstlane_b32 s3, v1
    s_lshl_b32 s14, s14, 2
    s_bfe_u32 s15, s2, 0x20003
    s_add_u32 s14, s14, s15
    s_lshr_b32 s15, s2, 5
    v_and_b32 v1, 63, v0
    v_and_b32 v2, 31, v1
    v_lshrrev_b32 v3, 5, v1
    v_and_b32 v4, 0x13, v2
    v_and_b32 v5, 4, v2
    v_lshl_or_b32 v4, v5, 1, v4
    v_and_b32 v5, 8, v2
    v_lshrrev_b32 v5, 1, v5
    v_or_b32 v4, v4, v5
    s_waitcnt lgkmcnt(0)
    s_mul_i32 s40, s14, 18
    s_lshr_b32 s55, s40, 4
    s_and_b32 s59, s40, 15
    s_lshl_b32 s40, s55, 16
    s_add_u32 s16, s12, 0x0
    s_addc_u32 s17, s13, 0
    s_add_u32 s16, s16, s40
    s_addc_u32 s17, s17, 0
    s_mov_b32 s18, 131072
    s_mov_b32 s19, 0x20000
    s_add_u32 s20, s12, 0x240000
    s_addc_u32 s21, s13, 0
    s_add_u32 s20, s20, s40
    s_addc_u32 s21, s21, 0
    s_mov_b32 s22, 131072
    s_mov_b32 s23, 0x20000
    s_mul_i32 s40, s14, 73728
    s_add_u32 s24, s12, 0x600000
    s_addc_u32 s25, s13, 0
    s_add_u32 s24, s24, s40
    s_addc_u32 s25, s25, 0
    s_mov_b32 s26, 73728
    s_mov_b32 s27, 0x20000
    s_add_u32 s28, s12, 0x900000
    s_addc_u32 s29, s13, 0
    s_mov_b32 s30, 0x300000
    s_mov_b32 s31, 0x20000
    v_bfe_u32 v5, v1, 4, 1
    v_xor_b32 v5, v5, v1
    v_lshlrev_b32 v18, 4, v5
    s_cmp_ge_u32 s59, 8
    s_cselect_b32 s40, 0, 1
    s_lshr_b32 s41, s3, 1
    s_cmp_eq_u32 s41, s40
    s_cselect_b32 s41, s40, 2
    v_and_b32 v6, 1, v5
    v_cmp_eq_u32 vcc, s41, v6
    v_mov_b32 v6, 0x7fffffff
    s_nop 0
    v_cndmask_b32 v18, v18, v6, vcc
    v_xor_b32 v5, v2, v3
    s_add_u32 s40, s3, 0
    s_lshl_b32 s40, s40, 1
    s_and_b32 s41, s40, 15
    v_xor_b32 v6, s41, v5
    v_lshlrev_b32 v6, 4, v6
    v_lshl_add_u32 v6, v3, 12, v6
    s_lshl_b32 s40, s40, 12
    v_add_u32 v19, s40, v6
    s_add_u32 s40, s3, 4
    s_lshl_b32 s40, s40, 1
    s_and_b32 s41, s40, 15
    v_xor_b32 v6, s41, v5
    v_lshlrev_b32 v6, 4, v6
    v_lshl_add_u32 v6, v3, 12, v6
    s_lshl_b32 s40, s40, 12
    v_add_u32 v20, s40, v6
    s_add_u32 s40, s3, 8
    s_lshl_b32 s40, s40, 1
    s_and_b32 s41, s40, 15
    v_xor_b32 v6, s41, v5
    v_lshlrev_b32 v6, 4, v6
    v_lshl_add_u32 v6, v3, 12, v6
    s_lshl_b32 s40, s40, 12
    v_add_u32 v21, s40, v6
    s_lshl_b32 s44, s3, 12
    s_lshr_b32 s40, s3, 1
    s_lshl_b32 s40, s40, 16
    s_and_b32 s9, s3, 1
    s_lshl_b32 s9, s9, 12
    s_add_u32 s9, s9, s40
    s_lshl_b32 s45, s3, 10
    s_add_u32 s45, s45, 16384
    s_cmp_eq_u32 s3, 0
    s_cselect_b32 s51, 1, 0
    s_lshl_b32 s50, s15, 8
    s_lshl_b32 s41, s3, 6
    s_add_u32 s50, s50, s41
    v_add_u32 v5, s50, v4
    v_lshlrev_b32 v5, 5, v5
    v_lshl_add_u32 v6, v3, 4, v5
    s_mov_b32 s40, 65536
    buffer_load_dwordx4 v[36:39], v6, s[16:19], 0 offen offset:0
    buffer_load_dwordx4 v[44:47], v6, s[16:19], s40 offen offset:0
    buffer_load_dwordx4 v[40:43], v6, s[16:19], 0 offen offset:1024
    buffer_load_dwordx4 v[48:51], v6, s[16:19], s40 offen offset:1024
    s_mov_b32 s48, 0
    s_mov_b32 s49, 0
    s_mov_b32 s47, 0
    s_add_u32 m0, s47, s44
    s_add_u32 s40, s48, s9
    buffer_load_dwordx4 v18, s[20:23], s40 offen lds
    s_add_u32 m0, m0, 1024
    s_add_u32 s40, s40, 1024
    buffer_load_dwordx4 v18, s[20:23], s40 offen lds
    s_add_u32 m0, m0, 1024
    s_add_u32 s40, s40, 1024
    buffer_load_dwordx4 v18, s[20:23], s40 offen lds
    s_add_u32 m0, m0, 1024
    s_add_u32 s40, s40, 1024
    buffer_load_dwordx4 v18, s[20:23], s40 offen lds
    s_add_u32 m0, s47, s45
    s_nop 0
    buffer_load_dwordx4 v19, s[24:27], s49 offen lds
    s_add_u32 m0, m0, 4096
    s_nop 0
    buffer_load_dwordx4 v20, s[24:27], s49 offen lds
    s_cmp_eq_u32 s51, 0
    s_cbranch_scc1 k2_kernel_w0_1
    s_add_u32 m0, m0, 4096
    s_nop 0
    buffer_load_dwordx4 v21, s[24:27], s49 offen lds
k2_kernel_w0_1:
    v_bfe_u32 v5, v4, 3, 1
    v_xor_b32 v5, v5, v3
    v_lshlrev_b32 v5, 4, v5
    v_lshl_add_u32 v7, v4, 5, v5
    v_and_b32 v6, 15, v4
    v_xor_b32 v6, v6, v3
    v_cmp_gt_u32 vcc, 19, v2
    v_mov_b32 v5, 19
    s_nop 0
    v_cndmask_b32 v5, v5, v4, vcc
    v_lshlrev_b32 v5, 9, v5
    v_add_u32 v5, 16384, v5
    v_xor_b32 v10, 0, v6
    v_lshl_add_u32 v10, v10, 4, v5
    v_xor_b32 v11, 2, v6
    v_lshl_add_u32 v11, v11, 4, v5
    v_xor_b32 v12, 4, v6
    v_lshl_add_u32 v12, v12, 4, v5
    v_xor_b32 v13, 6, v6
    v_lshl_add_u32 v13, v13, 4, v5
    v_xor_b32 v14, 8, v6
    v_lshl_add_u32 v14, v14, 4, v5
    v_xor_b32 v15, 10, v6
    v_lshl_add_u32 v15, v15, 4, v5
    v_xor_b32 v16, 12, v6
    v_lshl_add_u32 v16, v16, 4, v5
    v_xor_b32 v17, 14, v6
    v_lshl_add_u32 v17, v17, 4, v5
    v_mov_b32 v84, 0x3f803f80
    v_cmp_gt_u32 vcc, 128, v0
    v_lshlrev_b32 v5, 2, v0
    s_nop 0
    v_cndmask_b32 v84, 0, v84, vcc
    v_add_u32 v5, 25600, v5
    ds_write_b32 v5, v84 offset:0
    ds_write_b32 v5, v84 offset:26624
    ds_write_b32 v5, v84 offset:53248
    s_mul_i32 s40, s14, 3
    v_add_u32 v5, s40, v3
    v_lshlrev_b32 v6, 4, v2
    v_lshl_add_u32 v196, v5, 9, v6
    s_add_u32 s40, s40, 2
    s_lshl_b32 s40, s40, 9
    v_add_u32 v197, s40, v6
    v_cmp_eq_u32 vcc, 0, v3
    v_mov_b32 v92, 0x7fffffff
    s_nop 0
    v_cndmask_b32 v197, v92, v197, vcc
    v_mov_b32 v132, 0
    v_mov_b32 v133, 0
    v_mov_b32 v134, 0
    v_mov_b32 v135, 0
    v_mov_b32 v136, 0
    v_mov_b32 v137, 0
    v_mov_b32 v138, 0
    v_mov_b32 v139, 0
    v_mov_b32 v140, 0
    v_mov_b32 v141, 0
    v_mov_b32 v142, 0
    v_mov_b32 v143, 0
    v_mov_b32 v144, 0
    v_mov_b32 v145, 0
    v_mov_b32 v146, 0
    v_mov_b32 v147, 0
    v_mov_b32 v148, 0
    v_mov_b32 v149, 0
    v_mov_b32 v150, 0
    v_mov_b32 v151, 0
    v_mov_b32 v152, 0
    v_mov_b32 v153, 0
    v_mov_b32 v154, 0
    v_mov_b32 v155, 0
    v_mov_b32 v156, 0
    v_mov_b32 v157, 0
    v_mov_b32 v158, 0
    v_mov_b32 v159, 0
    v_mov_b32 v160, 0
    v_mov_b32 v161, 0
    v_mov_b32 v162, 0
    v_mov_b32 v163, 0
    v_mov_b32 v124, 0
    v_mov_b32 v76, 0
    v_mov_b32 v125, 0
    v_mov_b32 v77, 0
    v_mov_b32 v126, 0
    v_mov_b32 v78, 0
    v_mov_b32 v127, 0
    v_mov_b32 v79, 0
    v_mov_b32 v128, 0
    v_mov_b32 v80, 0
    v_mov_b32 v129, 0
    v_mov_b32 v81, 0
    v_mov_b32 v130, 0
    v_mov_b32 v82, 0
    v_mov_b32 v131, 0
    v_mov_b32 v83, 0
    s_mov_b32 s43, 0
    s_mov_b32 s57, 0
    s_waitcnt vmcnt(2) lgkmcnt(0)
    s_barrier
    v_lshlrev_b32 v5, 3, v3
    s_add_u32 s40, s59, 2
    v_add_u32 v6, 0, v5
    v_cmp_le_u32 vcc, s59, v6
    s_nop 1
    v_cndmask_b32 v36, 0, v36, vcc
    v_cndmask_b32 v40, 0, v40, vcc
    v_cmp_gt_u32 vcc, s40, v6
    s_nop 1
    v_cndmask_b32 v44, 0, v44, vcc
    v_cndmask_b32 v48, 0, v48, vcc
    v_add_u32 v6, 2, v5
    v_cmp_le_u32 vcc, s59, v6
    s_nop 1
    v_cndmask_b32 v37, 0, v37, vcc
    v_cndmask_b32 v41, 0, v41, vcc
    v_cmp_gt_u32 vcc, s40, v6
    s_nop 1
    v_cndmask_b32 v45, 0, v45, vcc
    v_cndmask_b32 v49, 0, v49, vcc
    v_add_u32 v6, 4, v5
    v_cmp_le_u32 vcc, s59, v6
    s_nop 1
    v_cndmask_b32 v38, 0, v38, vcc
    v_cndmask_b32 v42, 0, v42, vcc
    v_cmp_gt_u32 vcc, s40, v6
    s_nop 1
    v_cndmask_b32 v46, 0, v46, vcc
    v_cndmask_b32 v50, 0, v50, vcc
    v_add_u32 v6, 6, v5
    v_cmp_le_u32 vcc, s59, v6
    s_nop 1
    v_cndmask_b32 v39, 0, v39, vcc
    v_cndmask_b32 v43, 0, v43, vcc
    v_cmp_gt_u32 vcc, s40, v6
    s_nop 1
    v_cndmask_b32 v47, 0, v47, vcc
    v_cndmask_b32 v51, 0, v51, vcc
    v_add_u32 v24, 0, v7
    ds_read_b128 v[52:55], v24 offset:0
    ds_read_b128 v[60:63], v24 offset:8192
    ds_read_b128 v[56:59], v24 offset:1024
    ds_read_b128 v[64:67], v24 offset:9216
    s_waitcnt lgkmcnt(2)
    v_mfma_f32_32x32x16_bf16 v[84:99], v[52:55], v[36:39], 0
    v_mfma_f32_32x32x16_bf16 v[84:99], v[60:63], v[44:47], v[84:99]
    v_mfma_f32_32x32x16_bf16 v[100:115], v[52:55], v[40:43], 0
    v_mfma_f32_32x32x16_bf16 v[100:115], v[60:63], v[48:51], v[100:115]
    s_waitcnt lgkmcnt(0)
    v_mfma_f32_32x32x16_bf16 v[164:179], v[56:59], v[36:39], 0
    v_mfma_f32_32x32x16_bf16 v[164:179], v[64:67], v[44:47], v[164:179]
    v_mfma_f32_32x32x16_bf16 v[180:195], v[56:59], v[40:43], 0
    v_mfma_f32_32x32x16_bf16 v[180:195], v[64:67], v[48:51], v[180:195]
    s_waitcnt vmcnt(0)
    s_barrier
    s_mov_b32 s48, 8192
    s_mov_b32 s49, 512
    s_mov_b32 s47, 26624
    s_add_u32 m0, s47, s44
    s_add_u32 s40, s48, s9
    buffer_load_dwordx4 v18, s[20:23], s40 offen lds
    s_add_u32 m0, m0, 1024
    s_add_u32 s40, s40, 1024
    buffer_load_dwordx4 v18, s[20:23], s40 offen lds
    s_add_u32 m0, m0, 1024
    s_add_u32 s40, s40, 1024
    buffer_load_dwordx4 v18, s[20:23], s40 offen lds
    s_add_u32 m0, m0, 1024
    s_add_u32 s40, s40, 1024
    buffer_load_dwordx4 v18, s[20:23], s40 offen lds
    s_add_u32 m0, s47, s45
    s_nop 0
    buffer_load_dwordx4 v19, s[24:27], s49 offen lds
    s_add_u32 m0, m0, 4096
    s_nop 0
    buffer_load_dwordx4 v20, s[24:27], s49 offen lds
    s_cmp_eq_u32 s51, 0
    s_cbranch_scc1 k2_kernel_w0_2
    s_add_u32 m0, m0, 4096
    s_nop 0
    buffer_load_dwordx4 v21, s[24:27], s49 offen lds
k2_kernel_w0_2:
    v_max3_f32 v22, v84, v85, v84
    v_max3_f32 v22, v86, v87, v22
    v_max3_f32 v22, v88, v89, v22
    v_max3_f32 v22, v90, v91, v22
    v_max3_f32 v22, v92, v93, v22
    v_max3_f32 v22, v94, v95, v22
    v_max3_f32 v22, v96, v97, v22
    v_max3_f32 v22, v98, v99, v22
    v_max3_f32 v23, v100, v101, v100
    v_max3_f32 v23, v102, v103, v23
    v_max3_f32 v23, v104, v105, v23
    v_max3_f32 v23, v106, v107, v23
    v_max3_f32 v23, v108, v109, v23
    v_max3_f32 v23, v110, v111, v23
    v_max3_f32 v23, v112, v113, v23
    v_max3_f32 v23, v114, v115, v23
    s_nop 7
    v_max3_f32 v22, v164, v165, v22
    v_max3_f32 v22, v166, v167, v22
    v_max3_f32 v22, v168, v169, v22
    v_max3_f32 v22, v170, v171, v22
    v_max3_f32 v22, v172, v173, v22
    v_max3_f32 v22, v174, v175, v22
    v_max3_f32 v22, v176, v177, v22
    v_max3_f32 v22, v178, v179, v22
    v_max3_f32 v23, v180, v181, v23
    v_max3_f32 v23, v182, v183, v23
    v_max3_f32 v23, v184, v185, v23
    v_max3_f32 v23, v186, v187, v23
    v_max3_f32 v23, v188, v189, v23
    v_max3_f32 v23, v190, v191, v23
    v_max3_f32 v23, v192, v193, v23
    v_max3_f32 v23, v194, v195, v23
    s_branch k2_kernel_maxdone
k2_kernel_maxpass:
    v_mov_b32 v22, 0xff800000
    v_mov_b32 v23, 0xff800000
    s_mov_b32 s42, 0
    s_mov_b32 s46, 0
    s_mov_b32 s54, 8
k2_kernel_maxchunk:
    v_add_u32 v24, s46, v7
    s_mov_b32 s53, 0
k2_kernel_maxtile:
    ds_read_b128 v[52:55], v24
    ds_read_b128 v[60:63], v24 offset:8192
    v_add_u32 v24, 1024, v24
    s_waitcnt lgkmcnt(0)
    v_mfma_f32_32x32x16_bf16 v[84:99], v[52:55], v[36:39], 0
    v_mfma_f32_32x32x16_bf16 v[84:99], v[60:63], v[44:47], v[84:99]
    v_mfma_f32_32x32x16_bf16 v[100:115], v[52:55], v[40:43], 0
    v_mfma_f32_32x32x16_bf16 v[100:115], v[60:63], v[48:51], v[100:115]
    s_nop 7
    s_nop 7
    v_max3_f32 v22, v84, v85, v22
    v_max3_f32 v22, v86, v87, v22
    v_max3_f32 v22, v88, v89, v22
    v_max3_f32 v22, v90, v91, v22
    v_max3_f32 v22, v92, v93, v22
    v_max3_f32 v22, v94, v95, v22
    v_max3_f32 v22, v96, v97, v22
    v_max3_f32 v22, v98, v99, v22
    v_max3_f32 v23, v100, v101, v23
    v_max3_f32 v23, v102, v103, v23
    v_max3_f32 v23, v104, v105, v23
    v_max3_f32 v23, v106, v107, v23
    v_max3_f32 v23, v108, v109, v23
    v_max3_f32 v23, v110, v111, v23
    v_max3_f32 v23, v112, v113, v23
    v_max3_f32 v23, v114, v115, v23
    s_add_u32 s53, s53, 1
    s_cmp_lt_u32 s53, s54
    s_cbranch_scc1 k2_kernel_maxtile
    s_add_u32 s42, s42, 1
    s_barrier
    s_cmp_ge_u32 s42, 8
    s_cbranch_scc1 k2_kernel_maxall
    s_lshl_b32 s48, s42, 13
    s_lshl_b32 s49, s42, 9
    s_mov_b32 s47, 0
    s_add_u32 m0, s47, s44
    s_add_u32 s40, s48, s9
    buffer_load_dwordx4 v18, s[20:23], s40 offen lds
    s_add_u32 m0, m0, 1024
    s_add_u32 s40, s40, 1024
    buffer_load_dwordx4 v18, s[20:23], s40 offen lds
    s_add_u32 m0, m0, 1024
    s_add_u32 s40, s40, 1024
    buffer_load_dwordx4 v18, s[20:23], s40 offen lds
    s_add_u32 m0, m0, 1024
    s_add_u32 s40, s40, 1024
    buffer_load_dwordx4 v18, s[20:23], s40 offen lds
    s_add_u32 m0, s47, s45
    s_nop 0
    buffer_load_dwordx4 v19, s[24:27], s49 offen lds
    s_add_u32 m0, m0, 4096
    s_nop 0
    buffer_load_dwordx4 v20, s[24:27], s49 offen lds
    s_cmp_eq_u32 s51, 0
    s_cbranch_scc1 k2_kernel_w0_3
    s_add_u32 m0, m0, 4096
    s_nop 0
    buffer_load_dwordx4 v21, s[24:27], s49 offen lds
k2_kernel_w0_3:
    s_waitcnt vmcnt(0)
    s_barrier
    s_branch k2_kernel_maxchunk
k2_kernel_maxall:
    v_mov_b32 v132, 0
    v_mov_b32 v133, 0
    v_mov_b32 v134, 0
    v_mov_b32 v135, 0
    v_mov_b32 v136, 0
    v_mov_b32 v137, 0
    v_mov_b32 v138, 0
    v_mov_b32 v139, 0
    v_mov_b32 v140, 0
    v_mov_b32 v141, 0
    v_mov_b32 v142, 0
    v_mov_b32 v143, 0
    v_mov_b32 v144, 0
    v_mov_b32 v145, 0
    v_mov_b32 v146, 0
    v_mov_b32 v147, 0
    v_mov_b32 v148, 0
    v_mov_b32 v149, 0
    v_mov_b32 v150, 0
    v_mov_b32 v151, 0
    v_mov_b32 v152, 0
    v_mov_b32 v153, 0
    v_mov_b32 v154, 0
    v_mov_b32 v155, 0
    v_mov_b32 v156, 0
    v_mov_b32 v157, 0
    v_mov_b32 v158, 0
    v_mov_b32 v159, 0
    v_mov_b32 v160, 0
    v_mov_b32 v161, 0
    v_mov_b32 v162, 0
    v_mov_b32 v163, 0
    v_mov_b32 v124, 0
    v_mov_b32 v76, 0
    v_mov_b32 v125, 0
    v_mov_b32 v77, 0
    v_mov_b32 v126, 0
    v_mov_b32 v78, 0
    v_mov_b32 v127, 0
    v_mov_b32 v79, 0
    v_mov_b32 v128, 0
    v_mov_b32 v80, 0
    v_mov_b32 v129, 0
    v_mov_b32 v81, 0
    v_mov_b32 v130, 0
    v_mov_b32 v82, 0
    v_mov_b32 v131, 0
    v_mov_b32 v83, 0
    s_mov_b32 s48, 0
    s_mov_b32 s49, 0
    s_mov_b32 s47, 0
    s_add_u32 m0, s47, s44
    s_add_u32 s40, s48, s9
    buffer_load_dwordx4 v18, s[20:23], s40 offen lds
    s_add_u32 m0, m0, 1024
    s_add_u32 s40, s40, 1024
    buffer_load_dwordx4 v18, s[20:23], s40 offen lds
    s_add_u32 m0, m0, 1024
    s_add_u32 s40, s40, 1024
    buffer_load_dwordx4 v18, s[20:23], s40 offen lds
    s_add_u32 m0, m0, 1024
    s_add_u32 s40, s40, 1024
    buffer_load_dwordx4 v18, s[20:23], s40 offen lds
    s_add_u32 m0, s47, s45
    s_nop 0
    buffer_load_dwordx4 v19, s[24:27], s49 offen lds
    s_add_u32 m0, m0, 4096
    s_nop 0
    buffer_load_dwordx4 v20, s[24:27], s49 offen lds
    s_cmp_eq_u32 s51, 0
    s_cbranch_scc1 k2_kernel_w0_4
    s_add_u32 m0, m0, 4096
    s_nop 0
    buffer_load_dwordx4 v21, s[24:27], s49 offen lds
k2_kernel_w0_4:
    s_mov_b32 s48, 8192
    s_mov_b32 s49, 512
    s_mov_b32 s47, 26624
    s_add_u32 m0, s47, s44
    s_add_u32 s40, s48, s9
    buffer_load_dwordx4 v18, s[20:23], s40 offen lds
    s_add_u32 m0, m0, 1024
    s_add_u32 s40, s40, 1024
    buffer_load_dwordx4 v18, s[20:23], s40 offen lds
    s_add_u32 m0, m0, 1024
    s_add_u32 s40, s40, 1024
    buffer_load_dwordx4 v18, s[20:23], s40 offen lds
    s_add_u32 m0, m0, 1024
    s_add_u32 s40, s40, 1024
    buffer_load_dwordx4 v18, s[20:23], s40 offen lds
    s_add_u32 m0, s47, s45
    s_nop 0
    buffer_load_dwordx4 v19, s[24:27], s49 offen lds
    s_add_u32 m0, m0, 4096
    s_nop 0
    buffer_load_dwordx4 v20, s[24:27], s49 offen lds
    s_cmp_eq_u32 s51, 0
    s_cbranch_scc1 k2_kernel_w0_5
    s_add_u32 m0, m0, 4096
    s_nop 0
    buffer_load_dwordx4 v21, s[24:27], s49 offen lds
k2_kernel_w0_5:
    s_waitcnt vmcnt(0)
    s_barrier
k2_kernel_maxdone:
    s_cmp_eq_u32 s43, 0
    s_cselect_b32 s40, 0x42a00000, 0
    v_mov_b32 v84, v22
    s_nop 1
    v_permlane32_swap_b32 v22, v84
    s_nop 1
    v_max_f32 v22, v22, v84
    v_add_f32 v22, s40, v22
    v_sub_f32 v22, 0, v22
    v_mov_b32 v164, v22
    v_mov_b32 v165, v22
    v_mov_b32 v166, v22
    v_mov_b32 v167, v22
    v_mov_b32 v168, v22
    v_mov_b32 v169, v22
    v_mov_b32 v170, v22
    v_mov_b32 v171, v22
    v_mov_b32 v172, v22
    v_mov_b32 v173, v22
    v_mov_b32 v174, v22
    v_mov_b32 v175, v22
    v_mov_b32 v176, v22
    v_mov_b32 v177, v22
    v_mov_b32 v178, v22
    v_mov_b32 v179, v22
    v_mov_b32 v84, v23
    s_nop 1
    v_permlane32_swap_b32 v23, v84
    s_nop 1
    v_max_f32 v23, v23, v84
    v_add_f32 v23, s40, v23
    v_sub_f32 v23, 0, v23
    v_mov_b32 v180, v23
    v_mov_b32 v181, v23
    v_mov_b32 v182, v23
    v_mov_b32 v183, v23
    v_mov_b32 v184, v23
    v_mov_b32 v185, v23
    v_mov_b32 v186, v23
    v_mov_b32 v187, v23
    v_mov_b32 v188, v23
    v_mov_b32 v189, v23
    v_mov_b32 v190, v23
    v_mov_b32 v191, v23
    v_mov_b32 v192, v23
    v_mov_b32 v193, v23
    v_mov_b32 v194, v23
    v_mov_b32 v195, v23
    s_mov_b32 s42, 0
    s_mov_b32 s46, 0
    s_mov_b32 s52, 26624
    s_mov_b32 s47, 53248
    s_mov_b32 s48, 16384
    s_mov_b32 s49, 1024
    v_add_u32 v24, s46, v7
    v_add_u32 v26, s46, v10
    v_add_u32 v27, s46, v11
    v_add_u32 v28, s46, v12
    v_add_u32 v29, s46, v13
    v_add_u32 v30, s46, v14
    v_add_u32 v31, s46, v15
    v_add_u32 v32, s46, v16
    v_add_u32 v33, s46, v17
    ds_read_b128 v[52:55], v24 offset:0
    ds_read_b128 v[60:63], v24 offset:8192
    s_waitcnt lgkmcnt(0)
    v_mfma_f32_32x32x16_bf16 v[84:99], v[52:55], v[36:39], v[164:179]
    v_mfma_f32_32x32x16_bf16 v[84:99], v[60:63], v[44:47], v[84:99]
    s_nop 7
    s_nop 3
k2_kernel_chunk:
    v_mfma_f32_32x32x16_bf16 v[100:115], v[52:55], v[40:43], v[180:195]
    ds_read_b128 v[56:59], v24 offset:1024
    ds_read_b128 v[64:67], v24 offset:9216
    ds_read_b128 v[68:71], v26 offset:0
    ds_read_b128 v[72:75], v27 offset:0
    v_exp_f32 v84, v84
    v_exp_f32 v85, v85
    v_exp_f32 v86, v86
    v_exp_f32 v87, v87
    v_mfma_f32_32x32x16_bf16 v[100:115], v[60:63], v[48:51], v[100:115]
    v_exp_f32 v88, v88
    v_exp_f32 v89, v89
    v_exp_f32 v90, v90
    v_exp_f32 v91, v91
    v_cvt_pk_bf16_f32 v116, v84, v85
    v_cvt_pk_bf16_f32 v117, v86, v87
    v_mfma_f32_32x32x16_bf16 v[148:163], v[76:79], v[124:127], v[148:163]
    v_exp_f32 v92, v92
    v_exp_f32 v93, v93
    v_exp_f32 v94, v94
    v_exp_f32 v95, v95
    v_cvt_pk_bf16_f32 v118, v88, v89
    v_cvt_pk_bf16_f32 v119, v90, v91
    v_mfma_f32_32x32x16_bf16 v[148:163], v[80:83], v[128:131], v[148:163]
    v_exp_f32 v96, v96
    v_exp_f32 v97, v97
    v_exp_f32 v98, v98
    v_exp_f32 v99, v99
    v_cvt_pk_bf16_f32 v120, v92, v93
    v_cvt_pk_bf16_f32 v121, v94, v95
    v_cvt_pk_bf16_f32 v122, v96, v97
    v_cvt_pk_bf16_f32 v123, v98, v99
    s_waitcnt lgkmcnt(0)
    v_mfma_f32_32x32x16_bf16 v[84:99], v[56:59], v[36:39], v[164:179]
    v_exp_f32 v100, v100
    v_exp_f32 v101, v101
    v_exp_f32 v102, v102
    v_exp_f32 v103, v103
    v_mfma_f32_32x32x16_bf16 v[84:99], v[64:67], v[44:47], v[84:99]
    v_exp_f32 v104, v104
    v_exp_f32 v105, v105
    v_exp_f32 v106, v106
    v_exp_f32 v107, v107
    v_cvt_pk_bf16_f32 v124, v100, v101
    v_cvt_pk_bf16_f32 v125, v102, v103
    v_mfma_f32_32x32x16_bf16 v[132:147], v[68:71], v[116:119], v[132:147]
    v_exp_f32 v108, v108
    v_exp_f32 v109, v109
    v_exp_f32 v110, v110
    v_exp_f32 v111, v111
    v_cvt_pk_bf16_f32 v126, v104, v105
    v_cvt_pk_bf16_f32 v127, v106, v107
    v_mfma_f32_32x32x16_bf16 v[132:147], v[72:75], v[120:123], v[132:147]
    v_exp_f32 v112, v112
    v_exp_f32 v113, v113
    v_exp_f32 v114, v114
    v_exp_f32 v115, v115
    v_cvt_pk_bf16_f32 v128, v108, v109
    v_cvt_pk_bf16_f32 v129, v110, v111
    v_cvt_pk_bf16_f32 v130, v112, v113
    v_cvt_pk_bf16_f32 v131, v114, v115
    s_waitcnt vmcnt(0)
    s_barrier
    v_mfma_f32_32x32x16_bf16 v[100:115], v[56:59], v[40:43], v[180:195]
    ds_read_b128 v[52:55], v24 offset:2048
    ds_read_b128 v[60:63], v24 offset:10240
    ds_read_b128 v[76:79], v28 offset:0
    ds_read_b128 v[80:83], v29 offset:0
    v_exp_f32 v84, v84
    v_exp_f32 v85, v85
    v_exp_f32 v86, v86
    v_exp_f32 v87, v87
    v_mfma_f32_32x32x16_bf16 v[100:115], v[64:67], v[48:51], v[100:115]
    v_exp_f32 v88, v88
    v_exp_f32 v89, v89
    v_exp_f32 v90, v90
    v_exp_f32 v91, v91
    v_cvt_pk_bf16_f32 v116, v84, v85
    v_cvt_pk_bf16_f32 v117, v86, v87
    v_mfma_f32_32x32x16_bf16 v[148:163], v[68:71], v[124:127], v[148:163]
    v_exp_f32 v92, v92
    v_exp_f32 v93, v93
    v_exp_f32 v94, v94
    v_exp_f32 v95, v95
    v_cvt_pk_bf16_f32 v118, v88, v89
    v_cvt_pk_bf16_f32 v119, v90, v91
    v_mfma_f32_32x32x16_bf16 v[148:163], v[72:75], v[128:131], v[148:163]
    v_exp_f32 v96, v96
    v_exp_f32 v97, v97
    v_exp_f32 v98, v98
    v_exp_f32 v99, v99
    v_cvt_pk_bf16_f32 v120, v92, v93
    v_cvt_pk_bf16_f32 v121, v94, v95
    v_cvt_pk_bf16_f32 v122, v96, v97
    v_cvt_pk_bf16_f32 v123, v98, v99
    s_waitcnt lgkmcnt(0)
    v_mfma_f32_32x32x16_bf16 v[84:99], v[52:55], v[36:39], v[164:179]
    v_exp_f32 v100, v100
    v_exp_f32 v101, v101
    v_exp_f32 v102, v102
    v_exp_f32 v103, v103
    v_mfma_f32_32x32x16_bf16 v[84:99], v[60:63], v[44:47], v[84:99]
    v_exp_f32 v104, v104
    v_exp_f32 v105, v105
    v_exp_f32 v106, v106
    v_exp_f32 v107, v107
    v_cvt_pk_bf16_f32 v124, v100, v101
    v_cvt_pk_bf16_f32 v125, v102, v103
    v_mfma_f32_32x32x16_bf16 v[132:147], v[76:79], v[116:119], v[132:147]
    v_exp_f32 v108, v108
    v_exp_f32 v109, v109
    v_exp_f32 v110, v110
    v_exp_f32 v111, v111
    v_cvt_pk_bf16_f32 v126, v104, v105
    v_cvt_pk_bf16_f32 v127, v106, v107
    v_mfma_f32_32x32x16_bf16 v[132:147], v[80:83], v[120:123], v[132:147]
    v_exp_f32 v112, v112
    v_exp_f32 v113, v113
    v_exp_f32 v114, v114
    v_exp_f32 v115, v115
    v_cvt_pk_bf16_f32 v128, v108, v109
    v_cvt_pk_bf16_f32 v129, v110, v111
    v_cvt_pk_bf16_f32 v130, v112, v113
    v_cvt_pk_bf16_f32 v131, v114, v115
    v_mfma_f32_32x32x16_bf16 v[100:115], v[52:55], v[40:43], v[180:195]
    ds_read_b128 v[56:59], v24 offset:3072
    ds_read_b128 v[64:67], v24 offset:11264
    ds_read_b128 v[68:71], v30 offset:0
    ds_read_b128 v[72:75], v31 offset:0
    v_exp_f32 v84, v84
    v_exp_f32 v85, v85
    v_exp_f32 v86, v86
    v_exp_f32 v87, v87
    v_mfma_f32_32x32x16_bf16 v[100:115], v[60:63], v[48:51], v[100:115]
    v_exp_f32 v88, v88
    v_exp_f32 v89, v89
    v_exp_f32 v90, v90
    v_exp_f32 v91, v91
    v_cvt_pk_bf16_f32 v116, v84, v85
    v_cvt_pk_bf16_f32 v117, v86, v87
    v_mfma_f32_32x32x16_bf16 v[148:163], v[76:79], v[124:127], v[148:163]
    v_exp_f32 v92, v92
    v_exp_f32 v93, v93
    v_exp_f32 v94, v94
    v_exp_f32 v95, v95
    v_cvt_pk_bf16_f32 v118, v88, v89
    v_cvt_pk_bf16_f32 v119, v90, v91
    v_mfma_f32_32x32x16_bf16 v[148:163], v[80:83], v[128:131], v[148:163]
    s_cmp_ge_u32 s42, 6
    s_cbranch_scc1 k2_kernel_nd_8
    s_add_u32 m0, s47, s44
    s_add_u32 s40, s48, s9
    buffer_load_dwordx4 v18, s[20:23], s40 offen lds
    s_add_u32 m0, m0, 1024
    s_add_u32 s40, s40, 1024
    buffer_load_dwordx4 v18, s[20:23], s40 offen lds
k2_kernel_nd_8:
    v_exp_f32 v96, v96
    v_exp_f32 v97, v97
    v_exp_f32 v98, v98
    v_exp_f32 v99, v99
    v_cvt_pk_bf16_f32 v120, v92, v93
    v_cvt_pk_bf16_f32 v121, v94, v95
    v_cvt_pk_bf16_f32 v122, v96, v97
    v_cvt_pk_bf16_f32 v123, v98, v99
    s_waitcnt lgkmcnt(0)
    v_mfma_f32_32x32x16_bf16 v[84:99], v[56:59], v[36:39], v[164:179]
    v_exp_f32 v100, v100
    v_exp_f32 v101, v101
    v_exp_f32 v102, v102
    v_exp_f32 v103, v103
    v_mfma_f32_32x32x16_bf16 v[84:99], v[64:67], v[44:47], v[84:99]
    v_exp_f32 v104, v104
    v_exp_f32 v105, v105
    v_exp_f32 v106, v106
    v_exp_f32 v107, v107
    v_cvt_pk_bf16_f32 v124, v100, v101
    v_cvt_pk_bf16_f32 v125, v102, v103
    v_mfma_f32_32x32x16_bf16 v[132:147], v[68:71], v[116:119], v[132:147]
    v_exp_f32 v108, v108
    v_exp_f32 v109, v109
    v_exp_f32 v110, v110
    v_exp_f32 v111, v111
    v_cvt_pk_bf16_f32 v126, v104, v105
    v_cvt_pk_bf16_f32 v127, v106, v107
    v_mfma_f32_32x32x16_bf16 v[132:147], v[72:75], v[120:123], v[132:147]
    v_exp_f32 v112, v112
    v_exp_f32 v113, v113
    v_exp_f32 v114, v114
    v_exp_f32 v115, v115
    v_cvt_pk_bf16_f32 v128, v108, v109
    v_cvt_pk_bf16_f32 v129, v110, v111
    v_cvt_pk_bf16_f32 v130, v112, v113
    v_cvt_pk_bf16_f32 v131, v114, v115
    v_mfma_f32_32x32x16_bf16 v[100:115], v[56:59], v[40:43], v[180:195]
    ds_read_b128 v[52:55], v24 offset:4096
    ds_read_b128 v[60:63], v24 offset:12288
    ds_read_b128 v[76:79], v32 offset:0
    ds_read_b128 v[80:83], v33 offset:0
    v_exp_f32 v84, v84
    v_exp_f32 v85, v85
    v_exp_f32 v86, v86
    v_exp_f32 v87, v87
    v_mfma_f32_32x32x16_bf16 v[100:115], v[64:67], v[48:51], v[100:115]
    v_exp_f32 v88, v88
    v_exp_f32 v89, v89
    v_exp_f32 v90, v90
    v_exp_f32 v91, v91
    v_cvt_pk_bf16_f32 v116, v84, v85
    v_cvt_pk_bf16_f32 v117, v86, v87
    v_mfma_f32_32x32x16_bf16 v[148:163], v[68:71], v[124:127], v[148:163]
    v_exp_f32 v92, v92
    v_exp_f32 v93, v93
    v_exp_f32 v94, v94
    v_exp_f32 v95, v95
    v_cvt_pk_bf16_f32 v118, v88, v89
    v_cvt_pk_bf16_f32 v119, v90, v91
    v_mfma_f32_32x32x16_bf16 v[148:163], v[72:75], v[128:131], v[148:163]
    s_cmp_ge_u32 s42, 6
    s_cbranch_scc1 k2_kernel_nd_9
    s_add_u32 m0, m0, 1024
    s_add_u32 s40, s40, 1024
    buffer_load_dwordx4 v18, s[20:23], s40 offen lds
    s_add_u32 m0, m0, 1024
    s_add_u32 s40, s40, 1024
    buffer_load_dwordx4 v18, s[20:23], s40 offen lds
k2_kernel_nd_9:
    v_exp_f32 v96, v96
    v_exp_f32 v97, v97
    v_exp_f32 v98, v98
    v_exp_f32 v99, v99
    v_cvt_pk_bf16_f32 v120, v92, v93
    v_cvt_pk_bf16_f32 v121, v94, v95
    v_cvt_pk_bf16_f32 v122, v96, v97
    v_cvt_pk_bf16_f32 v123, v98, v99
    s_waitcnt lgkmcnt(0)
    v_mfma_f32_32x32x16_bf16 v[84:99], v[52:55], v[36:39], v[164:179]
    v_exp_f32 v100, v100
    v_exp_f32 v101, v101
    v_exp_f32 v102, v102
    v_exp_f32 v103, v103
    v_mfma_f32_32x32x16_bf16 v[84:99], v[60:63], v[44:47], v[84:99]
    v_exp_f32 v104, v104
    v_exp_f32 v105, v105
    v_exp_f32 v106, v106
    v_exp_f32 v107, v107
    v_cvt_pk_bf16_f32 v124, v100, v101
    v_cvt_pk_bf16_f32 v125, v102, v103
    v_mfma_f32_32x32x16_bf16 v[132:147], v[76:79], v[116:119], v[132:147]
    v_exp_f32 v108, v108
    v_exp_f32 v109, v109
    v_exp_f32 v110, v110
    v_exp_f32 v111, v111
    v_cvt_pk_bf16_f32 v126, v104, v105
    v_cvt_pk_bf16_f32 v127, v106, v107
    v_mfma_f32_32x32x16_bf16 v[132:147], v[80:83], v[120:123], v[132:147]
    v_exp_f32 v112, v112
    v_exp_f32 v113, v113
    v_exp_f32 v114, v114
    v_exp_f32 v115, v115
    v_cvt_pk_bf16_f32 v128, v108, v109
    v_cvt_pk_bf16_f32 v129, v110, v111
    v_cvt_pk_bf16_f32 v130, v112, v113
    v_cvt_pk_bf16_f32 v131, v114, v115
    v_mfma_f32_32x32x16_bf16 v[100:115], v[52:55], v[40:43], v[180:195]
    ds_read_b128 v[56:59], v24 offset:5120
    ds_read_b128 v[64:67], v24 offset:13312
    ds_read_b128 v[68:71], v26 offset:256
    ds_read_b128 v[72:75], v27 offset:256
    v_exp_f32 v84, v84
    v_exp_f32 v85, v85
    v_exp_f32 v86, v86
    v_exp_f32 v87, v87
    v_mfma_f32_32x32x16_bf16 v[100:115], v[60:63], v[48:51], v[100:115]
    v_exp_f32 v88, v88
    v_exp_f32 v89, v89
    v_exp_f32 v90, v90
    v_exp_f32 v91, v91
    v_cvt_pk_bf16_f32 v116, v84, v85
    v_cvt_pk_bf16_f32 v117, v86, v87
    v_mfma_f32_32x32x16_bf16 v[148:163], v[76:79], v[124:127], v[148:163]
    v_exp_f32 v92, v92
    v_exp_f32 v93, v93
    v_exp_f32 v94, v94
    v_exp_f32 v95, v95
    v_cvt_pk_bf16_f32 v118, v88, v89
    v_cvt_pk_bf16_f32 v119, v90, v91
    v_mfma_f32_32x32x16_bf16 v[148:163], v[80:83], v[128:131], v[148:163]
    s_cmp_ge_u32 s42, 6
    s_cbranch_scc1 k2_kernel_nd_10
    s_add_u32 m0, s47, s45
    s_nop 0
    buffer_load_dwordx4 v19, s[24:27], s49 offen lds
    s_add_u32 m0, m0, 4096
    s_nop 0
    buffer_load_dwordx4 v20, s[24:27], s49 offen lds
k2_kernel_nd_10:
    v_exp_f32 v96, v96
    v_exp_f32 v97, v97
    v_exp_f32 v98, v98
    v_exp_f32 v99, v99
    v_cvt_pk_bf16_f32 v120, v92, v93
    v_cvt_pk_bf16_f32 v121, v94, v95
    v_cvt_pk_bf16_f32 v122, v96, v97
    v_cvt_pk_bf16_f32 v123, v98, v99
    s_waitcnt lgkmcnt(0)
    v_mfma_f32_32x32x16_bf16 v[84:99], v[56:59], v[36:39], v[164:179]
    v_exp_f32 v100, v100
    v_exp_f32 v101, v101
    v_exp_f32 v102, v102
    v_exp_f32 v103, v103
    v_mfma_f32_32x32x16_bf16 v[84:99], v[64:67], v[44:47], v[84:99]
    v_exp_f32 v104, v104
    v_exp_f32 v105, v105
    v_exp_f32 v106, v106
    v_exp_f32 v107, v107
    v_cvt_pk_bf16_f32 v124, v100, v101
    v_cvt_pk_bf16_f32 v125, v102, v103
    v_mfma_f32_32x32x16_bf16 v[132:147], v[68:71], v[116:119], v[132:147]
    v_exp_f32 v108, v108
    v_exp_f32 v109, v109
    v_exp_f32 v110, v110
    v_exp_f32 v111, v111
    v_cvt_pk_bf16_f32 v126, v104, v105
    v_cvt_pk_bf16_f32 v127, v106, v107
    v_mfma_f32_32x32x16_bf16 v[132:147], v[72:75], v[120:123], v[132:147]
    v_exp_f32 v112, v112
    v_exp_f32 v113, v113
    v_exp_f32 v114, v114
    v_exp_f32 v115, v115
    v_cvt_pk_bf16_f32 v128, v108, v109
    v_cvt_pk_bf16_f32 v129, v110, v111
    v_cvt_pk_bf16_f32 v130, v112, v113
    v_cvt_pk_bf16_f32 v131, v114, v115
    v_mfma_f32_32x32x16_bf16 v[100:115], v[56:59], v[40:43], v[180:195]
    ds_read_b128 v[52:55], v24 offset:6144
    ds_read_b128 v[60:63], v24 offset:14336
    ds_read_b128 v[76:79], v28 offset:256
    ds_read_b128 v[80:83], v29 offset:256
    v_exp_f32 v84, v84
    v_exp_f32 v85, v85
    v_exp_f32 v86, v86
    v_exp_f32 v87, v87
    v_mfma_f32_32x32x16_bf16 v[100:115], v[64:67], v[48:51], v[100:115]
    v_exp_f32 v88, v88
    v_exp_f32 v89, v89
    v_exp_f32 v90, v90
    v_exp_f32 v91, v91
    v_cvt_pk_bf16_f32 v116, v84, v85
    v_cvt_pk_bf16_f32 v117, v86, v87
    v_mfma_f32_32x32x16_bf16 v[148:163], v[68:71], v[124:127], v[148:163]
    v_exp_f32 v92, v92
    v_exp_f32 v93, v93
    v_exp_f32 v94, v94
    v_exp_f32 v95, v95
    v_cvt_pk_bf16_f32 v118, v88, v89
    v_cvt_pk_bf16_f32 v119, v90, v91
    v_mfma_f32_32x32x16_bf16 v[148:163], v[72:75], v[128:131], v[148:163]
    s_cmp_ge_u32 s42, 6
    s_cbranch_scc1 k2_kernel_nd_11
    s_cmp_eq_u32 s51, 0
    s_cbranch_scc1 k2_kernel_w0_6
    s_add_u32 m0, m0, 4096
    s_nop 0
    buffer_load_dwordx4 v21, s[24:27], s49 offen lds
k2_kernel_w0_6:
k2_kernel_nd_11:
    v_exp_f32 v96, v96
    v_exp_f32 v97, v97
    v_exp_f32 v98, v98
    v_exp_f32 v99, v99
    v_cvt_pk_bf16_f32 v120, v92, v93
    v_cvt_pk_bf16_f32 v121, v94, v95
    v_cvt_pk_bf16_f32 v122, v96, v97
    v_cvt_pk_bf16_f32 v123, v98, v99
    s_waitcnt lgkmcnt(0)
    v_mfma_f32_32x32x16_bf16 v[84:99], v[52:55], v[36:39], v[164:179]
    v_exp_f32 v100, v100
    v_exp_f32 v101, v101
    v_exp_f32 v102, v102
    v_exp_f32 v103, v103
    v_mfma_f32_32x32x16_bf16 v[84:99], v[60:63], v[44:47], v[84:99]
    v_exp_f32 v104, v104
    v_exp_f32 v105, v105
    v_exp_f32 v106, v106
    v_exp_f32 v107, v107
    v_cvt_pk_bf16_f32 v124, v100, v101
    v_cvt_pk_bf16_f32 v125, v102, v103
    v_mfma_f32_32x32x16_bf16 v[132:147], v[76:79], v[116:119], v[132:147]
    v_exp_f32 v108, v108
    v_exp_f32 v109, v109
    v_exp_f32 v110, v110
    v_exp_f32 v111, v111
    v_cvt_pk_bf16_f32 v126, v104, v105
    v_cvt_pk_bf16_f32 v127, v106, v107
    v_mfma_f32_32x32x16_bf16 v[132:147], v[80:83], v[120:123], v[132:147]
    v_exp_f32 v112, v112
    v_exp_f32 v113, v113
    v_exp_f32 v114, v114
    v_exp_f32 v115, v115
    v_cvt_pk_bf16_f32 v128, v108, v109
    v_cvt_pk_bf16_f32 v129, v110, v111
    v_cvt_pk_bf16_f32 v130, v112, v113
    v_cvt_pk_bf16_f32 v131, v114, v115
    v_mfma_f32_32x32x16_bf16 v[100:115], v[52:55], v[40:43], v[180:195]
    ds_read_b128 v[56:59], v24 offset:7168
    ds_read_b128 v[64:67], v24 offset:15360
    ds_read_b128 v[68:71], v30 offset:256
    ds_read_b128 v[72:75], v31 offset:256
    v_exp_f32 v84, v84
    v_exp_f32 v85, v85
    v_exp_f32 v86, v86
    v_exp_f32 v87, v87
    v_mfma_f32_32x32x16_bf16 v[100:115], v[60:63], v[48:51], v[100:115]
    v_exp_f32 v88, v88
    v_exp_f32 v89, v89
    v_exp_f32 v90, v90
    v_exp_f32 v91, v91
    v_cvt_pk_bf16_f32 v116, v84, v85
    v_cvt_pk_bf16_f32 v117, v86, v87
    v_mfma_f32_32x32x16_bf16 v[148:163], v[76:79], v[124:127], v[148:163]
    v_exp_f32 v92, v92
    v_exp_f32 v93, v93
    v_exp_f32 v94, v94
    v_exp_f32 v95, v95
    v_cvt_pk_bf16_f32 v118, v88, v89
    v_cvt_pk_bf16_f32 v119, v90, v91
    v_mfma_f32_32x32x16_bf16 v[148:163], v[80:83], v[128:131], v[148:163]
    v_exp_f32 v96, v96
    v_exp_f32 v97, v97
    v_exp_f32 v98, v98
    v_exp_f32 v99, v99
    v_cvt_pk_bf16_f32 v120, v92, v93
    v_cvt_pk_bf16_f32 v121, v94, v95
    v_cvt_pk_bf16_f32 v122, v96, v97
    v_cvt_pk_bf16_f32 v123, v98, v99
    s_waitcnt lgkmcnt(0)
    v_mfma_f32_32x32x16_bf16 v[84:99], v[56:59], v[36:39], v[164:179]
    v_exp_f32 v100, v100
    v_exp_f32 v101, v101
    v_exp_f32 v102, v102
    v_exp_f32 v103, v103
    v_mfma_f32_32x32x16_bf16 v[84:99], v[64:67], v[44:47], v[84:99]
    v_exp_f32 v104, v104
    v_exp_f32 v105, v105
    v_exp_f32 v106, v106
    v_exp_f32 v107, v107
    v_cvt_pk_bf16_f32 v124, v100, v101
    v_cvt_pk_bf16_f32 v125, v102, v103
    v_mfma_f32_32x32x16_bf16 v[132:147], v[68:71], v[116:119], v[132:147]
    v_exp_f32 v108, v108
    v_exp_f32 v109, v109
    v_exp_f32 v110, v110
    v_exp_f32 v111, v111
    v_cvt_pk_bf16_f32 v126, v104, v105
    v_cvt_pk_bf16_f32 v127, v106, v107
    v_mfma_f32_32x32x16_bf16 v[132:147], v[72:75], v[120:123], v[132:147]
    v_exp_f32 v112, v112
    v_exp_f32 v113, v113
    v_exp_f32 v114, v114
    v_exp_f32 v115, v115
    v_cvt_pk_bf16_f32 v128, v108, v109
    v_cvt_pk_bf16_f32 v129, v110, v111
    v_cvt_pk_bf16_f32 v130, v112, v113
    v_cvt_pk_bf16_f32 v131, v114, v115
    v_mfma_f32_32x32x16_bf16 v[100:115], v[56:59], v[40:43], v[180:195]
    v_add_u32 v24, s52, v7
    ds_read_b128 v[52:55], v24 offset:0
    ds_read_b128 v[60:63], v24 offset:8192
    ds_read_b128 v[76:79], v32 offset:256
    ds_read_b128 v[80:83], v33 offset:256
    v_exp_f32 v84, v84
    v_exp_f32 v85, v85
    v_exp_f32 v86, v86
    v_exp_f32 v87, v87
    v_mfma_f32_32x32x16_bf16 v[100:115], v[64:67], v[48:51], v[100:115]
    v_exp_f32 v88, v88
    v_exp_f32 v89, v89
    v_exp_f32 v90, v90
    v_exp_f32 v91, v91
    v_cvt_pk_bf16_f32 v116, v84, v85
    v_cvt_pk_bf16_f32 v117, v86, v87
    v_mfma_f32_32x32x16_bf16 v[148:163], v[68:71], v[124:127], v[148:163]
    v_exp_f32 v92, v92
    v_exp_f32 v93, v93
    v_exp_f32 v94, v94
    v_exp_f32 v95, v95
    v_cvt_pk_bf16_f32 v118, v88, v89
    v_cvt_pk_bf16_f32 v119, v90, v91
    v_mfma_f32_32x32x16_bf16 v[148:163], v[72:75], v[128:131], v[148:163]
    v_exp_f32 v96, v96
    v_exp_f32 v97, v97
    v_exp_f32 v98, v98
    v_exp_f32 v99, v99
    v_cvt_pk_bf16_f32 v120, v92, v93
    v_cvt_pk_bf16_f32 v121, v94, v95
    v_cvt_pk_bf16_f32 v122, v96, v97
    v_cvt_pk_bf16_f32 v123, v98, v99
    s_waitcnt lgkmcnt(0)
    v_mfma_f32_32x32x16_bf16 v[84:99], v[52:55], v[36:39], v[164:179]
    v_add_u32 v26, s52, v10
    v_add_u32 v27, s52, v11
    v_add_u32 v28, s52, v12
    v_add_u32 v29, s52, v13
    v_add_u32 v30, s52, v14
    v_add_u32 v31, s52, v15
    v_add_u32 v32, s52, v16
    v_add_u32 v33, s52, v17
    v_exp_f32 v100, v100
    v_exp_f32 v101, v101
    v_exp_f32 v102, v102
    v_exp_f32 v103, v103
    v_mfma_f32_32x32x16_bf16 v[84:99], v[60:63], v[44:47], v[84:99]
    v_exp_f32 v104, v104
    v_exp_f32 v105, v105
    v_exp_f32 v106, v106
    v_exp_f32 v107, v107
    v_cvt_pk_bf16_f32 v124, v100, v101
    v_cvt_pk_bf16_f32 v125, v102, v103
    v_mfma_f32_32x32x16_bf16 v[132:147], v[76:79], v[116:119], v[132:147]
    s_add_u32 s42, s42, 1
    s_mov_b32 s41, s46
    s_mov_b32 s46, s52
    s_mov_b32 s52, s47
    s_mov_b32 s47, s41
    s_add_u32 s48, s48, 8192
    s_add_u32 s49, s49, 512
    v_exp_f32 v108, v108
    v_exp_f32 v109, v109
    v_exp_f32 v110, v110
    v_exp_f32 v111, v111
    v_cvt_pk_bf16_f32 v126, v104, v105
    v_cvt_pk_bf16_f32 v127, v106, v107
    v_mfma_f32_32x32x16_bf16 v[132:147], v[80:83], v[120:123], v[132:147]
    v_exp_f32 v112, v112
    v_exp_f32 v113, v113
    v_exp_f32 v114, v114
    v_exp_f32 v115, v115
    v_cvt_pk_bf16_f32 v128, v108, v109
    v_cvt_pk_bf16_f32 v129, v110, v111
    v_cvt_pk_bf16_f32 v130, v112, v113
    v_cvt_pk_bf16_f32 v131, v114, v115
    s_cmp_lt_u32 s42, 8
    s_cbranch_scc1 k2_kernel_chunk
    v_mfma_f32_32x32x16_bf16 v[148:163], v[76:79], v[124:127], v[148:163]
    v_mfma_f32_32x32x16_bf16 v[148:163], v[80:83], v[128:131], v[148:163]
    s_nop 7
    s_nop 7
    v_mov_b32 v92, 0
    v_mov_b32 v93, 0x71800000
    v_mov_b32 v94, 0x7fc00000
    v_mov_b32 v97, 0xd800000
    v_mov_b32 v84, v142
    v_mov_b32 v85, v142
    s_nop 1
    v_permlane32_swap_b32 v84, v85
    s_nop 1
    v_cmp_nlt_f32 vcc, v84, v93
    v_rcp_f32 v84, v84
    s_nop 0
    v_cndmask_b32 v92, v92, v94, vcc
    v_max3_f32 v95, |v132|, |v133|, |v134|
    v_max3_f32 v95, |v135|, |v136|, v95
    v_max3_f32 v95, |v137|, |v138|, v95
    v_max_f32 v95, |v139|, v95
    v_mov_b32 v96, v95
    s_nop 1
    v_permlane32_swap_b32 v95, v96
    s_nop 1
    v_max_f32 v95, v95, v96
    v_cmp_gt_f32 vcc, v97, v95
    s_nop 1
    v_cndmask_b32 v92, v92, v94, vcc
    v_mul_f32 v132, v132, v84
    v_mul_f32 v133, v133, v84
    v_mul_f32 v134, v134, v84
    v_mul_f32 v135, v135, v84
    v_mul_f32 v136, v136, v84
    v_mul_f32 v137, v137, v84
    v_mul_f32 v138, v138, v84
    v_mul_f32 v139, v139, v84
    v_mul_f32 v140, v140, v84
    v_mul_f32 v141, v141, v84
    v_fma_f32 v92, v132, 0, v92
    v_fma_f32 v92, v133, 0, v92
    v_fma_f32 v92, v134, 0, v92
    v_fma_f32 v92, v135, 0, v92
    v_fma_f32 v92, v136, 0, v92
    v_fma_f32 v92, v137, 0, v92
    v_fma_f32 v92, v138, 0, v92
    v_fma_f32 v92, v139, 0, v92
    v_mov_b32 v86, v158
    v_mov_b32 v87, v158
    s_nop 1
    v_permlane32_swap_b32 v86, v87
    s_nop 1
    v_cmp_nlt_f32 vcc, v86, v93
    v_rcp_f32 v86, v86
    s_nop 0
    v_cndmask_b32 v92, v92, v94, vcc
    v_max3_f32 v95, |v148|, |v149|, |v150|
    v_max3_f32 v95, |v151|, |v152|, v95
    v_max3_f32 v95, |v153|, |v154|, v95
    v_max_f32 v95, |v155|, v95
    v_mov_b32 v96, v95
    s_nop 1
    v_permlane32_swap_b32 v95, v96
    s_nop 1
    v_max_f32 v95, v95, v96
    v_cmp_gt_f32 vcc, v97, v95
    s_nop 1
    v_cndmask_b32 v92, v92, v94, vcc
    v_mul_f32 v148, v148, v86
    v_mul_f32 v149, v149, v86
    v_mul_f32 v150, v150, v86
    v_mul_f32 v151, v151, v86
    v_mul_f32 v152, v152, v86
    v_mul_f32 v153, v153, v86
    v_mul_f32 v154, v154, v86
    v_mul_f32 v155, v155, v86
    v_mul_f32 v156, v156, v86
    v_mul_f32 v157, v157, v86
    v_fma_f32 v92, v148, 0, v92
    v_fma_f32 v92, v149, 0, v92
    v_fma_f32 v92, v150, 0, v92
    v_fma_f32 v92, v151, 0, v92
    v_fma_f32 v92, v152, 0, v92
    v_fma_f32 v92, v153, 0, v92
    v_fma_f32 v92, v154, 0, v92
    v_fma_f32 v92, v155, 0, v92
    v_cmp_u_f32 vcc, v92, v92
    s_nop 3
    s_cmp_lg_u64 vcc, 0
    s_cselect_b32 s56, 1, 0
    s_cmp_eq_u32 s43, 1
    s_cselect_b32 s56, 0, s56
    s_or_b32 s40, s56, s57
    s_cmp_lg_u32 s40, 0
    s_cbranch_scc1 k2_kernel_vote
    s_lshr_b32 s40, s50, 5
    s_add_u32 s40, s40, 0
    s_mul_i32 s40, s40, 49152
    v_cvt_pk_bf16_f32 v132, v132, v133
    v_cvt_pk_bf16_f32 v133, v134, v135
    v_cvt_pk_bf16_f32 v134, v136, v137
    v_cvt_pk_bf16_f32 v135, v138, v139
    v_cvt_pk_bf16_f32 v136, v140, v141
    v_mov_b32 v137, 0
    v_mov_b32 v138, 0
    v_mov_b32 v139, 0
    buffer_store_dwordx4 v[132:135], v196, s[28:31], s40 offen sc1
    buffer_store_dwordx4 v[136:139], v197, s[28:31], s40 offen sc1
    s_lshr_b32 s40, s50, 5
    s_add_u32 s40, s40, 1
    s_mul_i32 s40, s40, 49152
    v_cvt_pk_bf16_f32 v148, v148, v149
    v_cvt_pk_bf16_f32 v149, v150, v151
    v_cvt_pk_bf16_f32 v150, v152, v153
    v_cvt_pk_bf16_f32 v151, v154, v155
    v_cvt_pk_bf16_f32 v152, v156, v157
    v_mov_b32 v153, 0
    v_mov_b32 v154, 0
    v_mov_b32 v155, 0
    buffer_store_dwordx4 v[148:151], v196, s[28:31], s40 offen sc1
    buffer_store_dwordx4 v[152:155], v197, s[28:31], s40 offen sc1
    s_lshl_b32 s59, s15, 2
    s_add_u32 s59, s59, s3
    s_lshl_b32 s59, s59, 5
    s_add_u32 s59, s59, s14
    s_lshl_b32 s59, s59, 2
    s_add_u32 s36, s12, 0x3400000
    s_addc_u32 s37, s13, 0
    s_mov_b32 s38, 0x3000
    s_mov_b32 s39, 0x20000
    v_mov_b32 v4, 1
    v_and_b32 v5, 63, v0
    v_cmp_eq_u32 vcc, 0, v5
    v_mov_b32 v5, 0x7fffffff
    s_nop 0
    v_cndmask_b32 v5, v5, 0, vcc
    s_waitcnt vmcnt(0)
    buffer_store_dword v4, v5, s[36:39], s59 offen sc1
    s_mov_b32 s57, 1
k2_kernel_vote:
    v_mov_b32 v5, s56
    s_lshl_b32 s41, s3, 2
    s_add_u32 s41, s41, 79872
    v_mov_b32 v6, s41
    ds_write_b32 v6, v5
    s_waitcnt lgkmcnt(0)
    s_barrier
    v_mov_b32 v6, 79872
    ds_read_b128 v[96:99], v6
    s_waitcnt lgkmcnt(0)
    v_or_b32 v96, v96, v97
    v_or3_b32 v96, v96, v98, v99
    s_nop 0
    v_readfirstlane_b32 s40, v96
    s_nop 3
    s_cmp_eq_u32 s40, 0
    s_cbranch_scc1 k2_kernel_store
    s_mov_b32 s43, 1
    s_waitcnt vmcnt(0)
    s_barrier
    s_mov_b32 s48, 0
    s_mov_b32 s49, 0
    s_mov_b32 s47, 0
    s_add_u32 m0, s47, s44
    s_add_u32 s40, s48, s9
    buffer_load_dwordx4 v18, s[20:23], s40 offen lds
    s_add_u32 m0, m0, 1024
    s_add_u32 s40, s40, 1024
    buffer_load_dwordx4 v18, s[20:23], s40 offen lds
    s_add_u32 m0, m0, 1024
    s_add_u32 s40, s40, 1024
    buffer_load_dwordx4 v18, s[20:23], s40 offen lds
    s_add_u32 m0, m0, 1024
    s_add_u32 s40, s40, 1024
    buffer_load_dwordx4 v18, s[20:23], s40 offen lds
    s_add_u32 m0, s47, s45
    s_nop 0
    buffer_load_dwordx4 v19, s[24:27], s49 offen lds
    s_add_u32 m0, m0, 4096
    s_nop 0
    buffer_load_dwordx4 v20, s[24:27], s49 offen lds
    s_cmp_eq_u32 s51, 0
    s_cbranch_scc1 k2_kernel_w0_12
    s_add_u32 m0, m0, 4096
    s_nop 0
    buffer_load_dwordx4 v21, s[24:27], s49 offen lds
k2_kernel_w0_12:
    s_waitcnt vmcnt(0)
    s_barrier
    s_branch k2_kernel_maxpass
k2_kernel_store:
    s_cmp_lt_u32 s2, 208
    s_cbranch_scc1 k2_kernel_end
    s_add_u32 s58, s2, 32
    s_mov_b32 s45, s58
    s_mov_b64 s[4:5], s[76:77]
    s_mov_b64 s[6:7], s[78:79]
    s_mov_b64 s[8:9], s[80:81]
    s_mov_b64 s[10:11], s[82:83]
    s_and_b32 s40, s45, 7
    s_lshr_b32 s41, s45, 3
    s_and_b32 s14, s41, 3
    s_lshl_b32 s40, s40, 2
    s_add_u32 s14, s14, s40
    s_lshr_b32 s43, s41, 2
    s_lshl_b32 s14, s14, 1
    s_lshr_b32 s40, s3, 1
    s_add_u32 s14, s14, s40
    s_and_b32 s44, s3, 1
    s_lshl_b32 s15, s43, 1
    s_add_u32 s15, s15, s44
    v_and_b32 v1, 63, v0
    s_waitcnt lgkmcnt(0)
    s_mov_b32 s16, s6
    s_mov_b32 s17, s7
    s_mov_b32 s18, 0xa2000
    s_mov_b32 s19, 0x20000
    s_add_u32 s20, s10, 0x900000
    s_addc_u32 s21, s11, 0
    s_mov_b32 s22, 0x300000
    s_mov_b32 s23, 0x20000
    s_add_u32 s24, s10, 0x2400000
    s_addc_u32 s25, s11, 0
    s_mov_b32 s26, 0xb40000
    s_mov_b32 s27, 0x20000
    s_mov_b32 s28, s4
    s_mov_b32 s29, s5
    s_mov_b32 s30, 0x240000
    s_mov_b32 s31, 0x20000
    s_mov_b32 s32, s8
    s_mov_b32 s33, s9
    s_mov_b32 s34, 0x240000
    s_mov_b32 s35, 0x20000
    s_add_u32 s36, s10, 0x3400000
    s_addc_u32 s37, s11, 0
    s_mov_b32 s38, 0x3000
    s_mov_b32 s39, 0x20000
    v_lshlrev_b32 v9, 4, v1
    s_movk_i32 s40, 1152
    v_lshrrev_b32 v4, 3, v1
    v_mul_lo_u32 v8, v4, s40
    v_bfe_u32 v4, v1, 4, 1
    v_lshlrev_b32 v4, 2, v4
    v_and_b32 v5, 7, v1
    v_xor_b32 v4, v4, v5
    v_lshl_add_u32 v8, v4, 4, v8
    s_mul_i32 s42, s3, 165888
    s_lshl_b32 s40, s43, 7
    s_add_u32 s42, s42, s40
    s_mul_i32 s40, s3, 18432
    s_mov_b32 m0, s40
    s_nop 0
    buffer_load_dwordx4 v8, s[16:19], s42 offen lds
    s_add_u32 s42, s42, 9216
    s_add_u32 m0, m0, 1024
    s_nop 0
    buffer_load_dwordx4 v8, s[16:19], s42 offen lds
    s_add_u32 s42, s42, 9216
    s_add_u32 m0, m0, 1024
    s_nop 0
    buffer_load_dwordx4 v8, s[16:19], s42 offen lds
    s_add_u32 s42, s42, 9216
    s_add_u32 m0, m0, 1024
    s_nop 0
    buffer_load_dwordx4 v8, s[16:19], s42 offen lds
    s_add_u32 s42, s42, 9216
    s_add_u32 m0, m0, 1024
    s_nop 0
    buffer_load_dwordx4 v8, s[16:19], s42 offen lds
    s_add_u32 s42, s42, 9216
    s_add_u32 m0, m0, 1024
    s_nop 0
    buffer_load_dwordx4 v8, s[16:19], s42 offen lds
    s_add_u32 s42, s42, 9216
    s_add_u32 m0, m0, 1024
    s_nop 0
    buffer_load_dwordx4 v8, s[16:19], s42 offen lds
    s_add_u32 s42, s42, 9216
    s_add_u32 m0, m0, 1024
    s_nop 0
    buffer_load_dwordx4 v8, s[16:19], s42 offen lds
    s_add_u32 s42, s42, 9216
    s_add_u32 m0, m0, 1024
    s_nop 0
    buffer_load_dwordx4 v8, s[16:19], s42 offen lds
    s_add_u32 s42, s42, 9216
    s_add_u32 m0, m0, 1024
    s_nop 0
    buffer_load_dwordx4 v8, s[16:19], s42 offen lds
    s_add_u32 s42, s42, 9216
    s_add_u32 m0, m0, 1024
    s_nop 0
    buffer_load_dwordx4 v8, s[16:19], s42 offen lds
    s_add_u32 s42, s42, 9216
    s_add_u32 m0, m0, 1024
    s_nop 0
    buffer_load_dwordx4 v8, s[16:19], s42 offen lds
    s_add_u32 s42, s42, 9216
    s_add_u32 m0, m0, 1024
    s_nop 0
    buffer_load_dwordx4 v8, s[16:19], s42 offen lds
    s_add_u32 s42, s42, 9216
    s_add_u32 m0, m0, 1024
    s_nop 0
    buffer_load_dwordx4 v8, s[16:19], s42 offen lds
    s_add_u32 s42, s42, 9216
    s_add_u32 m0, m0, 1024
    s_nop 0
    buffer_load_dwordx4 v8, s[16:19], s42 offen lds
    s_add_u32 s42, s42, 9216
    s_add_u32 m0, m0, 1024
    s_nop 0
    buffer_load_dwordx4 v8, s[16:19], s42 offen lds
    s_add_u32 s42, s42, 9216
    s_add_u32 m0, m0, 1024
    s_nop 0
    buffer_load_dwordx4 v8, s[16:19], s42 offen lds
    s_add_u32 s42, s42, 9216
    s_add_u32 m0, m0, 1024
    s_nop 0
    buffer_load_dwordx4 v8, s[16:19], s42 offen lds
    v_mov_b32 v216, 0
    v_mov_b32 v217, 0
    v_mov_b32 v218, 0
    v_mov_b32 v219, 0
    v_add_u32 v4, 73728, v9
    ds_write_b128 v4, v[216:219]
    v_and_b32 v2, 31, v1
    v_lshrrev_b32 v3, 5, v1
    v_and_b32 v4, 0x13, v2
    v_and_b32 v5, 4, v2
    v_lshl_or_b32 v4, v5, 1, v4
    v_and_b32 v5, 8, v2
    v_lshrrev_b32 v5, 1, v5
    v_or_b32 v4, v4, v5
    s_lshl_b32 s40, s14, 5
    v_add_u32 v4, s40, v4
    s_movk_i32 s40, 1152
    v_mul_lo_u32 v10, v4, s40
    v_lshl_add_u32 v10, v3, 4, v10
    s_lshl_b32 s40, s15, 6
    v_add_u32 v10, s40, v10
    buffer_load_dwordx4 v[208:211], v10, s[28:31], 0 offen
    buffer_load_dwordx4 v[212:215], v10, s[28:31], 0 offen offset:32
    v_bfe_u32 v6, v1, 4, 1
    v_lshlrev_b32 v6, 5, v6
    v_and_b32 v4, 1, v1
    v_lshl_add_u32 v6, v4, 4, v6
    v_bfe_u32 v4, v1, 1, 1
    v_lshl_add_u32 v6, v4, 3, v6
    s_mul_i32 s40, s44, 36864
    v_add_u32 v6, s40, v6
    v_mul_u32_u24 v4, 8, v3
    v_bfe_u32 v5, v1, 2, 2
    v_add3_u32 v4, v4, v5, 0
    v_bfe_u32 v5, v4, 1, 1
    v_lshl_add_u32 v5, v5, 6, v6
    v_lshl_add_u32 v232, v4, 7, v5
    v_xor_b32 v233, 64, v232
    v_mul_u32_u24 v4, 2, v3
    v_bfe_u32 v5, v1, 2, 2
    v_add3_u32 v4, v4, v5, 16
    v_bfe_u32 v5, v4, 1, 1
    v_lshl_add_u32 v5, v5, 6, v6
    v_lshl_add_u32 v234, v4, 7, v5
    v_xor_b32 v235, 64, v234
    v_mul_u32_u24 v4, 8, v3
    v_bfe_u32 v5, v1, 2, 2
    v_add3_u32 v4, v4, v5, 26
    v_bfe_u32 v5, v4, 1, 1
    v_lshl_add_u32 v5, v5, 6, v6
    v_lshl_add_u32 v236, v4, 7, v5
    v_xor_b32 v237, 64, v236
    s_waitcnt vmcnt(0) lgkmcnt(0)
    s_cmp_eq_u32 s3, 0
    s_cbranch_scc0 k2_kernel_l_polled_14
    v_and_b32 v5, 31, v1
    s_and_b32 s40, s14, -2
    s_mul_i32 s40, s40, 3
    s_mul_i32 s41, s43, 43
    s_lshr_b32 s41, s41, 7
    s_add_u32 s40, s40, s41
    s_lshl_b32 s40, s40, 5
    s_add_u32 s40, s40, 4096
    v_and_b32 v6, 7, v5
    v_lshrrev_b32 v4, 3, v5
    v_mul_u32_u24 v4, 24, v4
    v_add_u32 v6, v6, v4
    v_lshl_add_u32 v6, v6, 2, s40
    s_lshr_b32 s40, s14, 1
    s_lshl_b32 s40, s40, 7
    v_lshl_add_u32 v11, v1, 2, s40
    v_cmp_gt_u32 vcc, 32, v1
    s_nop 1
    v_cndmask_b32 v11, v6, v11, vcc
    s_mov_b32 s46, 0xffffffff
    s_mov_b32 s47, 0x1f1f
    v_mov_b32 v5, 0x7fffffff
    v_cndmask_b32 v11, v5, v11, s[46:47]
k2_kernel_l_poll_13:
    buffer_load_dword v4, v11, s[36:39], 0 offen sc1
    s_waitcnt vmcnt(0)
    v_cmp_ne_u32 vcc, 0, v4
    s_nop 3
    s_and_b64 vcc, vcc, s[46:47]
    s_cmp_eq_u64 vcc, s[46:47]
    s_cbranch_scc1 k2_kernel_l_polled_14
    s_sleep 2
    s_branch k2_kernel_l_poll_13
k2_kernel_l_polled_14:
    s_barrier
    s_mul_i32 s40, s14, 18
    s_add_u32 s40, s40, s15
    s_lshl_b32 s42, s40, 11
    buffer_load_dwordx4 v[168:171], v9, s[24:27], s42 offen offset:0 sc1
    buffer_load_dwordx4 v[172:175], v9, s[24:27], s42 offen offset:1024 sc1
    s_add_u32 s42, s42, 2359296
    buffer_load_dwordx4 v[176:179], v9, s[24:27], s42 offen offset:0 sc1
    buffer_load_dwordx4 v[180:183], v9, s[24:27], s42 offen offset:1024 sc1
    s_add_u32 s42, s42, 2359296
    buffer_load_dwordx4 v[184:187], v9, s[24:27], s42 offen offset:0 sc1
    buffer_load_dwordx4 v[188:191], v9, s[24:27], s42 offen offset:1024 sc1
    s_add_u32 s42, s42, 2359296
    buffer_load_dwordx4 v[192:195], v9, s[24:27], s42 offen offset:0 sc1
    buffer_load_dwordx4 v[196:199], v9, s[24:27], s42 offen offset:1024 sc1
    s_add_u32 s42, s42, 2359296
    buffer_load_dwordx4 v[200:203], v9, s[24:27], s42 offen offset:0 sc1
    buffer_load_dwordx4 v[204:207], v9, s[24:27], s42 offen offset:1024 sc1
    s_mov_b32 s50, 0x3ef5fdf0
    s_mov_b32 s51, 0xbfb8aa3b
    s_mul_i32 s41, s14, 49152
    s_mul_i32 s40, s44, 24576
    s_add_u32 s41, s41, s40
    buffer_load_dwordx4 v[16:19], v9, s[20:23], s41 offen offset:0 sc1
    buffer_load_dwordx4 v[20:23], v9, s[20:23], s41 offen offset:1024 sc1
    buffer_load_dwordx4 v[24:27], v9, s[20:23], s41 offen offset:2048 sc1
    buffer_load_dwordx4 v[28:31], v9, s[20:23], s41 offen offset:3072 sc1
    s_add_u32 s41, s41, 4096
    buffer_load_dwordx4 v[32:35], v9, s[20:23], s41 offen offset:0 sc1
    buffer_load_dwordx4 v[36:39], v9, s[20:23], s41 offen offset:1024 sc1
    buffer_load_dwordx4 v[40:43], v9, s[20:23], s41 offen offset:2048 sc1
    buffer_load_dwordx4 v[44:47], v9, s[20:23], s41 offen offset:3072 sc1
    ds_read_b64_tr_b16 v[144:145], v232 offset:0
    ds_read_b64_tr_b16 v[146:147], v232 offset:512
    ds_read_b64_tr_b16 v[148:149], v233 offset:0
    ds_read_b64_tr_b16 v[150:151], v233 offset:512
    ds_read_b64_tr_b16 v[152:153], v234 offset:0
    ds_read_b64_tr_b16 v[154:155], v234 offset:512
    ds_read_b64_tr_b16 v[156:157], v235 offset:0
    ds_read_b64_tr_b16 v[158:159], v235 offset:512
    ds_read_b64_tr_b16 v[160:161], v236 offset:0
    ds_read_b64_tr_b16 v[162:163], v236 offset:512
    ds_read_b64_tr_b16 v[164:165], v237 offset:0
    ds_read_b64_tr_b16 v[166:167], v237 offset:512
    s_waitcnt vmcnt(7)
    s_waitcnt lgkmcnt(8)
    v_mfma_f32_32x32x16_bf16 v[112:127], v[144:147], v[16:19], 0
    ds_read_b64_tr_b16 v[144:145], v232 offset:4608
    ds_read_b64_tr_b16 v[146:147], v232 offset:5120
    s_add_u32 s41, s41, 4096
    buffer_load_dwordx4 v[48:51], v9, s[20:23], s41 offen offset:0 sc1
    v_lshlrev_b32 v216, 16, v168
    v_and_b32 v217, 0xffff0000, v168
    v_lshlrev_b32 v218, 16, v169
    v_and_b32 v219, 0xffff0000, v169
    v_lshlrev_b32 v220, 16, v170
    v_and_b32 v221, 0xffff0000, v170
    v_mfma_f32_32x32x16_bf16 v[128:143], v[148:151], v[16:19], 0
    ds_read_b64_tr_b16 v[148:149], v233 offset:4608
    ds_read_b64_tr_b16 v[150:151], v233 offset:5120
    v_lshlrev_b32 v222, 16, v171
    v_and_b32 v223, 0xffff0000, v171
    v_lshlrev_b32 v224, 16, v172
    v_and_b32 v225, 0xffff0000, v172
    v_lshlrev_b32 v226, 16, v173
    v_and_b32 v227, 0xffff0000, v173
    s_waitcnt vmcnt(7)
    s_waitcnt lgkmcnt(8)
    v_mfma_f32_32x32x16_bf16 v[112:127], v[152:155], v[20:23], v[112:127]
    ds_read_b64_tr_b16 v[152:153], v234 offset:4608
    ds_read_b64_tr_b16 v[154:155], v234 offset:5120
    buffer_load_dwordx4 v[52:55], v9, s[20:23], s41 offen offset:1024 sc1
    v_lshlrev_b32 v228, 16, v174
    v_and_b32 v229, 0xffff0000, v174
    v_lshlrev_b32 v230, 16, v175
    v_and_b32 v231, 0xffff0000, v175
    v_lshlrev_b32 v238, 16, v176
    v_mfma_f32_32x32x16_bf16 v[128:143], v[156:159], v[20:23], v[128:143]
    ds_read_b64_tr_b16 v[156:157], v235 offset:4608
    ds_read_b64_tr_b16 v[158:159], v235 offset:5120
    v_and_b32 v239, 0xffff0000, v176
    v_add_f32 v216, v216, v238
    v_add_f32 v217, v217, v239
    v_lshlrev_b32 v238, 16, v177
    v_and_b32 v239, 0xffff0000, v177
    v_add_f32 v218, v218, v238
    s_waitcnt vmcnt(7)
    s_waitcnt lgkmcnt(8)
    v_mfma_f32_32x32x16_bf16 v[112:127], v[160:163], v[24:27], v[112:127]
    ds_read_b64_tr_b16 v[160:161], v236 offset:4608
    ds_read_b64_tr_b16 v[162:163], v236 offset:5120
    buffer_load_dwordx4 v[56:59], v9, s[20:23], s41 offen offset:2048 sc1
    v_add_f32 v219, v219, v239
    v_lshlrev_b32 v238, 16, v178
    v_and_b32 v239, 0xffff0000, v178
    v_add_f32 v220, v220, v238
    v_add_f32 v221, v221, v239
    v_mfma_f32_32x32x16_bf16 v[128:143], v[164:167], v[24:27], v[128:143]
    ds_read_b64_tr_b16 v[164:165], v237 offset:4608
    ds_read_b64_tr_b16 v[166:167], v237 offset:5120
    v_lshlrev_b32 v238, 16, v179
    v_and_b32 v239, 0xffff0000, v179
    v_add_f32 v222, v222, v238
    v_add_f32 v223, v223, v239
    v_lshlrev_b32 v238, 16, v180
    v_and_b32 v239, 0xffff0000, v180
    s_waitcnt vmcnt(7)
    s_waitcnt lgkmcnt(8)
    v_mfma_f32_32x32x16_bf16 v[112:127], v[144:147], v[28:31], v[112:127]
    ds_read_b64_tr_b16 v[144:145], v232 offset:9216
    ds_read_b64_tr_b16 v[146:147], v232 offset:9728
    buffer_load_dwordx4 v[60:63], v9, s[20:23], s41 offen offset:3072 sc1
    v_add_f32 v224, v224, v238
    v_add_f32 v225, v225, v239
    v_lshlrev_b32 v238, 16, v181
    v_and_b32 v239, 0xffff0000, v181
    v_add_f32 v226, v226, v238
    v_mfma_f32_32x32x16_bf16 v[128:143], v[148:151], v[28:31], v[128:143]
    ds_read_b64_tr_b16 v[148:149], v233 offset:9216
    ds_read_b64_tr_b16 v[150:151], v233 offset:9728
    v_add_f32 v227, v227, v239
    v_lshlrev_b32 v238, 16, v182
    v_and_b32 v239, 0xffff0000, v182
    v_add_f32 v228, v228, v238
    v_add_f32 v229, v229, v239
    v_lshlrev_b32 v238, 16, v183
    s_waitcnt vmcnt(7)
    s_waitcnt lgkmcnt(8)
    v_mfma_f32_32x32x16_bf16 v[112:127], v[152:155], v[32:35], v[112:127]
    ds_read_b64_tr_b16 v[152:153], v234 offset:9216
    ds_read_b64_tr_b16 v[154:155], v234 offset:9728
    s_add_u32 s41, s41, 4096
    buffer_load_dwordx4 v[64:67], v9, s[20:23], s41 offen offset:0 sc1
    v_and_b32 v239, 0xffff0000, v183
    v_add_f32 v230, v230, v238
    v_add_f32 v231, v231, v239
    v_lshlrev_b32 v238, 16, v184
    v_and_b32 v239, 0xffff0000, v184
    v_add_f32 v216, v216, v238
    v_mfma_f32_32x32x16_bf16 v[128:143], v[156:159], v[32:35], v[128:143]
    ds_read_b64_tr_b16 v[156:157], v235 offset:9216
    ds_read_b64_tr_b16 v[158:159], v235 offset:9728
    v_add_f32 v217, v217, v239
    v_lshlrev_b32 v238, 16, v185
    v_and_b32 v239, 0xffff0000, v185
    v_add_f32 v218, v218, v238
    v_add_f32 v219, v219, v239
    s_waitcnt vmcnt(7)
    s_waitcnt lgkmcnt(8)
    v_mfma_f32_32x32x16_bf16 v[112:127], v[160:163], v[36:39], v[112:127]
    ds_read_b64_tr_b16 v[160:161], v236 offset:9216
    ds_read_b64_tr_b16 v[162:163], v236 offset:9728
    buffer_load_dwordx4 v[68:71], v9, s[20:23], s41 offen offset:1024 sc1
    v_lshlrev_b32 v238, 16, v186
    v_and_b32 v239, 0xffff0000, v186
    v_add_f32 v220, v220, v238
    v_add_f32 v221, v221, v239
    v_lshlrev_b32 v238, 16, v187
    v_and_b32 v239, 0xffff0000, v187
    v_mfma_f32_32x32x16_bf16 v[128:143], v[164:167], v[36:39], v[128:143]
    ds_read_b64_tr_b16 v[164:165], v237 offset:9216
    ds_read_b64_tr_b16 v[166:167], v237 offset:9728
    v_add_f32 v222, v222, v238
    v_add_f32 v223, v223, v239
    v_lshlrev_b32 v238, 16, v188
    v_and_b32 v239, 0xffff0000, v188
    v_add_f32 v224, v224, v238
    s_waitcnt vmcnt(7)
    s_waitcnt lgkmcnt(8)
    v_mfma_f32_32x32x16_bf16 v[112:127], v[144:147], v[40:43], v[112:127]
    ds_read_b64_tr_b16 v[144:145], v232 offset:13824
    ds_read_b64_tr_b16 v[146:147], v232 offset:14336
    buffer_load_dwordx4 v[72:75], v9, s[20:23], s41 offen offset:2048 sc1
    v_add_f32 v225, v225, v239
    v_lshlrev_b32 v238, 16, v189
    v_and_b32 v239, 0xffff0000, v189
    v_add_f32 v226, v226, v238
    v_add_f32 v227, v227, v239
    v_lshlrev_b32 v238, 16, v190
    v_mfma_f32_32x32x16_bf16 v[128:143], v[148:151], v[40:43], v[128:143]
    ds_read_b64_tr_b16 v[148:149], v233 offset:13824
    ds_read_b64_tr_b16 v[150:151], v233 offset:14336
    v_and_b32 v239, 0xffff0000, v190
    v_add_f32 v228, v228, v238
    v_add_f32 v229, v229, v239
    v_lshlrev_b32 v238, 16, v191
    v_and_b32 v239, 0xffff0000, v191
    s_waitcnt vmcnt(7)
    s_waitcnt lgkmcnt(8)
    v_mfma_f32_32x32x16_bf16 v[112:127], v[152:155], v[44:47], v[112:127]
    ds_read_b64_tr_b16 v[152:153], v234 offset:13824
    ds_read_b64_tr_b16 v[154:155], v234 offset:14336
    buffer_load_dwordx4 v[76:79], v9, s[20:23], s41 offen offset:3072 sc1
    v_add_f32 v230, v230, v238
    v_add_f32 v231, v231, v239
    v_lshlrev_b32 v238, 16, v192
    v_and_b32 v239, 0xffff0000, v192
    v_add_f32 v216, v216, v238
    v_add_f32 v217, v217, v239
    v_mfma_f32_32x32x16_bf16 v[128:143], v[156:159], v[44:47], v[128:143]
    ds_read_b64_tr_b16 v[156:157], v235 offset:13824
    ds_read_b64_tr_b16 v[158:159], v235 offset:14336
    v_lshlrev_b32 v238, 16, v193
    v_and_b32 v239, 0xffff0000, v193
    v_add_f32 v218, v218, v238
    v_add_f32 v219, v219, v239
    v_lshlrev_b32 v238, 16, v194
    v_and_b32 v239, 0xffff0000, v194
    s_waitcnt vmcnt(7)
    s_waitcnt lgkmcnt(8)
    v_mfma_f32_32x32x16_bf16 v[112:127], v[160:163], v[48:51], v[112:127]
    ds_read_b64_tr_b16 v[160:161], v236 offset:13824
    ds_read_b64_tr_b16 v[162:163], v236 offset:14336
    s_add_u32 s41, s41, 4096
    buffer_load_dwordx4 v[80:83], v9, s[20:23], s41 offen offset:0 sc1
    v_add_f32 v220, v220, v238
    v_add_f32 v221, v221, v239
    v_lshlrev_b32 v238, 16, v195
    v_and_b32 v239, 0xffff0000, v195
    v_add_f32 v222, v222, v238
    v_mfma_f32_32x32x16_bf16 v[128:143], v[164:167], v[48:51], v[128:143]
    ds_read_b64_tr_b16 v[164:165], v237 offset:13824
    ds_read_b64_tr_b16 v[166:167], v237 offset:14336
    v_add_f32 v223, v223, v239
    v_lshlrev_b32 v238, 16, v196
    v_and_b32 v239, 0xffff0000, v196
    v_add_f32 v224, v224, v238
    v_add_f32 v225, v225, v239
    v_lshlrev_b32 v238, 16, v197
    s_waitcnt vmcnt(7)
    s_waitcnt lgkmcnt(8)
    v_mfma_f32_32x32x16_bf16 v[112:127], v[144:147], v[52:55], v[112:127]
    ds_read_b64_tr_b16 v[144:145], v232 offset:18432
    ds_read_b64_tr_b16 v[146:147], v232 offset:18944
    buffer_load_dwordx4 v[84:87], v9, s[20:23], s41 offen offset:1024 sc1
    v_and_b32 v239, 0xffff0000, v197
    v_add_f32 v226, v226, v238
    v_add_f32 v227, v227, v239
    v_lshlrev_b32 v238, 16, v198
    v_and_b32 v239, 0xffff0000, v198
    v_mfma_f32_32x32x16_bf16 v[128:143], v[148:151], v[52:55], v[128:143]
    ds_read_b64_tr_b16 v[148:149], v233 offset:18432
    ds_read_b64_tr_b16 v[150:151], v233 offset:18944
    v_add_f32 v228, v228, v238
    v_add_f32 v229, v229, v239
    v_lshlrev_b32 v238, 16, v199
    v_and_b32 v239, 0xffff0000, v199
    v_add_f32 v230, v230, v238
    v_add_f32 v231, v231, v239
    s_waitcnt vmcnt(7)
    s_waitcnt lgkmcnt(8)
    v_mfma_f32_32x32x16_bf16 v[112:127], v[152:155], v[56:59], v[112:127]
    ds_read_b64_tr_b16 v[152:153], v234 offset:18432
    ds_read_b64_tr_b16 v[154:155], v234 offset:18944
    buffer_load_dwordx4 v[88:91], v9, s[20:23], s41 offen offset:2048 sc1
    v_lshlrev_b32 v238, 16, v200
    v_and_b32 v239, 0xffff0000, v200
    v_add_f32 v216, v216, v238
    v_add_f32 v217, v217, v239
    v_lshlrev_b32 v238, 16, v201
    v_mfma_f32_32x32x16_bf16 v[128:143], v[156:159], v[56:59], v[128:143]
    ds_read_b64_tr_b16 v[156:157], v235 offset:18432
    ds_read_b64_tr_b16 v[158:159], v235 offset:18944
    v_and_b32 v239, 0xffff0000, v201
    v_add_f32 v218, v218, v238
    v_add_f32 v219, v219, v239
    v_lshlrev_b32 v238, 16, v202
    v_and_b32 v239, 0xffff0000, v202
    v_add_f32 v220, v220, v238
    s_waitcnt vmcnt(7)
    s_waitcnt lgkmcnt(8)
    v_mfma_f32_32x32x16_bf16 v[112:127], v[160:163], v[60:63], v[112:127]
    ds_read_b64_tr_b16 v[160:161], v236 offset:18432
    ds_read_b64_tr_b16 v[162:163], v236 offset:18944
    buffer_load_dwordx4 v[92:95], v9, s[20:23], s41 offen offset:3072 sc1
    v_add_f32 v221, v221, v239
    v_lshlrev_b32 v238, 16, v203
    v_and_b32 v239, 0xffff0000, v203
    v_add_f32 v222, v222, v238
    v_add_f32 v223, v223, v239
    v_mfma_f32_32x32x16_bf16 v[128:143], v[164:167], v[60:63], v[128:143]
    ds_read_b64_tr_b16 v[164:165], v237 offset:18432
    ds_read_b64_tr_b16 v[166:167], v237 offset:18944
    v_lshlrev_b32 v238, 16, v204
    v_and_b32 v239, 0xffff0000, v204
    v_add_f32 v224, v224, v238
    v_add_f32 v225, v225, v239
    v_lshlrev_b32 v238, 16, v205
    v_and_b32 v239, 0xffff0000, v205
    s_waitcnt vmcnt(7)
    s_waitcnt lgkmcnt(8)
    v_mfma_f32_32x32x16_bf16 v[112:127], v[144:147], v[64:67], v[112:127]
    ds_read_b64_tr_b16 v[144:145], v232 offset:23040
    ds_read_b64_tr_b16 v[146:147], v232 offset:23552
    s_add_u32 s41, s41, 4096
    buffer_load_dwordx4 v[96:99], v9, s[20:23], s41 offen offset:0 sc1
    v_add_f32 v226, v226, v238
    v_add_f32 v227, v227, v239
    v_lshlrev_b32 v238, 16, v206
    v_and_b32 v239, 0xffff0000, v206
    v_add_f32 v228, v228, v238
    v_add_f32 v229, v229, v239
    v_mfma_f32_32x32x16_bf16 v[128:143], v[148:151], v[64:67], v[128:143]
    ds_read_b64_tr_b16 v[148:149], v233 offset:23040
    ds_read_b64_tr_b16 v[150:151], v233 offset:23552
    v_lshlrev_b32 v238, 16, v207
    v_and_b32 v239, 0xffff0000, v207
    v_add_f32 v230, v230, v238
    v_add_f32 v231, v231, v239
    v_mul_f32 v216, s50, v216
    s_waitcnt vmcnt(7)
    s_waitcnt lgkmcnt(8)
    v_mfma_f32_32x32x16_bf16 v[112:127], v[152:155], v[68:71], v[112:127]
    ds_read_b64_tr_b16 v[152:153], v234 offset:23040
    ds_read_b64_tr_b16 v[154:155], v234 offset:23552
    buffer_load_dwordx4 v[100:103], v9, s[20:23], s41 offen offset:1024 sc1
    v_mul_f32 v168, s51, v216
    v_mul_f32 v217, s50, v217
    v_mul_f32 v169, s51, v217
    v_mul_f32 v218, s50, v218
    v_mul_f32 v170, s51, v218
    v_mul_f32 v219, s50, v219
    v_mfma_f32_32x32x16_bf16 v[128:143], v[156:159], v[68:71], v[128:143]
    ds_read_b64_tr_b16 v[156:157], v235 offset:23040
    ds_read_b64_tr_b16 v[158:159], v235 offset:23552
    v_mul_f32 v171, s51, v219
    v_mul_f32 v220, s50, v220
    v_mul_f32 v172, s51, v220
    v_mul_f32 v221, s50, v221
    v_mul_f32 v173, s51, v221
    s_waitcnt vmcnt(7)
    s_waitcnt lgkmcnt(8)
    v_mfma_f32_32x32x16_bf16 v[112:127], v[160:163], v[72:75], v[112:127]
    ds_read_b64_tr_b16 v[160:161], v236 offset:23040
    ds_read_b64_tr_b16 v[162:163], v236 offset:23552
    buffer_load_dwordx4 v[104:107], v9, s[20:23], s41 offen offset:2048 sc1
    v_mul_f32 v222, s50, v222
    v_mul_f32 v174, s51, v222
    v_mul_f32 v223, s50, v223
    v_mul_f32 v175, s51, v223
    v_mul_f32 v224, s50, v224
    v_mul_f32 v176, s51, v224
    v_mfma_f32_32x32x16_bf16 v[128:143], v[164:167], v[72:75], v[128:143]
    ds_read_b64_tr_b16 v[164:165], v237 offset:23040
    ds_read_b64_tr_b16 v[166:167], v237 offset:23552
    v_mul_f32 v225, s50, v225
    v_mul_f32 v177, s51, v225
    v_mul_f32 v226, s50, v226
    v_mul_f32 v178, s51, v226
    v_mul_f32 v227, s50, v227
    s_waitcnt vmcnt(7)
    s_waitcnt lgkmcnt(8)
    v_mfma_f32_32x32x16_bf16 v[112:127], v[144:147], v[76:79], v[112:127]
    ds_read_b64_tr_b16 v[144:145], v232 offset:27648
    ds_read_b64_tr_b16 v[146:147], v232 offset:28160
    buffer_load_dwordx4 v[108:111], v9, s[20:23], s41 offen offset:3072 sc1
    v_mul_f32 v179, s51, v227
    v_mul_f32 v228, s50, v228
    v_mul_f32 v180, s51, v228
    v_mul_f32 v229, s50, v229
    v_mul_f32 v181, s51, v229
    v_mul_f32 v230, s50, v230
    v_mfma_f32_32x32x16_bf16 v[128:143], v[148:151], v[76:79], v[128:143]
    ds_read_b64_tr_b16 v[148:149], v233 offset:27648
    ds_read_b64_tr_b16 v[150:151], v233 offset:28160
    v_mul_f32 v182, s51, v230
    v_mul_f32 v231, s50, v231
    v_mul_f32 v183, s51, v231
    v_exp_f32 v168, v168
    v_exp_f32 v169, v169
    v_exp_f32 v170, v170
    s_waitcnt vmcnt(7)
    s_waitcnt lgkmcnt(8)
    v_mfma_f32_32x32x16_bf16 v[112:127], v[152:155], v[80:83], v[112:127]
    ds_read_b64_tr_b16 v[152:153], v234 offset:27648
    ds_read_b64_tr_b16 v[154:155], v234 offset:28160
    v_exp_f32 v171, v171
    v_exp_f32 v172, v172
    v_exp_f32 v173, v173
    v_exp_f32 v174, v174
    v_exp_f32 v175, v175
    v_mfma_f32_32x32x16_bf16 v[128:143], v[156:159], v[80:83], v[128:143]
    ds_read_b64_tr_b16 v[156:157], v235 offset:27648
    ds_read_b64_tr_b16 v[158:159], v235 offset:28160
    v_exp_f32 v176, v176
    v_exp_f32 v177, v177
    v_exp_f32 v178, v178
    v_exp_f32 v179, v179
    v_exp_f32 v180, v180
    v_exp_f32 v181, v181
    s_waitcnt vmcnt(6)
    s_waitcnt lgkmcnt(8)
    v_mfma_f32_32x32x16_bf16 v[112:127], v[160:163], v[84:87], v[112:127]
    ds_read_b64_tr_b16 v[160:161], v236 offset:27648
    ds_read_b64_tr_b16 v[162:163], v236 offset:28160
    v_exp_f32 v182, v182
    v_exp_f32 v183, v183
    v_add_f32 v168, 1.0, v168
    v_add_f32 v169, 1.0, v169
    v_add_f32 v170, 1.0, v170
    v_mfma_f32_32x32x16_bf16 v[128:143], v[164:167], v[84:87], v[128:143]
    ds_read_b64_tr_b16 v[164:165], v237 offset:27648
    ds_read_b64_tr_b16 v[166:167], v237 offset:28160
    v_add_f32 v171, 1.0, v171
    v_add_f32 v172, 1.0, v172
    v_add_f32 v173, 1.0, v173
    v_add_f32 v174, 1.0, v174
    v_add_f32 v175, 1.0, v175
    v_add_f32 v176, 1.0, v176
    s_waitcnt vmcnt(5)
    s_waitcnt lgkmcnt(8)
    v_mfma_f32_32x32x16_bf16 v[112:127], v[144:147], v[88:91], v[112:127]
    ds_read_b64_tr_b16 v[144:145], v232 offset:32256
    ds_read_b64_tr_b16 v[146:147], v232 offset:32768
    v_add_f32 v177, 1.0, v177
    v_add_f32 v178, 1.0, v178
    v_add_f32 v179, 1.0, v179
    v_add_f32 v180, 1.0, v180
    v_add_f32 v181, 1.0, v181
    v_mfma_f32_32x32x16_bf16 v[128:143], v[148:151], v[88:91], v[128:143]
    ds_read_b64_tr_b16 v[148:149], v233 offset:32256
    ds_read_b64_tr_b16 v[150:151], v233 offset:32768
    v_add_f32 v182, 1.0, v182
    v_add_f32 v183, 1.0, v183
    v_rcp_f32 v168, v168
    v_rcp_f32 v169, v169
    v_rcp_f32 v170, v170
    v_rcp_f32 v171, v171
    s_waitcnt vmcnt(4)
    s_waitcnt lgkmcnt(8)
    v_mfma_f32_32x32x16_bf16 v[112:127], v[152:155], v[92:95], v[112:127]
    ds_read_b64_tr_b16 v[152:153], v234 offset:32256
    ds_read_b64_tr_b16 v[154:155], v234 offset:32768
    v_rcp_f32 v172, v172
    v_rcp_f32 v173, v173
    v_rcp_f32 v174, v174
    v_rcp_f32 v175, v175
    v_rcp_f32 v176, v176
    v_rcp_f32 v177, v177
    v_mfma_f32_32x32x16_bf16 v[128:143], v[156:159], v[92:95], v[128:143]
    ds_read_b64_tr_b16 v[156:157], v235 offset:32256
    ds_read_b64_tr_b16 v[158:159], v235 offset:32768
    v_rcp_f32 v178, v178
    v_rcp_f32 v179, v179
    v_rcp_f32 v180, v180
    v_rcp_f32 v181, v181
    v_rcp_f32 v182, v182
    s_waitcnt vmcnt(3)
    s_waitcnt lgkmcnt(8)
    v_mfma_f32_32x32x16_bf16 v[112:127], v[160:163], v[96:99], v[112:127]
    ds_read_b64_tr_b16 v[160:161], v236 offset:32256
    ds_read_b64_tr_b16 v[162:163], v236 offset:32768
    v_rcp_f32 v183, v183
    v_lshlrev_b32 v184, 16, v208
    v_and_b32 v185, 0xffff0000, v208
    v_lshlrev_b32 v186, 16, v209
    v_and_b32 v187, 0xffff0000, v209
    v_lshlrev_b32 v188, 16, v210
    v_mfma_f32_32x32x16_bf16 v[128:143], v[164:167], v[96:99], v[128:143]
    ds_read_b64_tr_b16 v[164:165], v237 offset:32256
    ds_read_b64_tr_b16 v[166:167], v237 offset:32768
    v_and_b32 v189, 0xffff0000, v210
    v_lshlrev_b32 v190, 16, v211
    v_and_b32 v191, 0xffff0000, v211
    v_lshlrev_b32 v192, 16, v212
    v_and_b32 v193, 0xffff0000, v212
    s_waitcnt vmcnt(2)
    s_waitcnt lgkmcnt(8)
    v_mfma_f32_32x32x16_bf16 v[112:127], v[144:147], v[100:103], v[112:127]
    v_lshlrev_b32 v194, 16, v213
    v_and_b32 v195, 0xffff0000, v213
    v_lshlrev_b32 v196, 16, v214
    v_and_b32 v197, 0xffff0000, v214
    v_lshlrev_b32 v198, 16, v215
    v_and_b32 v199, 0xffff0000, v215
    v_mfma_f32_32x32x16_bf16 v[128:143], v[148:151], v[100:103], v[128:143]
    v_mul_f32 v216, v216, v168
    v_mul_f32 v217, v217, v169
    v_mul_f32 v218, v218, v170
    v_mul_f32 v219, v219, v171
    v_mul_f32 v220, v220, v172
    s_waitcnt vmcnt(1)
    s_waitcnt lgkmcnt(4)
    v_mfma_f32_32x32x16_bf16 v[112:127], v[152:155], v[104:107], v[112:127]
    v_mul_f32 v221, v221, v173
    v_mul_f32 v222, v222, v174
    v_mul_f32 v223, v223, v175
    v_mul_f32 v224, v224, v176
    v_mul_f32 v225, v225, v177
    v_mul_f32 v226, v226, v178
    v_mfma_f32_32x32x16_bf16 v[128:143], v[156:159], v[104:107], v[128:143]
    v_mul_f32 v227, v227, v179
    v_mul_f32 v228, v228, v180
    v_mul_f32 v229, v229, v181
    v_mul_f32 v230, v230, v182
    v_mul_f32 v231, v231, v183
    s_waitcnt vmcnt(0)
    s_waitcnt lgkmcnt(0)
    v_mfma_f32_32x32x16_bf16 v[112:127], v[160:163], v[108:111], v[112:127]
    v_mfma_f32_32x32x16_bf16 v[128:143], v[164:167], v[108:111], v[128:143]
    s_barrier
    s_lshl_b32 s40, s3, 12
    v_add_u32 v4, s40, v9
    s_nop 7
    s_cmp_eq_u32 s44, 0
    s_cbranch_scc1 k2_kernel_l_k_15
    ds_write_b128 v4, v[112:115] offset:0
    ds_write_b128 v4, v[116:119] offset:1024
    ds_write_b128 v4, v[120:123] offset:2048
    ds_write_b128 v4, v[124:127] offset:3072
    s_waitcnt lgkmcnt(0)
    v_mov_b32 v112, v128
    v_mov_b32 v113, v129
    v_mov_b32 v114, v130
    v_mov_b32 v115, v131
    v_mov_b32 v116, v132
    v_mov_b32 v117, v133
    v_mov_b32 v118, v134
    v_mov_b32 v119, v135
    v_mov_b32 v120, v136
    v_mov_b32 v121, v137
    v_mov_b32 v122, v138
    v_mov_b32 v123, v139
    v_mov_b32 v124, v140
    v_mov_b32 v125, v141
    v_mov_b32 v126, v142
    v_mov_b32 v127, v143
    s_branch k2_kernel_l_j_16
k2_kernel_l_k_15:
    ds_write_b128 v4, v[128:131] offset:0
    ds_write_b128 v4, v[132:135] offset:1024
    ds_write_b128 v4, v[136:139] offset:2048
    ds_write_b128 v4, v[140:143] offset:3072
k2_kernel_l_j_16:
    s_waitcnt lgkmcnt(0)
    s_barrier
    s_xor_b32 s40, s3, 1
    s_lshl_b32 s40, s40, 12
    v_add_u32 v4, s40, v9
    ds_read_b128 v[32:35], v4 offset:0
    ds_read_b128 v[36:39], v4 offset:1024
    ds_read_b128 v[40:43], v4 offset:2048
    ds_read_b128 v[44:47], v4 offset:3072
    s_waitcnt lgkmcnt(0)
    v_add_f32 v112, v112, v32
    v_add_f32 v113, v113, v33
    v_add_f32 v114, v114, v34
    v_add_f32 v115, v115, v35
    v_add_f32 v116, v116, v36
    v_add_f32 v117, v117, v37
    v_add_f32 v118, v118, v38
    v_add_f32 v119, v119, v39
    v_add_f32 v120, v120, v40
    v_add_f32 v121, v121, v41
    v_add_f32 v122, v122, v42
    v_add_f32 v123, v123, v43
    v_add_f32 v124, v124, v44
    v_add_f32 v125, v125, v45
    v_add_f32 v126, v126, v46
    v_add_f32 v127, v127, v47
    v_fma_f32 v216, v216, v112, v184
    v_fma_f32 v217, v217, v113, v185
    v_fma_f32 v218, v218, v114, v186
    v_fma_f32 v219, v219, v115, v187
    v_fma_f32 v220, v220, v116, v188
    v_fma_f32 v221, v221, v117, v189
    v_fma_f32 v222, v222, v118, v190
    v_fma_f32 v223, v223, v119, v191
    v_fma_f32 v224, v224, v120, v192
    v_fma_f32 v225, v225, v121, v193
    v_fma_f32 v226, v226, v122, v194
    v_fma_f32 v227, v227, v123, v195
    v_fma_f32 v228, v228, v124, v196
    v_fma_f32 v229, v229, v125, v197
    v_fma_f32 v230, v230, v126, v198
    v_fma_f32 v231, v231, v127, v199
    v_cvt_pk_bf16_f32 v216, v216, v217
    v_cvt_pk_bf16_f32 v217, v218, v219
    v_cvt_pk_bf16_f32 v218, v220, v221
    v_cvt_pk_bf16_f32 v219, v222, v223
    v_cvt_pk_bf16_f32 v220, v224, v225
    v_cvt_pk_bf16_f32 v221, v226, v227
    v_cvt_pk_bf16_f32 v222, v228, v229
    v_cvt_pk_bf16_f32 v223, v230, v231
    buffer_store_dwordx4 v[216:219], v10, s[32:35], 0 offen
    buffer_store_dwordx4 v[220:223], v10, s[32:35], 0 offen offset:32
    s_endpgm
k2_kernel_down:
    s_cmp_ge_u32 s2, 496
    s_cbranch_scc1 k2_kernel_end
    s_sub_u32 s58, s2, 256
    s_load_dwordx2 s[4:5], s[0:1], 48
    s_load_dwordx2 s[12:13], s[0:1], 72
    v_lshrrev_b32 v1, 6, v0
    s_and_b32 s41, s58, 7
    v_readfirstlane_b32 s3, v1
    s_lshr_b32 s42, s58, 3
    s_mul_i32 s41, s41, 30
    s_add_u32 s41, s41, s42
    s_mul_i32 s42, s41, 2731
    s_lshr_b32 s42, s42, 16
    s_mul_i32 s14, s42, 24
    s_sub_u32 s41, s41, s14
    s_lshr_b32 s40, s42, 1
    s_and_b32 s42, s42, 1
    s_lshl_b32 s42, s42, 3
    s_lshr_b32 s15, s41, 3
    s_and_b32 s14, s41, 7
    s_add_u32 s14, s14, s42
    s_cmp_eq_u32 s40, 4
    s_cselect_b32 s55, 28, 29
    v_and_b32 v1, 63, v0
    s_waitcnt lgkmcnt(0)
    s_mov_b32 s16, s4
    s_mov_b32 s17, s5
    s_mov_b32 s18, 0x510000
    s_mov_b32 s19, 0x20000
    s_add_u32 s20, s12, 0x1000000
    s_addc_u32 s21, s13, 0
    s_mov_b32 s22, 0x1200000
    s_mov_b32 s23, 0x20000
    s_add_u32 s24, s12, 0x2400000
    s_addc_u32 s25, s13, 0
    s_mov_b32 s26, 0xb40000
    s_mov_b32 s27, 0x20000
    s_movk_i32 s41, 1152
    v_lshrrev_b32 v2, 3, v1
    v_mul_lo_u32 v10, v2, s41
    v_bfe_u32 v2, v1, 4, 1
    v_lshlrev_b32 v2, 2, v2
    v_and_b32 v3, 7, v1
    v_xor_b32 v2, v2, v3
    v_lshl_add_u32 v10, v2, 4, v10
    v_lshlrev_b32 v11, 4, v1
    v_lshrrev_b32 v2, 5, v1
    v_lshlrev_b32 v2, 3, v2
    v_bfe_u32 v3, v1, 2, 2
    v_add_u32 v2, v2, v3
    v_lshlrev_b32 v4, 7, v2
    v_bfe_u32 v2, v1, 3, 1
    v_lshl_add_u32 v4, v2, 6, v4
    v_bfe_u32 v2, v1, 4, 1
    v_lshl_add_u32 v4, v2, 5, v4
    v_and_b32 v2, 1, v1
    v_lshl_add_u32 v4, v2, 4, v4
    v_bfe_u32 v2, v1, 1, 1
    v_lshl_add_u32 v4, v2, 3, v4
    v_xor_b32 v5, 64, v4
    s_mul_i32 s41, s3, 3
    s_add_u32 s41, s41, 0
    s_lshr_b32 s42, s41, 2
    s_and_b32 s41, s41, 3
    s_mul_i32 s41, s41, 9216
    s_lshl_b32 s42, s42, 7
    s_add_u32 s48, s41, s42
    s_mul_i32 s41, s3, 3
    s_add_u32 s41, s41, 1
    s_lshr_b32 s42, s41, 2
    s_and_b32 s41, s41, 3
    s_mul_i32 s41, s41, 9216
    s_lshl_b32 s42, s42, 7
    s_add_u32 s49, s41, s42
    s_mul_i32 s41, s3, 3
    s_add_u32 s41, s41, 2
    s_lshr_b32 s42, s41, 2
    s_and_b32 s41, s41, 3
    s_mul_i32 s41, s41, 9216
    s_lshl_b32 s42, s42, 7
    s_add_u32 s50, s41, s42
    s_mul_i32 s51, s3, 3072
    s_mul_i32 s44, s40, 1069056
    s_mul_i32 s41, s15, 384
    s_add_u32 s44, s44, s41
    s_lshl_b32 s41, s14, 2
    s_add_u32 s41, s41, s3
    s_mul_i32 s45, s41, 288
    s_mul_i32 s42, s40, 58
    s_add_u32 s45, s45, s42
    s_lshl_b32 s45, s45, 10
    s_mul_i32 s52, s41, 18
    s_mul_i32 s42, s40, 1152
    s_add_u32 s52, s52, s42
    s_mul_i32 s42, s15, 6
    s_add_u32 s52, s52, s42
    s_lshl_b32 s52, s52, 11
    s_and_b32 s41, s14, 7
    s_lshl_b32 s41, s41, 2
    s_add_u32 s41, s41, s3
    s_mul_i32 s41, s41, 6
    v_mul_u32_u24 v2, 43, v1
    v_lshrrev_b32 v2, 7, v2
    v_mul_u32_u24 v3, 3, v2
    v_sub_u32 v3, v1, v3
    v_add_u32 v2, s41, v2
    s_movk_i32 s42, 1152
    v_mul_lo_u32 v12, v2, s42
    v_lshl_add_u32 v12, v3, 7, v12
    v_cmp_gt_u32 vcc, 18, v1
    v_mov_b32 v3, 0x7fffffff
    s_nop 0
    v_cndmask_b32 v12, v3, v12, vcc
    s_lshl_b32 s41, s15, 12
    v_lshlrev_b32 v13, 7, v1
    v_add_u32 v13, s41, v13
    v_cmp_gt_u32 vcc, 32, v1
    s_nop 1
    v_cndmask_b32 v13, v3, v13, vcc
    s_add_u32 m0, s51, 0
    s_add_u32 s41, s44, s48
    buffer_load_dwordx4 v10, s[16:19], s41 offen lds
    s_add_u32 m0, m0, 1024
    s_add_u32 s41, s44, s49
    buffer_load_dwordx4 v10, s[16:19], s41 offen lds
    s_add_u32 m0, m0, 1024
    s_add_u32 s41, s44, s50
    buffer_load_dwordx4 v10, s[16:19], s41 offen lds
    buffer_load_dwordx4 v[112:115], v11, s[20:23], s45 offen offset:0
    buffer_load_dwordx4 v[116:119], v11, s[20:23], s45 offen offset:1024
    s_add_u32 s44, s44, 36864
    s_add_u32 s45, s45, 2048
    s_add_u32 m0, s51, 12288
    s_add_u32 s41, s44, s48
    buffer_load_dwordx4 v10, s[16:19], s41 offen lds
    s_add_u32 m0, m0, 1024
    s_add_u32 s41, s44, s49
    buffer_load_dwordx4 v10, s[16:19], s41 offen lds
    s_add_u32 m0, m0, 1024
    s_add_u32 s41, s44, s50
    buffer_load_dwordx4 v10, s[16:19], s41 offen lds
    buffer_load_dwordx4 v[120:123], v11, s[20:23], s45 offen offset:0
    buffer_load_dwordx4 v[124:127], v11, s[20:23], s45 offen offset:1024
    s_add_u32 s44, s44, 36864
    s_add_u32 s45, s45, 2048
    s_add_u32 m0, s51, 24576
    s_add_u32 s41, s44, s48
    buffer_load_dwordx4 v10, s[16:19], s41 offen lds
    s_add_u32 m0, m0, 1024
    s_add_u32 s41, s44, s49
    buffer_load_dwordx4 v10, s[16:19], s41 offen lds
    s_add_u32 m0, m0, 1024
    s_add_u32 s41, s44, s50
    buffer_load_dwordx4 v10, s[16:19], s41 offen lds
    buffer_load_dwordx4 v[128:131], v11, s[20:23], s45 offen offset:0
    buffer_load_dwordx4 v[132:135], v11, s[20:23], s45 offen offset:1024
    s_add_u32 s44, s44, 36864
    s_add_u32 s45, s45, 2048
    v_mov_b32 v16, 0
    v_mov_b32 v17, 0
    v_mov_b32 v18, 0
    v_mov_b32 v19, 0
    v_mov_b32 v20, 0
    v_mov_b32 v21, 0
    v_mov_b32 v22, 0
    v_mov_b32 v23, 0
    v_mov_b32 v24, 0
    v_mov_b32 v25, 0
    v_mov_b32 v26, 0
    v_mov_b32 v27, 0
    v_mov_b32 v28, 0
    v_mov_b32 v29, 0
    v_mov_b32 v30, 0
    v_mov_b32 v31, 0
    v_mov_b32 v32, 0
    v_mov_b32 v33, 0
    v_mov_b32 v34, 0
    v_mov_b32 v35, 0
    v_mov_b32 v36, 0
    v_mov_b32 v37, 0
    v_mov_b32 v38, 0
    v_mov_b32 v39, 0
    v_mov_b32 v40, 0
    v_mov_b32 v41, 0
    v_mov_b32 v42, 0
    v_mov_b32 v43, 0
    v_mov_b32 v44, 0
    v_mov_b32 v45, 0
    v_mov_b32 v46, 0
    v_mov_b32 v47, 0
    v_mov_b32 v48, 0
    v_mov_b32 v49, 0
    v_mov_b32 v50, 0
    v_mov_b32 v51, 0
    v_mov_b32 v52, 0
    v_mov_b32 v53, 0
    v_mov_b32 v54, 0
    v_mov_b32 v55, 0
    v_mov_b32 v56, 0
    v_mov_b32 v57, 0
    v_mov_b32 v58, 0
    v_mov_b32 v59, 0
    v_mov_b32 v60, 0
    v_mov_b32 v61, 0
    v_mov_b32 v62, 0
    v_mov_b32 v63, 0
    v_mov_b32 v64, 0
    v_mov_b32 v65, 0
    v_mov_b32 v66, 0
    v_mov_b32 v67, 0
    v_mov_b32 v68, 0
    v_mov_b32 v69, 0
    v_mov_b32 v70, 0
    v_mov_b32 v71, 0
    v_mov_b32 v72, 0
    v_mov_b32 v73, 0
    v_mov_b32 v74, 0
    v_mov_b32 v75, 0
    v_mov_b32 v76, 0
    v_mov_b32 v77, 0
    v_mov_b32 v78, 0
    v_mov_b32 v79, 0
    v_mov_b32 v80, 0
    v_mov_b32 v81, 0
    v_mov_b32 v82, 0
    v_mov_b32 v83, 0
    v_mov_b32 v84, 0
    v_mov_b32 v85, 0
    v_mov_b32 v86, 0
    v_mov_b32 v87, 0
    v_mov_b32 v88, 0
    v_mov_b32 v89, 0
    v_mov_b32 v90, 0
    v_mov_b32 v91, 0
    v_mov_b32 v92, 0
    v_mov_b32 v93, 0
    v_mov_b32 v94, 0
    v_mov_b32 v95, 0
    v_mov_b32 v96, 0
    v_mov_b32 v97, 0
    v_mov_b32 v98, 0
    v_mov_b32 v99, 0
    v_mov_b32 v100, 0
    v_mov_b32 v101, 0
    v_mov_b32 v102, 0
    v_mov_b32 v103, 0
    v_mov_b32 v104, 0
    v_mov_b32 v105, 0
    v_mov_b32 v106, 0
    v_mov_b32 v107, 0
    v_mov_b32 v108, 0
    v_mov_b32 v109, 0
    v_mov_b32 v110, 0
    v_mov_b32 v111, 0
    s_waitcnt vmcnt(10)
    s_barrier
    v_add_u32 v6, 0, v4
    v_add_u32 v7, 0, v5
    ds_read_b64_tr_b16 v[160:161], v6 offset:0
    ds_read_b64_tr_b16 v[162:163], v6 offset:512
    ds_read_b64_tr_b16 v[164:165], v7 offset:0
    ds_read_b64_tr_b16 v[166:167], v7 offset:512
    ds_read_b64_tr_b16 v[168:169], v6 offset:4096
    ds_read_b64_tr_b16 v[170:171], v6 offset:4608
    ds_read_b64_tr_b16 v[172:173], v7 offset:4096
    ds_read_b64_tr_b16 v[174:175], v7 offset:4608
    ds_read_b64_tr_b16 v[176:177], v6 offset:8192
    ds_read_b64_tr_b16 v[178:179], v6 offset:8704
    ds_read_b64_tr_b16 v[180:181], v7 offset:8192
    ds_read_b64_tr_b16 v[182:183], v7 offset:8704
    s_mov_b32 s43, 0
k2_kernel_d_loop:
    s_add_u32 s42, s43, 3
    s_cmp_lt_u32 s42, s55
    s_cselect_b32 s56, 1, 0
    s_waitcnt lgkmcnt(8)
    v_mfma_f32_32x32x16_bf16 v[16:31], v[160:163], v[112:115], v[16:31]
    ds_read_b64_tr_b16 v[160:161], v6 offset:2048
    ds_read_b64_tr_b16 v[162:163], v6 offset:2560
    s_cmp_eq_u32 s56, 0
    s_cbranch_scc1 k2_kernel_d_sk_18
    s_add_u32 m0, s51, 36864
    s_add_u32 s41, s44, s48
    buffer_load_dwordx4 v10, s[16:19], s41 offen lds
k2_kernel_d_sk_18:
    v_mfma_f32_32x32x16_bf16 v[32:47], v[164:167], v[112:115], v[32:47]
    ds_read_b64_tr_b16 v[164:165], v7 offset:2048
    ds_read_b64_tr_b16 v[166:167], v7 offset:2560
    s_waitcnt lgkmcnt(8)
    v_mfma_f32_32x32x16_bf16 v[48:63], v[168:171], v[112:115], v[48:63]
    ds_read_b64_tr_b16 v[168:169], v6 offset:6144
    ds_read_b64_tr_b16 v[170:171], v6 offset:6656
    s_cmp_eq_u32 s56, 0
    s_cbranch_scc1 k2_kernel_d_sk_19
    s_add_u32 m0, m0, 1024
    s_add_u32 s41, s44, s49
    buffer_load_dwordx4 v10, s[16:19], s41 offen lds
k2_kernel_d_sk_19:
    v_mfma_f32_32x32x16_bf16 v[64:79], v[172:175], v[112:115], v[64:79]
    ds_read_b64_tr_b16 v[172:173], v7 offset:6144
    ds_read_b64_tr_b16 v[174:175], v7 offset:6656
    s_waitcnt lgkmcnt(8)
    v_mfma_f32_32x32x16_bf16 v[80:95], v[176:179], v[112:115], v[80:95]
    ds_read_b64_tr_b16 v[176:177], v6 offset:10240
    ds_read_b64_tr_b16 v[178:179], v6 offset:10752
    s_cmp_eq_u32 s56, 0
    s_cbranch_scc1 k2_kernel_d_sk_20
    s_add_u32 m0, m0, 1024
    s_add_u32 s41, s44, s50
    buffer_load_dwordx4 v10, s[16:19], s41 offen lds
k2_kernel_d_sk_20:
    v_mfma_f32_32x32x16_bf16 v[96:111], v[180:183], v[112:115], v[96:111]
    ds_read_b64_tr_b16 v[180:181], v7 offset:10240
    ds_read_b64_tr_b16 v[182:183], v7 offset:10752
    s_waitcnt lgkmcnt(8)
    v_mfma_f32_32x32x16_bf16 v[16:31], v[160:163], v[116:119], v[16:31]
    s_cmp_eq_u32 s56, 0
    s_cbranch_scc0 k2_kernel_d_tw_21
    s_waitcnt vmcnt(0)
k2_kernel_d_tw_21:
    s_waitcnt vmcnt(8)
    s_barrier
    v_add_u32 v8, 12288, v4
    v_add_u32 v9, 12288, v5
    ds_read_b64_tr_b16 v[160:161], v8 offset:0
    ds_read_b64_tr_b16 v[162:163], v8 offset:512
    s_cmp_eq_u32 s56, 0
    s_cbranch_scc1 k2_kernel_d_sk_22
    buffer_load_dwordx4 v[136:139], v11, s[20:23], s45 offen offset:0
k2_kernel_d_sk_22:
    v_mfma_f32_32x32x16_bf16 v[32:47], v[164:167], v[116:119], v[32:47]
    ds_read_b64_tr_b16 v[164:165], v9 offset:0
    ds_read_b64_tr_b16 v[166:167], v9 offset:512
    s_waitcnt lgkmcnt(8)
    v_mfma_f32_32x32x16_bf16 v[48:63], v[168:171], v[116:119], v[48:63]
    ds_read_b64_tr_b16 v[168:169], v8 offset:4096
    ds_read_b64_tr_b16 v[170:171], v8 offset:4608
    s_cmp_eq_u32 s56, 0
    s_cbranch_scc1 k2_kernel_d_sk_23
    buffer_load_dwordx4 v[140:143], v11, s[20:23], s45 offen offset:1024
    s_add_u32 s44, s44, 36864
    s_add_u32 s45, s45, 2048
k2_kernel_d_sk_23:
    v_mfma_f32_32x32x16_bf16 v[64:79], v[172:175], v[116:119], v[64:79]
    ds_read_b64_tr_b16 v[172:173], v9 offset:4096
    ds_read_b64_tr_b16 v[174:175], v9 offset:4608
    s_waitcnt lgkmcnt(8)
    v_mfma_f32_32x32x16_bf16 v[80:95], v[176:179], v[116:119], v[80:95]
    ds_read_b64_tr_b16 v[176:177], v8 offset:8192
    ds_read_b64_tr_b16 v[178:179], v8 offset:8704
    v_mfma_f32_32x32x16_bf16 v[96:111], v[180:183], v[116:119], v[96:111]
    ds_read_b64_tr_b16 v[180:181], v9 offset:8192
    ds_read_b64_tr_b16 v[182:183], v9 offset:8704
    s_add_u32 s42, s43, 1
    s_cmp_ge_u32 s42, s55
    s_cbranch_scc1 k2_kernel_d_fin
    s_add_u32 s42, s43, 4
    s_cmp_lt_u32 s42, s55
    s_cselect_b32 s56, 1, 0
    s_waitcnt lgkmcnt(8)
    v_mfma_f32_32x32x16_bf16 v[16:31], v[160:163], v[120:123], v[16:31]
    ds_read_b64_tr_b16 v[160:161], v8 offset:2048
    ds_read_b64_tr_b16 v[162:163], v8 offset:2560
    s_cmp_eq_u32 s56, 0
    s_cbranch_scc1 k2_kernel_d_sk_25
    s_add_u32 m0, s51, 49152
    s_add_u32 s41, s44, s48
    buffer_load_dwordx4 v10, s[16:19], s41 offen lds
k2_kernel_d_sk_25:
    v_mfma_f32_32x32x16_bf16 v[32:47], v[164:167], v[120:123], v[32:47]
    ds_read_b64_tr_b16 v[164:165], v9 offset:2048
    ds_read_b64_tr_b16 v[166:167], v9 offset:2560
    s_waitcnt lgkmcnt(8)
    v_mfma_f32_32x32x16_bf16 v[48:63], v[168:171], v[120:123], v[48:63]
    ds_read_b64_tr_b16 v[168:169], v8 offset:6144
    ds_read_b64_tr_b16 v[170:171], v8 offset:6656
    s_cmp_eq_u32 s56, 0
    s_cbranch_scc1 k2_kernel_d_sk_26
    s_add_u32 m0, m0, 1024
    s_add_u32 s41, s44, s49
    buffer_load_dwordx4 v10, s[16:19], s41 offen lds
k2_kernel_d_sk_26:
    v_mfma_f32_32x32x16_bf16 v[64:79], v[172:175], v[120:123], v[64:79]
    ds_read_b64_tr_b16 v[172:173], v9 offset:6144
    ds_read_b64_tr_b16 v[174:175], v9 offset:6656
    s_waitcnt lgkmcnt(8)
    v_mfma_f32_32x32x16_bf16 v[80:95], v[176:179], v[120:123], v[80:95]
    ds_read_b64_tr_b16 v[176:177], v8 offset:10240
    ds_read_b64_tr_b16 v[178:179], v8 offset:10752
    s_cmp_eq_u32 s56, 0
    s_cbranch_scc1 k2_kernel_d_sk_27
    s_add_u32 m0, m0, 1024
    s_add_u32 s41, s44, s50
    buffer_load_dwordx4 v10, s[16:19], s41 offen lds
k2_kernel_d_sk_27:
    v_mfma_f32_32x32x16_bf16 v[96:111], v[180:183], v[120:123], v[96:111]
    ds_read_b64_tr_b16 v[180:181], v9 offset:10240
    ds_read_b64_tr_b16 v[182:183], v9 offset:10752
    s_waitcnt lgkmcnt(8)
    v_mfma_f32_32x32x16_bf16 v[16:31], v[160:163], v[124:127], v[16:31]
    s_cmp_eq_u32 s56, 0
    s_cbranch_scc0 k2_kernel_d_tw_28
    s_waitcnt vmcnt(0)
k2_kernel_d_tw_28:
    s_waitcnt vmcnt(8)
    s_barrier
    v_add_u32 v6, 24576, v4
    v_add_u32 v7, 24576, v5
    ds_read_b64_tr_b16 v[160:161], v6 offset:0
    ds_read_b64_tr_b16 v[162:163], v6 offset:512
    s_cmp_eq_u32 s56, 0
    s_cbranch_scc1 k2_kernel_d_sk_29
    buffer_load_dwordx4 v[144:147], v11, s[20:23], s45 offen offset:0
k2_kernel_d_sk_29:
    v_mfma_f32_32x32x16_bf16 v[32:47], v[164:167], v[124:127], v[32:47]
    ds_read_b64_tr_b16 v[164:165], v7 offset:0
    ds_read_b64_tr_b16 v[166:167], v7 offset:512
    s_waitcnt lgkmcnt(8)
    v_mfma_f32_32x32x16_bf16 v[48:63], v[168:171], v[124:127], v[48:63]
    ds_read_b64_tr_b16 v[168:169], v6 offset:4096
    ds_read_b64_tr_b16 v[170:171], v6 offset:4608
    s_cmp_eq_u32 s56, 0
    s_cbranch_scc1 k2_kernel_d_sk_30
    buffer_load_dwordx4 v[148:151], v11, s[20:23], s45 offen offset:1024
    s_add_u32 s44, s44, 36864
    s_add_u32 s45, s45, 2048
k2_kernel_d_sk_30:
    v_mfma_f32_32x32x16_bf16 v[64:79], v[172:175], v[124:127], v[64:79]
    ds_read_b64_tr_b16 v[172:173], v7 offset:4096
    ds_read_b64_tr_b16 v[174:175], v7 offset:4608
    s_waitcnt lgkmcnt(8)
    v_mfma_f32_32x32x16_bf16 v[80:95], v[176:179], v[124:127], v[80:95]
    ds_read_b64_tr_b16 v[176:177], v6 offset:8192
    ds_read_b64_tr_b16 v[178:179], v6 offset:8704
    v_mfma_f32_32x32x16_bf16 v[96:111], v[180:183], v[124:127], v[96:111]
    ds_read_b64_tr_b16 v[180:181], v7 offset:8192
    ds_read_b64_tr_b16 v[182:183], v7 offset:8704
    s_add_u32 s42, s43, 2
    s_cmp_ge_u32 s42, s55
    s_cbranch_scc1 k2_kernel_d_fin
    s_add_u32 s42, s43, 5
    s_cmp_lt_u32 s42, s55
    s_cselect_b32 s56, 1, 0
    s_waitcnt lgkmcnt(8)
    v_mfma_f32_32x32x16_bf16 v[16:31], v[160:163], v[128:131], v[16:31]
    ds_read_b64_tr_b16 v[160:161], v6 offset:2048
    ds_read_b64_tr_b16 v[162:163], v6 offset:2560
    s_cmp_eq_u32 s56, 0
    s_cbranch_scc1 k2_kernel_d_sk_32
    s_add_u32 m0, s51, 61440
    s_add_u32 s41, s44, s48
    buffer_load_dwordx4 v10, s[16:19], s41 offen lds
k2_kernel_d_sk_32:
    v_mfma_f32_32x32x16_bf16 v[32:47], v[164:167], v[128:131], v[32:47]
    ds_read_b64_tr_b16 v[164:165], v7 offset:2048
    ds_read_b64_tr_b16 v[166:167], v7 offset:2560
    s_waitcnt lgkmcnt(8)
    v_mfma_f32_32x32x16_bf16 v[48:63], v[168:171], v[128:131], v[48:63]
    ds_read_b64_tr_b16 v[168:169], v6 offset:6144
    ds_read_b64_tr_b16 v[170:171], v6 offset:6656
    s_cmp_eq_u32 s56, 0
    s_cbranch_scc1 k2_kernel_d_sk_33
    s_add_u32 m0, m0, 1024
    s_add_u32 s41, s44, s49
    buffer_load_dwordx4 v10, s[16:19], s41 offen lds
k2_kernel_d_sk_33:
    v_mfma_f32_32x32x16_bf16 v[64:79], v[172:175], v[128:131], v[64:79]
    ds_read_b64_tr_b16 v[172:173], v7 offset:6144
    ds_read_b64_tr_b16 v[174:175], v7 offset:6656
    s_waitcnt lgkmcnt(8)
    v_mfma_f32_32x32x16_bf16 v[80:95], v[176:179], v[128:131], v[80:95]
    ds_read_b64_tr_b16 v[176:177], v6 offset:10240
    ds_read_b64_tr_b16 v[178:179], v6 offset:10752
    s_cmp_eq_u32 s56, 0
    s_cbranch_scc1 k2_kernel_d_sk_34
    s_add_u32 m0, m0, 1024
    s_add_u32 s41, s44, s50
    buffer_load_dwordx4 v10, s[16:19], s41 offen lds
k2_kernel_d_sk_34:
    v_mfma_f32_32x32x16_bf16 v[96:111], v[180:183], v[128:131], v[96:111]
    ds_read_b64_tr_b16 v[180:181], v7 offset:10240
    ds_read_b64_tr_b16 v[182:183], v7 offset:10752
    s_waitcnt lgkmcnt(8)
    v_mfma_f32_32x32x16_bf16 v[16:31], v[160:163], v[132:135], v[16:31]
    s_cmp_eq_u32 s56, 0
    s_cbranch_scc0 k2_kernel_d_tw_35
    s_waitcnt vmcnt(0)
k2_kernel_d_tw_35:
    s_waitcnt vmcnt(8)
    s_barrier
    v_add_u32 v8, 36864, v4
    v_add_u32 v9, 36864, v5
    ds_read_b64_tr_b16 v[160:161], v8 offset:0
    ds_read_b64_tr_b16 v[162:163], v8 offset:512
    s_cmp_eq_u32 s56, 0
    s_cbranch_scc1 k2_kernel_d_sk_36
    buffer_load_dwordx4 v[152:155], v11, s[20:23], s45 offen offset:0
k2_kernel_d_sk_36:
    v_mfma_f32_32x32x16_bf16 v[32:47], v[164:167], v[132:135], v[32:47]
    ds_read_b64_tr_b16 v[164:165], v9 offset:0
    ds_read_b64_tr_b16 v[166:167], v9 offset:512
    s_waitcnt lgkmcnt(8)
    v_mfma_f32_32x32x16_bf16 v[48:63], v[168:171], v[132:135], v[48:63]
    ds_read_b64_tr_b16 v[168:169], v8 offset:4096
    ds_read_b64_tr_b16 v[170:171], v8 offset:4608
    s_cmp_eq_u32 s56, 0
    s_cbranch_scc1 k2_kernel_d_sk_37
    buffer_load_dwordx4 v[156:159], v11, s[20:23], s45 offen offset:1024
    s_add_u32 s44, s44, 36864
    s_add_u32 s45, s45, 2048
k2_kernel_d_sk_37:
    v_mfma_f32_32x32x16_bf16 v[64:79], v[172:175], v[132:135], v[64:79]
    ds_read_b64_tr_b16 v[172:173], v9 offset:4096
    ds_read_b64_tr_b16 v[174:175], v9 offset:4608
    s_waitcnt lgkmcnt(8)
    v_mfma_f32_32x32x16_bf16 v[80:95], v[176:179], v[132:135], v[80:95]
    ds_read_b64_tr_b16 v[176:177], v8 offset:8192
    ds_read_b64_tr_b16 v[178:179], v8 offset:8704
    v_mfma_f32_32x32x16_bf16 v[96:111], v[180:183], v[132:135], v[96:111]
    ds_read_b64_tr_b16 v[180:181], v9 offset:8192
    ds_read_b64_tr_b16 v[182:183], v9 offset:8704
    s_add_u32 s42, s43, 3
    s_cmp_ge_u32 s42, s55
    s_cbranch_scc1 k2_kernel_d_fin
    s_add_u32 s42, s43, 6
    s_cmp_lt_u32 s42, s55
    s_cselect_b32 s56, 1, 0
    s_waitcnt lgkmcnt(8)
    v_mfma_f32_32x32x16_bf16 v[16:31], v[160:163], v[136:139], v[16:31]
    ds_read_b64_tr_b16 v[160:161], v8 offset:2048
    ds_read_b64_tr_b16 v[162:163], v8 offset:2560
    s_cmp_eq_u32 s56, 0
    s_cbranch_scc1 k2_kernel_d_sk_39
    s_add_u32 m0, s51, 0
    s_add_u32 s41, s44, s48
    buffer_load_dwordx4 v10, s[16:19], s41 offen lds
k2_kernel_d_sk_39:
    v_mfma_f32_32x32x16_bf16 v[32:47], v[164:167], v[136:139], v[32:47]
    ds_read_b64_tr_b16 v[164:165], v9 offset:2048
    ds_read_b64_tr_b16 v[166:167], v9 offset:2560
    s_waitcnt lgkmcnt(8)
    v_mfma_f32_32x32x16_bf16 v[48:63], v[168:171], v[136:139], v[48:63]
    ds_read_b64_tr_b16 v[168:169], v8 offset:6144
    ds_read_b64_tr_b16 v[170:171], v8 offset:6656
    s_cmp_eq_u32 s56, 0
    s_cbranch_scc1 k2_kernel_d_sk_40
    s_add_u32 m0, m0, 1024
    s_add_u32 s41, s44, s49
    buffer_load_dwordx4 v10, s[16:19], s41 offen lds
k2_kernel_d_sk_40:
    v_mfma_f32_32x32x16_bf16 v[64:79], v[172:175], v[136:139], v[64:79]
    ds_read_b64_tr_b16 v[172:173], v9 offset:6144
    ds_read_b64_tr_b16 v[174:175], v9 offset:6656
    s_waitcnt lgkmcnt(8)
    v_mfma_f32_32x32x16_bf16 v[80:95], v[176:179], v[136:139], v[80:95]
    ds_read_b64_tr_b16 v[176:177], v8 offset:10240
    ds_read_b64_tr_b16 v[178:179], v8 offset:10752
    s_cmp_eq_u32 s56, 0
    s_cbranch_scc1 k2_kernel_d_sk_41
    s_add_u32 m0, m0, 1024
    s_add_u32 s41, s44, s50
    buffer_load_dwordx4 v10, s[16:19], s41 offen lds
k2_kernel_d_sk_41:
    v_mfma_f32_32x32x16_bf16 v[96:111], v[180:183], v[136:139], v[96:111]
    ds_read_b64_tr_b16 v[180:181], v9 offset:10240
    ds_read_b64_tr_b16 v[182:183], v9 offset:10752
    s_waitcnt lgkmcnt(8)
    v_mfma_f32_32x32x16_bf16 v[16:31], v[160:163], v[140:143], v[16:31]
    s_cmp_eq_u32 s56, 0
    s_cbranch_scc0 k2_kernel_d_tw_42
    s_waitcnt vmcnt(0)
k2_kernel_d_tw_42:
    s_waitcnt vmcnt(8)
    s_barrier
    v_add_u32 v6, 49152, v4
    v_add_u32 v7, 49152, v5
    ds_read_b64_tr_b16 v[160:161], v6 offset:0
    ds_read_b64_tr_b16 v[162:163], v6 offset:512
    s_cmp_eq_u32 s56, 0
    s_cbranch_scc1 k2_kernel_d_sk_43
    buffer_load_dwordx4 v[112:115], v11, s[20:23], s45 offen offset:0
k2_kernel_d_sk_43:
    v_mfma_f32_32x32x16_bf16 v[32:47], v[164:167], v[140:143], v[32:47]
    ds_read_b64_tr_b16 v[164:165], v7 offset:0
    ds_read_b64_tr_b16 v[166:167], v7 offset:512
    s_waitcnt lgkmcnt(8)
    v_mfma_f32_32x32x16_bf16 v[48:63], v[168:171], v[140:143], v[48:63]
    ds_read_b64_tr_b16 v[168:169], v6 offset:4096
    ds_read_b64_tr_b16 v[170:171], v6 offset:4608
    s_cmp_eq_u32 s56, 0
    s_cbranch_scc1 k2_kernel_d_sk_44
    buffer_load_dwordx4 v[116:119], v11, s[20:23], s45 offen offset:1024
    s_add_u32 s44, s44, 36864
    s_add_u32 s45, s45, 2048
k2_kernel_d_sk_44:
    v_mfma_f32_32x32x16_bf16 v[64:79], v[172:175], v[140:143], v[64:79]
    ds_read_b64_tr_b16 v[172:173], v7 offset:4096
    ds_read_b64_tr_b16 v[174:175], v7 offset:4608
    s_waitcnt lgkmcnt(8)
    v_mfma_f32_32x32x16_bf16 v[80:95], v[176:179], v[140:143], v[80:95]
    ds_read_b64_tr_b16 v[176:177], v6 offset:8192
    ds_read_b64_tr_b16 v[178:179], v6 offset:8704
    v_mfma_f32_32x32x16_bf16 v[96:111], v[180:183], v[140:143], v[96:111]
    ds_read_b64_tr_b16 v[180:181], v7 offset:8192
    ds_read_b64_tr_b16 v[182:183], v7 offset:8704
    s_add_u32 s42, s43, 4
    s_cmp_ge_u32 s42, s55
    s_cbranch_scc1 k2_kernel_d_fin
    s_add_u32 s42, s43, 7
    s_cmp_lt_u32 s42, s55
    s_cselect_b32 s56, 1, 0
    s_waitcnt lgkmcnt(8)
    v_mfma_f32_32x32x16_bf16 v[16:31], v[160:163], v[144:147], v[16:31]
    ds_read_b64_tr_b16 v[160:161], v6 offset:2048
    ds_read_b64_tr_b16 v[162:163], v6 offset:2560
    s_cmp_eq_u32 s56, 0
    s_cbranch_scc1 k2_kernel_d_sk_46
    s_add_u32 m0, s51, 12288
    s_add_u32 s41, s44, s48
    buffer_load_dwordx4 v10, s[16:19], s41 offen lds
k2_kernel_d_sk_46:
    v_mfma_f32_32x32x16_bf16 v[32:47], v[164:167], v[144:147], v[32:47]
    ds_read_b64_tr_b16 v[164:165], v7 offset:2048
    ds_read_b64_tr_b16 v[166:167], v7 offset:2560
    s_waitcnt lgkmcnt(8)
    v_mfma_f32_32x32x16_bf16 v[48:63], v[168:171], v[144:147], v[48:63]
    ds_read_b64_tr_b16 v[168:169], v6 offset:6144
    ds_read_b64_tr_b16 v[170:171], v6 offset:6656
    s_cmp_eq_u32 s56, 0
    s_cbranch_scc1 k2_kernel_d_sk_47
    s_add_u32 m0, m0, 1024
    s_add_u32 s41, s44, s49
    buffer_load_dwordx4 v10, s[16:19], s41 offen lds
k2_kernel_d_sk_47:
    v_mfma_f32_32x32x16_bf16 v[64:79], v[172:175], v[144:147], v[64:79]
    ds_read_b64_tr_b16 v[172:173], v7 offset:6144
    ds_read_b64_tr_b16 v[174:175], v7 offset:6656
    s_waitcnt lgkmcnt(8)
    v_mfma_f32_32x32x16_bf16 v[80:95], v[176:179], v[144:147], v[80:95]
    ds_read_b64_tr_b16 v[176:177], v6 offset:10240
    ds_read_b64_tr_b16 v[178:179], v6 offset:10752
    s_cmp_eq_u32 s56, 0
    s_cbranch_scc1 k2_kernel_d_sk_48
    s_add_u32 m0, m0, 1024
    s_add_u32 s41, s44, s50
    buffer_load_dwordx4 v10, s[16:19], s41 offen lds
k2_kernel_d_sk_48:
    v_mfma_f32_32x32x16_bf16 v[96:111], v[180:183], v[144:147], v[96:111]
    ds_read_b64_tr_b16 v[180:181], v7 offset:10240
    ds_read_b64_tr_b16 v[182:183], v7 offset:10752
    s_waitcnt lgkmcnt(8)
    v_mfma_f32_32x32x16_bf16 v[16:31], v[160:163], v[148:151], v[16:31]
    s_cmp_eq_u32 s56, 0
    s_cbranch_scc0 k2_kernel_d_tw_49
    s_waitcnt vmcnt(0)
k2_kernel_d_tw_49:
    s_waitcnt vmcnt(8)
    s_barrier
    v_add_u32 v8, 61440, v4
    v_add_u32 v9, 61440, v5
    ds_read_b64_tr_b16 v[160:161], v8 offset:0
    ds_read_b64_tr_b16 v[162:163], v8 offset:512
    s_cmp_eq_u32 s56, 0
    s_cbranch_scc1 k2_kernel_d_sk_50
    buffer_load_dwordx4 v[120:123], v11, s[20:23], s45 offen offset:0
k2_kernel_d_sk_50:
    v_mfma_f32_32x32x16_bf16 v[32:47], v[164:167], v[148:151], v[32:47]
    ds_read_b64_tr_b16 v[164:165], v9 offset:0
    ds_read_b64_tr_b16 v[166:167], v9 offset:512
    s_waitcnt lgkmcnt(8)
    v_mfma_f32_32x32x16_bf16 v[48:63], v[168:171], v[148:151], v[48:63]
    ds_read_b64_tr_b16 v[168:169], v8 offset:4096
    ds_read_b64_tr_b16 v[170:171], v8 offset:4608
    s_cmp_eq_u32 s56, 0
    s_cbranch_scc1 k2_kernel_d_sk_51
    buffer_load_dwordx4 v[124:127], v11, s[20:23], s45 offen offset:1024
    s_add_u32 s44, s44, 36864
    s_add_u32 s45, s45, 2048
k2_kernel_d_sk_51:
    v_mfma_f32_32x32x16_bf16 v[64:79], v[172:175], v[148:151], v[64:79]
    ds_read_b64_tr_b16 v[172:173], v9 offset:4096
    ds_read_b64_tr_b16 v[174:175], v9 offset:4608
    s_waitcnt lgkmcnt(8)
    v_mfma_f32_32x32x16_bf16 v[80:95], v[176:179], v[148:151], v[80:95]
    ds_read_b64_tr_b16 v[176:177], v8 offset:8192
    ds_read_b64_tr_b16 v[178:179], v8 offset:8704
    v_mfma_f32_32x32x16_bf16 v[96:111], v[180:183], v[148:151], v[96:111]
    ds_read_b64_tr_b16 v[180:181], v9 offset:8192
    ds_read_b64_tr_b16 v[182:183], v9 offset:8704
    s_add_u32 s42, s43, 5
    s_cmp_ge_u32 s42, s55
    s_cbranch_scc1 k2_kernel_d_fin
    s_add_u32 s42, s43, 8
    s_cmp_lt_u32 s42, s55
    s_cselect_b32 s56, 1, 0
    s_waitcnt lgkmcnt(8)
    v_mfma_f32_32x32x16_bf16 v[16:31], v[160:163], v[152:155], v[16:31]
    ds_read_b64_tr_b16 v[160:161], v8 offset:2048
    ds_read_b64_tr_b16 v[162:163], v8 offset:2560
    s_cmp_eq_u32 s56, 0
    s_cbranch_scc1 k2_kernel_d_sk_53
    s_add_u32 m0, s51, 24576
    s_add_u32 s41, s44, s48
    buffer_load_dwordx4 v10, s[16:19], s41 offen lds
k2_kernel_d_sk_53:
    v_mfma_f32_32x32x16_bf16 v[32:47], v[164:167], v[152:155], v[32:47]
    ds_read_b64_tr_b16 v[164:165], v9 offset:2048
    ds_read_b64_tr_b16 v[166:167], v9 offset:2560
    s_waitcnt lgkmcnt(8)
    v_mfma_f32_32x32x16_bf16 v[48:63], v[168:171], v[152:155], v[48:63]
    ds_read_b64_tr_b16 v[168:169], v8 offset:6144
    ds_read_b64_tr_b16 v[170:171], v8 offset:6656
    s_cmp_eq_u32 s56, 0
    s_cbranch_scc1 k2_kernel_d_sk_54
    s_add_u32 m0, m0, 1024
    s_add_u32 s41, s44, s49
    buffer_load_dwordx4 v10, s[16:19], s41 offen lds
k2_kernel_d_sk_54:
    v_mfma_f32_32x32x16_bf16 v[64:79], v[172:175], v[152:155], v[64:79]
    ds_read_b64_tr_b16 v[172:173], v9 offset:6144
    ds_read_b64_tr_b16 v[174:175], v9 offset:6656
    s_waitcnt lgkmcnt(8)
    v_mfma_f32_32x32x16_bf16 v[80:95], v[176:179], v[152:155], v[80:95]
    ds_read_b64_tr_b16 v[176:177], v8 offset:10240
    ds_read_b64_tr_b16 v[178:179], v8 offset:10752
    s_cmp_eq_u32 s56, 0
    s_cbranch_scc1 k2_kernel_d_sk_55
    s_add_u32 m0, m0, 1024
    s_add_u32 s41, s44, s50
    buffer_load_dwordx4 v10, s[16:19], s41 offen lds
k2_kernel_d_sk_55:
    v_mfma_f32_32x32x16_bf16 v[96:111], v[180:183], v[152:155], v[96:111]
    ds_read_b64_tr_b16 v[180:181], v9 offset:10240
    ds_read_b64_tr_b16 v[182:183], v9 offset:10752
    s_waitcnt lgkmcnt(8)
    v_mfma_f32_32x32x16_bf16 v[16:31], v[160:163], v[156:159], v[16:31]
    s_cmp_eq_u32 s56, 0
    s_cbranch_scc0 k2_kernel_d_tw_56
    s_waitcnt vmcnt(0)
k2_kernel_d_tw_56:
    s_waitcnt vmcnt(8)
    s_barrier
    v_add_u32 v6, 0, v4
    v_add_u32 v7, 0, v5
    ds_read_b64_tr_b16 v[160:161], v6 offset:0
    ds_read_b64_tr_b16 v[162:163], v6 offset:512
    s_cmp_eq_u32 s56, 0
    s_cbranch_scc1 k2_kernel_d_sk_57
    buffer_load_dwordx4 v[128:131], v11, s[20:23], s45 offen offset:0
k2_kernel_d_sk_57:
    v_mfma_f32_32x32x16_bf16 v[32:47], v[164:167], v[156:159], v[32:47]
    ds_read_b64_tr_b16 v[164:165], v7 offset:0
    ds_read_b64_tr_b16 v[166:167], v7 offset:512
    s_waitcnt lgkmcnt(8)
    v_mfma_f32_32x32x16_bf16 v[48:63], v[168:171], v[156:159], v[48:63]
    ds_read_b64_tr_b16 v[168:169], v6 offset:4096
    ds_read_b64_tr_b16 v[170:171], v6 offset:4608
    s_cmp_eq_u32 s56, 0
    s_cbranch_scc1 k2_kernel_d_sk_58
    buffer_load_dwordx4 v[132:135], v11, s[20:23], s45 offen offset:1024
    s_add_u32 s44, s44, 36864
    s_add_u32 s45, s45, 2048
k2_kernel_d_sk_58:
    v_mfma_f32_32x32x16_bf16 v[64:79], v[172:175], v[156:159], v[64:79]
    ds_read_b64_tr_b16 v[172:173], v7 offset:4096
    ds_read_b64_tr_b16 v[174:175], v7 offset:4608
    s_waitcnt lgkmcnt(8)
    v_mfma_f32_32x32x16_bf16 v[80:95], v[176:179], v[156:159], v[80:95]
    ds_read_b64_tr_b16 v[176:177], v6 offset:8192
    ds_read_b64_tr_b16 v[178:179], v6 offset:8704
    v_mfma_f32_32x32x16_bf16 v[96:111], v[180:183], v[156:159], v[96:111]
    ds_read_b64_tr_b16 v[180:181], v7 offset:8192
    ds_read_b64_tr_b16 v[182:183], v7 offset:8704
    s_add_u32 s43, s43, 6
    s_cmp_lt_u32 s43, s55
    s_cbranch_scc1 k2_kernel_d_loop
k2_kernel_d_fin:
    s_waitcnt lgkmcnt(0)
    s_nop 7
    s_nop 7
    v_cvt_pk_bf16_f32 v16, v16, v17
    v_cvt_pk_bf16_f32 v17, v18, v19
    v_cvt_pk_bf16_f32 v18, v20, v21
    v_cvt_pk_bf16_f32 v19, v22, v23
    v_cvt_pk_bf16_f32 v20, v24, v25
    v_cvt_pk_bf16_f32 v21, v26, v27
    v_cvt_pk_bf16_f32 v22, v28, v29
    v_cvt_pk_bf16_f32 v23, v30, v31
    buffer_store_dwordx4 v[16:19], v11, s[24:27], s52 offen sc1
    buffer_store_dwordx4 v[20:23], v11, s[24:27], s52 offen offset:1024 sc1
    s_add_u32 s52, s52, 2048
    v_cvt_pk_bf16_f32 v32, v32, v33
    v_cvt_pk_bf16_f32 v33, v34, v35
    v_cvt_pk_bf16_f32 v34, v36, v37
    v_cvt_pk_bf16_f32 v35, v38, v39
    v_cvt_pk_bf16_f32 v36, v40, v41
    v_cvt_pk_bf16_f32 v37, v42, v43
    v_cvt_pk_bf16_f32 v38, v44, v45
    v_cvt_pk_bf16_f32 v39, v46, v47
    buffer_store_dwordx4 v[32:35], v11, s[24:27], s52 offen sc1
    buffer_store_dwordx4 v[36:39], v11, s[24:27], s52 offen offset:1024 sc1
    s_add_u32 s52, s52, 2048
    v_cvt_pk_bf16_f32 v48, v48, v49
    v_cvt_pk_bf16_f32 v49, v50, v51
    v_cvt_pk_bf16_f32 v50, v52, v53
    v_cvt_pk_bf16_f32 v51, v54, v55
    v_cvt_pk_bf16_f32 v52, v56, v57
    v_cvt_pk_bf16_f32 v53, v58, v59
    v_cvt_pk_bf16_f32 v54, v60, v61
    v_cvt_pk_bf16_f32 v55, v62, v63
    buffer_store_dwordx4 v[48:51], v11, s[24:27], s52 offen sc1
    buffer_store_dwordx4 v[52:55], v11, s[24:27], s52 offen offset:1024 sc1
    s_add_u32 s52, s52, 2048
    v_cvt_pk_bf16_f32 v64, v64, v65
    v_cvt_pk_bf16_f32 v65, v66, v67
    v_cvt_pk_bf16_f32 v66, v68, v69
    v_cvt_pk_bf16_f32 v67, v70, v71
    v_cvt_pk_bf16_f32 v68, v72, v73
    v_cvt_pk_bf16_f32 v69, v74, v75
    v_cvt_pk_bf16_f32 v70, v76, v77
    v_cvt_pk_bf16_f32 v71, v78, v79
    buffer_store_dwordx4 v[64:67], v11, s[24:27], s52 offen sc1
    buffer_store_dwordx4 v[68:71], v11, s[24:27], s52 offen offset:1024 sc1
    s_add_u32 s52, s52, 2048
    v_cvt_pk_bf16_f32 v80, v80, v81
    v_cvt_pk_bf16_f32 v81, v82, v83
    v_cvt_pk_bf16_f32 v82, v84, v85
    v_cvt_pk_bf16_f32 v83, v86, v87
    v_cvt_pk_bf16_f32 v84, v88, v89
    v_cvt_pk_bf16_f32 v85, v90, v91
    v_cvt_pk_bf16_f32 v86, v92, v93
    v_cvt_pk_bf16_f32 v87, v94, v95
    buffer_store_dwordx4 v[80:83], v11, s[24:27], s52 offen sc1
    buffer_store_dwordx4 v[84:87], v11, s[24:27], s52 offen offset:1024 sc1
    s_add_u32 s52, s52, 2048
    v_cvt_pk_bf16_f32 v96, v96, v97
    v_cvt_pk_bf16_f32 v97, v98, v99
    v_cvt_pk_bf16_f32 v98, v100, v101
    v_cvt_pk_bf16_f32 v99, v102, v103
    v_cvt_pk_bf16_f32 v100, v104, v105
    v_cvt_pk_bf16_f32 v101, v106, v107
    v_cvt_pk_bf16_f32 v102, v108, v109
    v_cvt_pk_bf16_f32 v103, v110, v111
    buffer_store_dwordx4 v[96:99], v11, s[24:27], s52 offen sc1
    buffer_store_dwordx4 v[100:103], v11, s[24:27], s52 offen offset:1024 sc1
    s_add_u32 s52, s52, 2048
    s_lshl_b32 s59, s14, 2
    s_add_u32 s59, s59, s3
    s_mul_i32 s59, s59, 3
    s_add_u32 s59, s59, s15
    s_lshl_b32 s59, s59, 3
    s_add_u32 s59, s59, s40
    s_lshl_b32 s59, s59, 2
    s_add_u32 s59, s59, 4096
    s_add_u32 s36, s12, 0x3400000
    s_addc_u32 s37, s13, 0
    s_mov_b32 s38, 0x3000
    s_mov_b32 s39, 0x20000
    v_mov_b32 v4, 1
    v_and_b32 v5, 63, v0
    v_cmp_eq_u32 vcc, 0, v5
    v_mov_b32 v5, 0x7fffffff
    s_nop 0
    v_cndmask_b32 v5, v5, 0, vcc
    s_waitcnt vmcnt(0)
    buffer_store_dword v4, v5, s[36:39], s59 offen sc1
    s_barrier
k2_kernel_final:
    s_mov_b32 s45, s58
    s_mov_b64 s[4:5], s[76:77]
    s_mov_b64 s[6:7], s[78:79]
    s_mov_b64 s[8:9], s[80:81]
    s_mov_b64 s[10:11], s[82:83]
    s_and_b32 s40, s45, 7
    s_lshr_b32 s41, s45, 3
    s_and_b32 s14, s41, 3
    s_lshl_b32 s40, s40, 2
    s_add_u32 s14, s14, s40
    s_lshr_b32 s43, s41, 2
    s_lshl_b32 s14, s14, 1
    s_lshr_b32 s40, s3, 1
    s_add_u32 s14, s14, s40
    s_and_b32 s44, s3, 1
    s_lshl_b32 s15, s43, 1
    s_add_u32 s15, s15, s44
    v_and_b32 v1, 63, v0
    s_waitcnt lgkmcnt(0)
    s_mov_b32 s16, s6
    s_mov_b32 s17, s7
    s_mov_b32 s18, 0xa2000
    s_mov_b32 s19, 0x20000
    s_add_u32 s20, s10, 0x900000
    s_addc_u32 s21, s11, 0
    s_mov_b32 s22, 0x300000
    s_mov_b32 s23, 0x20000
    s_add_u32 s24, s10, 0x2400000
    s_addc_u32 s25, s11, 0
    s_mov_b32 s26, 0xb40000
    s_mov_b32 s27, 0x20000
    s_mov_b32 s28, s4
    s_mov_b32 s29, s5
    s_mov_b32 s30, 0x240000
    s_mov_b32 s31, 0x20000
    s_mov_b32 s32, s8
    s_mov_b32 s33, s9
    s_mov_b32 s34, 0x240000
    s_mov_b32 s35, 0x20000
    s_add_u32 s36, s10, 0x3400000
    s_addc_u32 s37, s11, 0
    s_mov_b32 s38, 0x3000
    s_mov_b32 s39, 0x20000
    v_lshlrev_b32 v9, 4, v1
    s_movk_i32 s40, 1152
    v_lshrrev_b32 v4, 3, v1
    v_mul_lo_u32 v8, v4, s40
    v_bfe_u32 v4, v1, 4, 1
    v_lshlrev_b32 v4, 2, v4
    v_and_b32 v5, 7, v1
    v_xor_b32 v4, v4, v5
    v_lshl_add_u32 v8, v4, 4, v8
    s_mul_i32 s42, s3, 165888
    s_lshl_b32 s40, s43, 7
    s_add_u32 s42, s42, s40
    s_mul_i32 s40, s3, 18432
    s_mov_b32 m0, s40
    s_nop 0
    buffer_load_dwordx4 v8, s[16:19], s42 offen lds
    s_add_u32 s42, s42, 9216
    s_add_u32 m0, m0, 1024
    s_nop 0
    buffer_load_dwordx4 v8, s[16:19], s42 offen lds
    s_add_u32 s42, s42, 9216
    s_add_u32 m0, m0, 1024
    s_nop 0
    buffer_load_dwordx4 v8, s[16:19], s42 offen lds
    s_add_u32 s42, s42, 9216
    s_add_u32 m0, m0, 1024
    s_nop 0
    buffer_load_dwordx4 v8, s[16:19], s42 offen lds
    s_add_u32 s42, s42, 9216
    s_add_u32 m0, m0, 1024
    s_nop 0
    buffer_load_dwordx4 v8, s[16:19], s42 offen lds
    s_add_u32 s42, s42, 9216
    s_add_u32 m0, m0, 1024
    s_nop 0
    buffer_load_dwordx4 v8, s[16:19], s42 offen lds
    s_add_u32 s42, s42, 9216
    s_add_u32 m0, m0, 1024
    s_nop 0
    buffer_load_dwordx4 v8, s[16:19], s42 offen lds
    s_add_u32 s42, s42, 9216
    s_add_u32 m0, m0, 1024
    s_nop 0
    buffer_load_dwordx4 v8, s[16:19], s42 offen lds
    s_add_u32 s42, s42, 9216
    s_add_u32 m0, m0, 1024
    s_nop 0
    buffer_load_dwordx4 v8, s[16:19], s42 offen lds
    s_add_u32 s42, s42, 9216
    s_add_u32 m0, m0, 1024
    s_nop 0
    buffer_load_dwordx4 v8, s[16:19], s42 offen lds
    s_add_u32 s42, s42, 9216
    s_add_u32 m0, m0, 1024
    s_nop 0
    buffer_load_dwordx4 v8, s[16:19], s42 offen lds
    s_add_u32 s42, s42, 9216
    s_add_u32 m0, m0, 1024
    s_nop 0
    buffer_load_dwordx4 v8, s[16:19], s42 offen lds
    s_add_u32 s42, s42, 9216
    s_add_u32 m0, m0, 1024
    s_nop 0
    buffer_load_dwordx4 v8, s[16:19], s42 offen lds
    s_add_u32 s42, s42, 9216
    s_add_u32 m0, m0, 1024
    s_nop 0
    buffer_load_dwordx4 v8, s[16:19], s42 offen lds
    s_add_u32 s42, s42, 9216
    s_add_u32 m0, m0, 1024
    s_nop 0
    buffer_load_dwordx4 v8, s[16:19], s42 offen lds
    s_add_u32 s42, s42, 9216
    s_add_u32 m0, m0, 1024
    s_nop 0
    buffer_load_dwordx4 v8, s[16:19], s42 offen lds
    s_add_u32 s42, s42, 9216
    s_add_u32 m0, m0, 1024
    s_nop 0
    buffer_load_dwordx4 v8, s[16:19], s42 offen lds
    s_add_u32 s42, s42, 9216
    s_add_u32 m0, m0, 1024
    s_nop 0
    buffer_load_dwordx4 v8, s[16:19], s42 offen lds
    v_mov_b32 v216, 0
    v_mov_b32 v217, 0
    v_mov_b32 v218, 0
    v_mov_b32 v219, 0
    v_add_u32 v4, 73728, v9
    ds_write_b128 v4, v[216:219]
    v_and_b32 v2, 31, v1
    v_lshrrev_b32 v3, 5, v1
    v_and_b32 v4, 0x13, v2
    v_and_b32 v5, 4, v2
    v_lshl_or_b32 v4, v5, 1, v4
    v_and_b32 v5, 8, v2
    v_lshrrev_b32 v5, 1, v5
    v_or_b32 v4, v4, v5
    s_lshl_b32 s40, s14, 5
    v_add_u32 v4, s40, v4
    s_movk_i32 s40, 1152
    v_mul_lo_u32 v10, v4, s40
    v_lshl_add_u32 v10, v3, 4, v10
    s_lshl_b32 s40, s15, 6
    v_add_u32 v10, s40, v10
    buffer_load_dwordx4 v[208:211], v10, s[28:31], 0 offen
    buffer_load_dwordx4 v[212:215], v10, s[28:31], 0 offen offset:32
    v_bfe_u32 v6, v1, 4, 1
    v_lshlrev_b32 v6, 5, v6
    v_and_b32 v4, 1, v1
    v_lshl_add_u32 v6, v4, 4, v6
    v_bfe_u32 v4, v1, 1, 1
    v_lshl_add_u32 v6, v4, 3, v6
    s_mul_i32 s40, s44, 36864
    v_add_u32 v6, s40, v6
    v_mul_u32_u24 v4, 8, v3
    v_bfe_u32 v5, v1, 2, 2
    v_add3_u32 v4, v4, v5, 0
    v_bfe_u32 v5, v4, 1, 1
    v_lshl_add_u32 v5, v5, 6, v6
    v_lshl_add_u32 v232, v4, 7, v5
    v_xor_b32 v233, 64, v232
    v_mul_u32_u24 v4, 2, v3
    v_bfe_u32 v5, v1, 2, 2
    v_add3_u32 v4, v4, v5, 16
    v_bfe_u32 v5, v4, 1, 1
    v_lshl_add_u32 v5, v5, 6, v6
    v_lshl_add_u32 v234, v4, 7, v5
    v_xor_b32 v235, 64, v234
    v_mul_u32_u24 v4, 8, v3
    v_bfe_u32 v5, v1, 2, 2
    v_add3_u32 v4, v4, v5, 26
    v_bfe_u32 v5, v4, 1, 1
    v_lshl_add_u32 v5, v5, 6, v6
    v_lshl_add_u32 v236, v4, 7, v5
    v_xor_b32 v237, 64, v236
    s_cmp_eq_u32 s3, 0
    s_cbranch_scc0 k2_kernel_f_polled_60
    s_and_b32 s40, s14, -2
    s_mul_i32 s40, s40, 3
    s_mul_i32 s41, s43, 43
    s_lshr_b32 s41, s41, 7
    s_add_u32 s40, s40, s41
    s_lshl_b32 s40, s40, 5
    s_add_u32 s40, s40, 4096
    v_and_b32 v11, 7, v1
    v_lshrrev_b32 v4, 3, v1
    v_mul_u32_u24 v4, 24, v4
    v_add_u32 v11, v11, v4
    v_lshl_add_u32 v11, v11, 2, s40
    s_mov_b32 s46, 0x1f1f
    s_mov_b32 s47, 0x0
    v_mov_b32 v5, 0x7fffffff
    v_cndmask_b32 v11, v5, v11, s[46:47]
k2_kernel_f_poll_59:
    buffer_load_dword v4, v11, s[36:39], 0 offen sc1
    s_waitcnt vmcnt(0)
    v_cmp_ne_u32 vcc, 0, v4
    s_nop 3
    s_and_b64 vcc, vcc, s[46:47]
    s_cmp_eq_u64 vcc, s[46:47]
    s_cbranch_scc1 k2_kernel_f_polled_60
    s_sleep 2
    s_branch k2_kernel_f_poll_59
k2_kernel_f_polled_60:
    s_barrier
    s_mul_i32 s40, s14, 18
    s_add_u32 s40, s40, s15
    s_lshl_b32 s42, s40, 11
    buffer_load_dwordx4 v[168:171], v9, s[24:27], s42 offen offset:0 sc1
    buffer_load_dwordx4 v[172:175], v9, s[24:27], s42 offen offset:1024 sc1
    s_add_u32 s42, s42, 2359296
    buffer_load_dwordx4 v[176:179], v9, s[24:27], s42 offen offset:0 sc1
    buffer_load_dwordx4 v[180:183], v9, s[24:27], s42 offen offset:1024 sc1
    s_add_u32 s42, s42, 2359296
    buffer_load_dwordx4 v[184:187], v9, s[24:27], s42 offen offset:0 sc1
    buffer_load_dwordx4 v[188:191], v9, s[24:27], s42 offen offset:1024 sc1
    s_add_u32 s42, s42, 2359296
    buffer_load_dwordx4 v[192:195], v9, s[24:27], s42 offen offset:0 sc1
    buffer_load_dwordx4 v[196:199], v9, s[24:27], s42 offen offset:1024 sc1
    s_add_u32 s42, s42, 2359296
    buffer_load_dwordx4 v[200:203], v9, s[24:27], s42 offen offset:0 sc1
    buffer_load_dwordx4 v[204:207], v9, s[24:27], s42 offen offset:1024 sc1
    s_mov_b32 s50, 0x3ef5fdf0
    s_mov_b32 s51, 0xbfb8aa3b
    s_waitcnt vmcnt(0) lgkmcnt(0)
    v_lshlrev_b32 v216, 16, v168
    v_and_b32 v217, 0xffff0000, v168
    v_lshlrev_b32 v218, 16, v169
    v_and_b32 v219, 0xffff0000, v169
    v_lshlrev_b32 v220, 16, v170
    v_and_b32 v221, 0xffff0000, v170
    v_lshlrev_b32 v222, 16, v171
    v_and_b32 v223, 0xffff0000, v171
    v_lshlrev_b32 v224, 16, v172
    v_and_b32 v225, 0xffff0000, v172
    v_lshlrev_b32 v226, 16, v173
    v_and_b32 v227, 0xffff0000, v173
    v_lshlrev_b32 v228, 16, v174
    v_and_b32 v229, 0xffff0000, v174
    v_lshlrev_b32 v230, 16, v175
    v_and_b32 v231, 0xffff0000, v175
    v_lshlrev_b32 v238, 16, v176
    v_and_b32 v239, 0xffff0000, v176
    v_add_f32 v216, v216, v238
    v_add_f32 v217, v217, v239
    v_lshlrev_b32 v238, 16, v177
    v_and_b32 v239, 0xffff0000, v177
    v_add_f32 v218, v218, v238
    v_add_f32 v219, v219, v239
    v_lshlrev_b32 v238, 16, v178
    v_and_b32 v239, 0xffff0000, v178
    v_add_f32 v220, v220, v238
    v_add_f32 v221, v221, v239
    v_lshlrev_b32 v238, 16, v179
    v_and_b32 v239, 0xffff0000, v179
    v_add_f32 v222, v222, v238
    v_add_f32 v223, v223, v239
    v_lshlrev_b32 v238, 16, v180
    v_and_b32 v239, 0xffff0000, v180
    v_add_f32 v224, v224, v238
    v_add_f32 v225, v225, v239
    v_lshlrev_b32 v238, 16, v181
    v_and_b32 v239, 0xffff0000, v181
    v_add_f32 v226, v226, v238
    v_add_f32 v227, v227, v239
    v_lshlrev_b32 v238, 16, v182
    v_and_b32 v239, 0xffff0000, v182
    v_add_f32 v228, v228, v238
    v_add_f32 v229, v229, v239
    v_lshlrev_b32 v238, 16, v183
    v_and_b32 v239, 0xffff0000, v183
    v_add_f32 v230, v230, v238
    v_add_f32 v231, v231, v239
    v_lshlrev_b32 v238, 16, v184
    v_and_b32 v239, 0xffff0000, v184
    v_add_f32 v216, v216, v238
    v_add_f32 v217, v217, v239
    v_lshlrev_b32 v238, 16, v185
    v_and_b32 v239, 0xffff0000, v185
    v_add_f32 v218, v218, v238
    v_add_f32 v219, v219, v239
    v_lshlrev_b32 v238, 16, v186
    v_and_b32 v239, 0xffff0000, v186
    v_add_f32 v220, v220, v238
    v_add_f32 v221, v221, v239
    v_lshlrev_b32 v238, 16, v187
    v_and_b32 v239, 0xffff0000, v187
    v_add_f32 v222, v222, v238
    v_add_f32 v223, v223, v239
    v_lshlrev_b32 v238, 16, v188
    v_and_b32 v239, 0xffff0000, v188
    v_add_f32 v224, v224, v238
    v_add_f32 v225, v225, v239
    v_lshlrev_b32 v238, 16, v189
    v_and_b32 v239, 0xffff0000, v189
    v_add_f32 v226, v226, v238
    v_add_f32 v227, v227, v239
    v_lshlrev_b32 v238, 16, v190
    v_and_b32 v239, 0xffff0000, v190
    v_add_f32 v228, v228, v238
    v_add_f32 v229, v229, v239
    v_lshlrev_b32 v238, 16, v191
    v_and_b32 v239, 0xffff0000, v191
    v_add_f32 v230, v230, v238
    v_add_f32 v231, v231, v239
    v_lshlrev_b32 v238, 16, v192
    v_and_b32 v239, 0xffff0000, v192
    v_add_f32 v216, v216, v238
    v_add_f32 v217, v217, v239
    v_lshlrev_b32 v238, 16, v193
    v_and_b32 v239, 0xffff0000, v193
    v_add_f32 v218, v218, v238
    v_add_f32 v219, v219, v239
    v_lshlrev_b32 v238, 16, v194
    v_and_b32 v239, 0xffff0000, v194
    v_add_f32 v220, v220, v238
    v_add_f32 v221, v221, v239
    v_lshlrev_b32 v238, 16, v195
    v_and_b32 v239, 0xffff0000, v195
    v_add_f32 v222, v222, v238
    v_add_f32 v223, v223, v239
    v_lshlrev_b32 v238, 16, v196
    v_and_b32 v239, 0xffff0000, v196
    v_add_f32 v224, v224, v238
    v_add_f32 v225, v225, v239
    v_lshlrev_b32 v238, 16, v197
    v_and_b32 v239, 0xffff0000, v197
    v_add_f32 v226, v226, v238
    v_add_f32 v227, v227, v239
    v_lshlrev_b32 v238, 16, v198
    v_and_b32 v239, 0xffff0000, v198
    v_add_f32 v228, v228, v238
    v_add_f32 v229, v229, v239
    v_lshlrev_b32 v238, 16, v199
    v_and_b32 v239, 0xffff0000, v199
    v_add_f32 v230, v230, v238
    v_add_f32 v231, v231, v239
    v_lshlrev_b32 v238, 16, v200
    v_and_b32 v239, 0xffff0000, v200
    v_add_f32 v216, v216, v238
    v_add_f32 v217, v217, v239
    v_lshlrev_b32 v238, 16, v201
    v_and_b32 v239, 0xffff0000, v201
    v_add_f32 v218, v218, v238
    v_add_f32 v219, v219, v239
    v_lshlrev_b32 v238, 16, v202
    v_and_b32 v239, 0xffff0000, v202
    v_add_f32 v220, v220, v238
    v_add_f32 v221, v221, v239
    v_lshlrev_b32 v238, 16, v203
    v_and_b32 v239, 0xffff0000, v203
    v_add_f32 v222, v222, v238
    v_add_f32 v223, v223, v239
    v_lshlrev_b32 v238, 16, v204
    v_and_b32 v239, 0xffff0000, v204
    v_add_f32 v224, v224, v238
    v_add_f32 v225, v225, v239
    v_lshlrev_b32 v238, 16, v205
    v_and_b32 v239, 0xffff0000, v205
    v_add_f32 v226, v226, v238
    v_add_f32 v227, v227, v239
    v_lshlrev_b32 v238, 16, v206
    v_and_b32 v239, 0xffff0000, v206
    v_add_f32 v228, v228, v238
    v_add_f32 v229, v229, v239
    v_lshlrev_b32 v238, 16, v207
    v_and_b32 v239, 0xffff0000, v207
    v_add_f32 v230, v230, v238
    v_add_f32 v231, v231, v239
    v_mul_f32 v216, s50, v216
    v_mul_f32 v168, s51, v216
    v_mul_f32 v217, s50, v217
    v_mul_f32 v169, s51, v217
    v_mul_f32 v218, s50, v218
    v_mul_f32 v170, s51, v218
    v_mul_f32 v219, s50, v219
    v_mul_f32 v171, s51, v219
    v_mul_f32 v220, s50, v220
    v_mul_f32 v172, s51, v220
    v_mul_f32 v221, s50, v221
    v_mul_f32 v173, s51, v221
    v_mul_f32 v222, s50, v222
    v_mul_f32 v174, s51, v222
    v_mul_f32 v223, s50, v223
    v_mul_f32 v175, s51, v223
    v_mul_f32 v224, s50, v224
    v_mul_f32 v176, s51, v224
    v_mul_f32 v225, s50, v225
    v_mul_f32 v177, s51, v225
    v_mul_f32 v226, s50, v226
    v_mul_f32 v178, s51, v226
    v_mul_f32 v227, s50, v227
    v_mul_f32 v179, s51, v227
    v_mul_f32 v228, s50, v228
    v_mul_f32 v180, s51, v228
    v_mul_f32 v229, s50, v229
    v_mul_f32 v181, s51, v229
    v_mul_f32 v230, s50, v230
    v_mul_f32 v182, s51, v230
    v_mul_f32 v231, s50, v231
    v_mul_f32 v183, s51, v231
    v_exp_f32 v168, v168
    v_exp_f32 v169, v169
    v_exp_f32 v170, v170
    v_exp_f32 v171, v171
    v_exp_f32 v172, v172
    v_exp_f32 v173, v173
    v_exp_f32 v174, v174
    v_exp_f32 v175, v175
    v_exp_f32 v176, v176
    v_exp_f32 v177, v177
    v_exp_f32 v178, v178
    v_exp_f32 v179, v179
    v_exp_f32 v180, v180
    v_exp_f32 v181, v181
    v_exp_f32 v182, v182
    v_exp_f32 v183, v183
    v_add_f32 v168, 1.0, v168
    v_add_f32 v169, 1.0, v169
    v_add_f32 v170, 1.0, v170
    v_add_f32 v171, 1.0, v171
    v_add_f32 v172, 1.0, v172
    v_add_f32 v173, 1.0, v173
    v_add_f32 v174, 1.0, v174
    v_add_f32 v175, 1.0, v175
    v_add_f32 v176, 1.0, v176
    v_add_f32 v177, 1.0, v177
    v_add_f32 v178, 1.0, v178
    v_add_f32 v179, 1.0, v179
    v_add_f32 v180, 1.0, v180
    v_add_f32 v181, 1.0, v181
    v_add_f32 v182, 1.0, v182
    v_add_f32 v183, 1.0, v183
    v_rcp_f32 v168, v168
    v_rcp_f32 v169, v169
    v_rcp_f32 v170, v170
    v_rcp_f32 v171, v171
    v_rcp_f32 v172, v172
    v_rcp_f32 v173, v173
    v_rcp_f32 v174, v174
    v_rcp_f32 v175, v175
    v_rcp_f32 v176, v176
    v_rcp_f32 v177, v177
    v_rcp_f32 v178, v178
    v_rcp_f32 v179, v179
    v_rcp_f32 v180, v180
    v_rcp_f32 v181, v181
    v_rcp_f32 v182, v182
    v_rcp_f32 v183, v183
    v_lshlrev_b32 v184, 16, v208
    v_and_b32 v185, 0xffff0000, v208
    v_lshlrev_b32 v186, 16, v209
    v_and_b32 v187, 0xffff0000, v209
    v_lshlrev_b32 v188, 16, v210
    v_and_b32 v189, 0xffff0000, v210
    v_lshlrev_b32 v190, 16, v211
    v_and_b32 v191, 0xffff0000, v211
    v_lshlrev_b32 v192, 16, v212
    v_and_b32 v193, 0xffff0000, v212
    v_lshlrev_b32 v194, 16, v213
    v_and_b32 v195, 0xffff0000, v213
    v_lshlrev_b32 v196, 16, v214
    v_and_b32 v197, 0xffff0000, v214
    v_lshlrev_b32 v198, 16, v215
    v_and_b32 v199, 0xffff0000, v215
    v_mul_f32 v216, v216, v168
    v_mul_f32 v217, v217, v169
    v_mul_f32 v218, v218, v170
    v_mul_f32 v219, v219, v171
    v_mul_f32 v220, v220, v172
    v_mul_f32 v221, v221, v173
    v_mul_f32 v222, v222, v174
    v_mul_f32 v223, v223, v175
    v_mul_f32 v224, v224, v176
    v_mul_f32 v225, v225, v177
    v_mul_f32 v226, v226, v178
    v_mul_f32 v227, v227, v179
    v_mul_f32 v228, v228, v180
    v_mul_f32 v229, v229, v181
    v_mul_f32 v230, v230, v182
    v_mul_f32 v231, v231, v183
    s_cmp_eq_u32 s3, 0
    s_cbranch_scc0 k2_kernel_f_polled_62
    s_lshr_b32 s40, s14, 1
    s_lshl_b32 s40, s40, 7
    v_lshl_add_u32 v11, v1, 2, s40
    s_mov_b32 s46, 0xffffffff
    s_mov_b32 s47, 0x0
    v_mov_b32 v5, 0x7fffffff
    v_cndmask_b32 v11, v5, v11, s[46:47]
k2_kernel_f_poll_61:
    buffer_load_dword v4, v11, s[36:39], 0 offen sc1
    s_waitcnt vmcnt(0)
    v_cmp_ne_u32 vcc, 0, v4
    s_nop 3
    s_and_b64 vcc, vcc, s[46:47]
    s_cmp_eq_u64 vcc, s[46:47]
    s_cbranch_scc1 k2_kernel_f_polled_62
    s_sleep 2
    s_branch k2_kernel_f_poll_61
k2_kernel_f_polled_62:
    s_barrier
    s_mul_i32 s41, s14, 49152
    s_mul_i32 s40, s44, 24576
    s_add_u32 s41, s41, s40
    buffer_load_dwordx4 v[16:19], v9, s[20:23], s41 offen offset:0 sc1
    buffer_load_dwordx4 v[20:23], v9, s[20:23], s41 offen offset:1024 sc1
    buffer_load_dwordx4 v[24:27], v9, s[20:23], s41 offen offset:2048 sc1
    buffer_load_dwordx4 v[28:31], v9, s[20:23], s41 offen offset:3072 sc1
    s_add_u32 s41, s41, 4096
    buffer_load_dwordx4 v[32:35], v9, s[20:23], s41 offen offset:0 sc1
    buffer_load_dwordx4 v[36:39], v9, s[20:23], s41 offen offset:1024 sc1
    buffer_load_dwordx4 v[40:43], v9, s[20:23], s41 offen offset:2048 sc1
    buffer_load_dwordx4 v[44:47], v9, s[20:23], s41 offen offset:3072 sc1
    ds_read_b64_tr_b16 v[144:145], v232 offset:0
    ds_read_b64_tr_b16 v[146:147], v232 offset:512
    ds_read_b64_tr_b16 v[148:149], v233 offset:0
    ds_read_b64_tr_b16 v[150:151], v233 offset:512
    ds_read_b64_tr_b16 v[152:153], v234 offset:0
    ds_read_b64_tr_b16 v[154:155], v234 offset:512
    ds_read_b64_tr_b16 v[156:157], v235 offset:0
    ds_read_b64_tr_b16 v[158:159], v235 offset:512
    ds_read_b64_tr_b16 v[160:161], v236 offset:0
    ds_read_b64_tr_b16 v[162:163], v236 offset:512
    ds_read_b64_tr_b16 v[164:165], v237 offset:0
    ds_read_b64_tr_b16 v[166:167], v237 offset:512
    s_waitcnt vmcnt(7)
    s_waitcnt lgkmcnt(8)
    v_mfma_f32_32x32x16_bf16 v[112:127], v[144:147], v[16:19], 0
    ds_read_b64_tr_b16 v[144:145], v232 offset:4608
    ds_read_b64_tr_b16 v[146:147], v232 offset:5120
    s_add_u32 s41, s41, 4096
    buffer_load_dwordx4 v[48:51], v9, s[20:23], s41 offen offset:0 sc1
    v_mfma_f32_32x32x16_bf16 v[128:143], v[148:151], v[16:19], 0
    ds_read_b64_tr_b16 v[148:149], v233 offset:4608
    ds_read_b64_tr_b16 v[150:151], v233 offset:5120
    s_waitcnt vmcnt(7)
    s_waitcnt lgkmcnt(8)
    v_mfma_f32_32x32x16_bf16 v[112:127], v[152:155], v[20:23], v[112:127]
    ds_read_b64_tr_b16 v[152:153], v234 offset:4608
    ds_read_b64_tr_b16 v[154:155], v234 offset:5120
    buffer_load_dwordx4 v[52:55], v9, s[20:23], s41 offen offset:1024 sc1
    v_mfma_f32_32x32x16_bf16 v[128:143], v[156:159], v[20:23], v[128:143]
    ds_read_b64_tr_b16 v[156:157], v235 offset:4608
    ds_read_b64_tr_b16 v[158:159], v235 offset:5120
    s_waitcnt vmcnt(7)
    s_waitcnt lgkmcnt(8)
    v_mfma_f32_32x32x16_bf16 v[112:127], v[160:163], v[24:27], v[112:127]
    ds_read_b64_tr_b16 v[160:161], v236 offset:4608
    ds_read_b64_tr_b16 v[162:163], v236 offset:5120
    buffer_load_dwordx4 v[56:59], v9, s[20:23], s41 offen offset:2048 sc1
    v_mfma_f32_32x32x16_bf16 v[128:143], v[164:167], v[24:27], v[128:143]
    ds_read_b64_tr_b16 v[164:165], v237 offset:4608
    ds_read_b64_tr_b16 v[166:167], v237 offset:5120
    s_waitcnt vmcnt(7)
    s_waitcnt lgkmcnt(8)
    v_mfma_f32_32x32x16_bf16 v[112:127], v[144:147], v[28:31], v[112:127]
    ds_read_b64_tr_b16 v[144:145], v232 offset:9216
    ds_read_b64_tr_b16 v[146:147], v232 offset:9728
    buffer_load_dwordx4 v[60:63], v9, s[20:23], s41 offen offset:3072 sc1
    v_mfma_f32_32x32x16_bf16 v[128:143], v[148:151], v[28:31], v[128:143]
    ds_read_b64_tr_b16 v[148:149], v233 offset:9216
    ds_read_b64_tr_b16 v[150:151], v233 offset:9728
    s_waitcnt vmcnt(7)
    s_waitcnt lgkmcnt(8)
    v_mfma_f32_32x32x16_bf16 v[112:127], v[152:155], v[32:35], v[112:127]
    ds_read_b64_tr_b16 v[152:153], v234 offset:9216
    ds_read_b64_tr_b16 v[154:155], v234 offset:9728
    s_add_u32 s41, s41, 4096
    buffer_load_dwordx4 v[64:67], v9, s[20:23], s41 offen offset:0 sc1
    v_mfma_f32_32x32x16_bf16 v[128:143], v[156:159], v[32:35], v[128:143]
    ds_read_b64_tr_b16 v[156:157], v235 offset:9216
    ds_read_b64_tr_b16 v[158:159], v235 offset:9728
    s_waitcnt vmcnt(7)
    s_waitcnt lgkmcnt(8)
    v_mfma_f32_32x32x16_bf16 v[112:127], v[160:163], v[36:39], v[112:127]
    ds_read_b64_tr_b16 v[160:161], v236 offset:9216
    ds_read_b64_tr_b16 v[162:163], v236 offset:9728
    buffer_load_dwordx4 v[68:71], v9, s[20:23], s41 offen offset:1024 sc1
    v_mfma_f32_32x32x16_bf16 v[128:143], v[164:167], v[36:39], v[128:143]
    ds_read_b64_tr_b16 v[164:165], v237 offset:9216
    ds_read_b64_tr_b16 v[166:167], v237 offset:9728
    s_waitcnt vmcnt(7)
    s_waitcnt lgkmcnt(8)
    v_mfma_f32_32x32x16_bf16 v[112:127], v[144:147], v[40:43], v[112:127]
    ds_read_b64_tr_b16 v[144:145], v232 offset:13824
    ds_read_b64_tr_b16 v[146:147], v232 offset:14336
    buffer_load_dwordx4 v[72:75], v9, s[20:23], s41 offen offset:2048 sc1
    v_mfma_f32_32x32x16_bf16 v[128:143], v[148:151], v[40:43], v[128:143]
    ds_read_b64_tr_b16 v[148:149], v233 offset:13824
    ds_read_b64_tr_b16 v[150:151], v233 offset:14336
    s_waitcnt vmcnt(7)
    s_waitcnt lgkmcnt(8)
    v_mfma_f32_32x32x16_bf16 v[112:127], v[152:155], v[44:47], v[112:127]
    ds_read_b64_tr_b16 v[152:153], v234 offset:13824
    ds_read_b64_tr_b16 v[154:155], v234 offset:14336
    buffer_load_dwordx4 v[76:79], v9, s[20:23], s41 offen offset:3072 sc1
    v_mfma_f32_32x32x16_bf16 v[128:143], v[156:159], v[44:47], v[128:143]
    ds_read_b64_tr_b16 v[156:157], v235 offset:13824
    ds_read_b64_tr_b16 v[158:159], v235 offset:14336
    s_waitcnt vmcnt(7)
    s_waitcnt lgkmcnt(8)
    v_mfma_f32_32x32x16_bf16 v[112:127], v[160:163], v[48:51], v[112:127]
    ds_read_b64_tr_b16 v[160:161], v236 offset:13824
    ds_read_b64_tr_b16 v[162:163], v236 offset:14336
    s_add_u32 s41, s41, 4096
    buffer_load_dwordx4 v[80:83], v9, s[20:23], s41 offen offset:0 sc1
    v_mfma_f32_32x32x16_bf16 v[128:143], v[164:167], v[48:51], v[128:143]
    ds_read_b64_tr_b16 v[164:165], v237 offset:13824
    ds_read_b64_tr_b16 v[166:167], v237 offset:14336
    s_waitcnt vmcnt(7)
    s_waitcnt lgkmcnt(8)
    v_mfma_f32_32x32x16_bf16 v[112:127], v[144:147], v[52:55], v[112:127]
    ds_read_b64_tr_b16 v[144:145], v232 offset:18432
    ds_read_b64_tr_b16 v[146:147], v232 offset:18944
    buffer_load_dwordx4 v[84:87], v9, s[20:23], s41 offen offset:1024 sc1
    v_mfma_f32_32x32x16_bf16 v[128:143], v[148:151], v[52:55], v[128:143]
    ds_read_b64_tr_b16 v[148:149], v233 offset:18432
    ds_read_b64_tr_b16 v[150:151], v233 offset:18944
    s_waitcnt vmcnt(7)
    s_waitcnt lgkmcnt(8)
    v_mfma_f32_32x32x16_bf16 v[112:127], v[152:155], v[56:59], v[112:127]
    ds_read_b64_tr_b16 v[152:153], v234 offset:18432
    ds_read_b64_tr_b16 v[154:155], v234 offset:18944
    buffer_load_dwordx4 v[88:91], v9, s[20:23], s41 offen offset:2048 sc1
    v_mfma_f32_32x32x16_bf16 v[128:143], v[156:159], v[56:59], v[128:143]
    ds_read_b64_tr_b16 v[156:157], v235 offset:18432
    ds_read_b64_tr_b16 v[158:159], v235 offset:18944
    s_waitcnt vmcnt(7)
    s_waitcnt lgkmcnt(8)
    v_mfma_f32_32x32x16_bf16 v[112:127], v[160:163], v[60:63], v[112:127]
    ds_read_b64_tr_b16 v[160:161], v236 offset:18432
    ds_read_b64_tr_b16 v[162:163], v236 offset:18944
    buffer_load_dwordx4 v[92:95], v9, s[20:23], s41 offen offset:3072 sc1
    v_mfma_f32_32x32x16_bf16 v[128:143], v[164:167], v[60:63], v[128:143]
    ds_read_b64_tr_b16 v[164:165], v237 offset:18432
    ds_read_b64_tr_b16 v[166:167], v237 offset:18944
    s_waitcnt vmcnt(7)
    s_waitcnt lgkmcnt(8)
    v_mfma_f32_32x32x16_bf16 v[112:127], v[144:147], v[64:67], v[112:127]
    ds_read_b64_tr_b16 v[144:145], v232 offset:23040
    ds_read_b64_tr_b16 v[146:147], v232 offset:23552
    s_add_u32 s41, s41, 4096
    buffer_load_dwordx4 v[96:99], v9, s[20:23], s41 offen offset:0 sc1
    v_mfma_f32_32x32x16_bf16 v[128:143], v[148:151], v[64:67], v[128:143]
    ds_read_b64_tr_b16 v[148:149], v233 offset:23040
    ds_read_b64_tr_b16 v[150:151], v233 offset:23552
    s_waitcnt vmcnt(7)
    s_waitcnt lgkmcnt(8)
    v_mfma_f32_32x32x16_bf16 v[112:127], v[152:155], v[68:71], v[112:127]
    ds_read_b64_tr_b16 v[152:153], v234 offset:23040
    ds_read_b64_tr_b16 v[154:155], v234 offset:23552
    buffer_load_dwordx4 v[100:103], v9, s[20:23], s41 offen offset:1024 sc1
    v_mfma_f32_32x32x16_bf16 v[128:143], v[156:159], v[68:71], v[128:143]
    ds_read_b64_tr_b16 v[156:157], v235 offset:23040
    ds_read_b64_tr_b16 v[158:159], v235 offset:23552
    s_waitcnt vmcnt(7)
    s_waitcnt lgkmcnt(8)
    v_mfma_f32_32x32x16_bf16 v[112:127], v[160:163], v[72:75], v[112:127]
    ds_read_b64_tr_b16 v[160:161], v236 offset:23040
    ds_read_b64_tr_b16 v[162:163], v236 offset:23552
    buffer_load_dwordx4 v[104:107], v9, s[20:23], s41 offen offset:2048 sc1
    v_mfma_f32_32x32x16_bf16 v[128:143], v[164:167], v[72:75], v[128:143]
    ds_read_b64_tr_b16 v[164:165], v237 offset:23040
    ds_read_b64_tr_b16 v[166:167], v237 offset:23552
    s_waitcnt vmcnt(7)
    s_waitcnt lgkmcnt(8)
    v_mfma_f32_32x32x16_bf16 v[112:127], v[144:147], v[76:79], v[112:127]
    ds_read_b64_tr_b16 v[144:145], v232 offset:27648
    ds_read_b64_tr_b16 v[146:147], v232 offset:28160
    buffer_load_dwordx4 v[108:111], v9, s[20:23], s41 offen offset:3072 sc1
    v_mfma_f32_32x32x16_bf16 v[128:143], v[148:151], v[76:79], v[128:143]
    ds_read_b64_tr_b16 v[148:149], v233 offset:27648
    ds_read_b64_tr_b16 v[150:151], v233 offset:28160
    s_waitcnt vmcnt(7)
    s_waitcnt lgkmcnt(8)
    v_mfma_f32_32x32x16_bf16 v[112:127], v[152:155], v[80:83], v[112:127]
    ds_read_b64_tr_b16 v[152:153], v234 offset:27648
    ds_read_b64_tr_b16 v[154:155], v234 offset:28160
    v_mfma_f32_32x32x16_bf16 v[128:143], v[156:159], v[80:83], v[128:143]
    ds_read_b64_tr_b16 v[156:157], v235 offset:27648
    ds_read_b64_tr_b16 v[158:159], v235 offset:28160
    s_waitcnt vmcnt(6)
    s_waitcnt lgkmcnt(8)
    v_mfma_f32_32x32x16_bf16 v[112:127], v[160:163], v[84:87], v[112:127]
    ds_read_b64_tr_b16 v[160:161], v236 offset:27648
    ds_read_b64_tr_b16 v[162:163], v236 offset:28160
    v_mfma_f32_32x32x16_bf16 v[128:143], v[164:167], v[84:87], v[128:143]
    ds_read_b64_tr_b16 v[164:165], v237 offset:27648
    ds_read_b64_tr_b16 v[166:167], v237 offset:28160
    s_waitcnt vmcnt(5)
    s_waitcnt lgkmcnt(8)
    v_mfma_f32_32x32x16_bf16 v[112:127], v[144:147], v[88:91], v[112:127]
    ds_read_b64_tr_b16 v[144:145], v232 offset:32256
    ds_read_b64_tr_b16 v[146:147], v232 offset:32768
    v_mfma_f32_32x32x16_bf16 v[128:143], v[148:151], v[88:91], v[128:143]
    ds_read_b64_tr_b16 v[148:149], v233 offset:32256
    ds_read_b64_tr_b16 v[150:151], v233 offset:32768
    s_waitcnt vmcnt(4)
    s_waitcnt lgkmcnt(8)
    v_mfma_f32_32x32x16_bf16 v[112:127], v[152:155], v[92:95], v[112:127]
    ds_read_b64_tr_b16 v[152:153], v234 offset:32256
    ds_read_b64_tr_b16 v[154:155], v234 offset:32768
    v_mfma_f32_32x32x16_bf16 v[128:143], v[156:159], v[92:95], v[128:143]
    ds_read_b64_tr_b16 v[156:157], v235 offset:32256
    ds_read_b64_tr_b16 v[158:159], v235 offset:32768
    s_waitcnt vmcnt(3)
    s_waitcnt lgkmcnt(8)
    v_mfma_f32_32x32x16_bf16 v[112:127], v[160:163], v[96:99], v[112:127]
    ds_read_b64_tr_b16 v[160:161], v236 offset:32256
    ds_read_b64_tr_b16 v[162:163], v236 offset:32768
    v_mfma_f32_32x32x16_bf16 v[128:143], v[164:167], v[96:99], v[128:143]
    ds_read_b64_tr_b16 v[164:165], v237 offset:32256
    ds_read_b64_tr_b16 v[166:167], v237 offset:32768
    s_waitcnt vmcnt(2)
    s_waitcnt lgkmcnt(8)
    v_mfma_f32_32x32x16_bf16 v[112:127], v[144:147], v[100:103], v[112:127]
    v_mfma_f32_32x32x16_bf16 v[128:143], v[148:151], v[100:103], v[128:143]
    s_waitcnt vmcnt(1)
    s_waitcnt lgkmcnt(4)
    v_mfma_f32_32x32x16_bf16 v[112:127], v[152:155], v[104:107], v[112:127]
    v_mfma_f32_32x32x16_bf16 v[128:143], v[156:159], v[104:107], v[128:143]
    s_waitcnt vmcnt(0)
    s_waitcnt lgkmcnt(0)
    v_mfma_f32_32x32x16_bf16 v[112:127], v[160:163], v[108:111], v[112:127]
    v_mfma_f32_32x32x16_bf16 v[128:143], v[164:167], v[108:111], v[128:143]
    s_barrier
    s_lshl_b32 s40, s3, 12
    v_add_u32 v4, s40, v9
    s_nop 7
    s_cmp_eq_u32 s44, 0
    s_cbranch_scc1 k2_kernel_f_k_63
    ds_write_b128 v4, v[112:115] offset:0
    ds_write_b128 v4, v[116:119] offset:1024
    ds_write_b128 v4, v[120:123] offset:2048
    ds_write_b128 v4, v[124:127] offset:3072
    s_waitcnt lgkmcnt(0)
    v_mov_b32 v112, v128
    v_mov_b32 v113, v129
    v_mov_b32 v114, v130
    v_mov_b32 v115, v131
    v_mov_b32 v116, v132
    v_mov_b32 v117, v133
    v_mov_b32 v118, v134
    v_mov_b32 v119, v135
    v_mov_b32 v120, v136
    v_mov_b32 v121, v137
    v_mov_b32 v122, v138
    v_mov_b32 v123, v139
    v_mov_b32 v124, v140
    v_mov_b32 v125, v141
    v_mov_b32 v126, v142
    v_mov_b32 v127, v143
    s_branch k2_kernel_f_j_64
k2_kernel_f_k_63:
    ds_write_b128 v4, v[128:131] offset:0
    ds_write_b128 v4, v[132:135] offset:1024
    ds_write_b128 v4, v[136:139] offset:2048
    ds_write_b128 v4, v[140:143] offset:3072
k2_kernel_f_j_64:
    s_waitcnt lgkmcnt(0)
    s_barrier
    s_xor_b32 s40, s3, 1
    s_lshl_b32 s40, s40, 12
    v_add_u32 v4, s40, v9
    ds_read_b128 v[32:35], v4 offset:0
    ds_read_b128 v[36:39], v4 offset:1024
    ds_read_b128 v[40:43], v4 offset:2048
    ds_read_b128 v[44:47], v4 offset:3072
    s_waitcnt lgkmcnt(0)
    v_add_f32 v112, v112, v32
    v_add_f32 v113, v113, v33
    v_add_f32 v114, v114, v34
    v_add_f32 v115, v115, v35
    v_add_f32 v116, v116, v36
    v_add_f32 v117, v117, v37
    v_add_f32 v118, v118, v38
    v_add_f32 v119, v119, v39
    v_add_f32 v120, v120, v40
    v_add_f32 v121, v121, v41
    v_add_f32 v122, v122, v42
    v_add_f32 v123, v123, v43
    v_add_f32 v124, v124, v44
    v_add_f32 v125, v125, v45
    v_add_f32 v126, v126, v46
    v_add_f32 v127, v127, v47
    v_fma_f32 v216, v216, v112, v184
    v_fma_f32 v217, v217, v113, v185
    v_fma_f32 v218, v218, v114, v186
    v_fma_f32 v219, v219, v115, v187
    v_fma_f32 v220, v220, v116, v188
    v_fma_f32 v221, v221, v117, v189
    v_fma_f32 v222, v222, v118, v190
    v_fma_f32 v223, v223, v119, v191
    v_fma_f32 v224, v224, v120, v192
    v_fma_f32 v225, v225, v121, v193
    v_fma_f32 v226, v226, v122, v194
    v_fma_f32 v227, v227, v123, v195
    v_fma_f32 v228, v228, v124, v196
    v_fma_f32 v229, v229, v125, v197
    v_fma_f32 v230, v230, v126, v198
    v_fma_f32 v231, v231, v127, v199
    v_cvt_pk_bf16_f32 v216, v216, v217
    v_cvt_pk_bf16_f32 v217, v218, v219
    v_cvt_pk_bf16_f32 v218, v220, v221
    v_cvt_pk_bf16_f32 v219, v222, v223
    v_cvt_pk_bf16_f32 v220, v224, v225
    v_cvt_pk_bf16_f32 v221, v226, v227
    v_cvt_pk_bf16_f32 v222, v228, v229
    v_cvt_pk_bf16_f32 v223, v230, v231
    buffer_store_dwordx4 v[216:219], v10, s[32:35], 0 offen
    buffer_store_dwordx4 v[220:223], v10, s[32:35], 0 offen offset:32
k2_kernel_end:
    s_endpgm
.section .rodata,"a"
.p2align 6
.amdhsa_kernel k2_kernel
  .amdhsa_next_free_vgpr 240
  .amdhsa_next_free_sgpr 96
  .amdhsa_accum_offset 240
  .amdhsa_group_segment_fixed_size 0
  .amdhsa_kernarg_size 80
  .amdhsa_user_sgpr_count 2
  .amdhsa_user_sgpr_kernarg_segment_ptr 1
  .amdhsa_system_sgpr_workgroup_id_x 1
  .amdhsa_float_denorm_mode_32 0
.end_amdhsa_kernel
```
